```python
import torch

def _softmax(x, axis=-1):
    return torch.softmax(x, dim=axis)
def _gelu(x):
    return torch.nn.functional.gelu(x, approximate="tanh")
def _silu(x):
    return torch.nn.functional.silu(x)
def _sigmoid(x):
    return torch.sigmoid(x)
def _layernorm(x, axis=-1, eps=1e-5):
    m = x.mean(dim=axis, keepdim=True)
    v = x.var(dim=axis, keepdim=True, unbiased=False)
    return (x - m) / torch.sqrt(v + eps)
def _scatter_add(tgt, idx, src, axis=0):
    return tgt.clone().index_add_(axis, idx, src)
def _segment_sum(src, seg, n):
    out = torch.zeros((n,) + src.shape[1:], dtype=src.dtype)
    return out.index_add_(0, seg, src)
def _pad(x, pw):
    flat = tuple(v for pair in reversed(pw) for v in pair)
    return torch.nn.functional.pad(x, flat)

kernel_name = 'interleave_layers__sliding_local_dilated__glu_gated_geglu__prompt'

def setup_inputs():

    _w = (lambda a: (lambda t: t.to(torch.bfloat16) if t.is_floating_point() else t)(torch.as_tensor(a)))
    def _A_setup():
        B, S, D = 1, 2048, 640
        return {
            "x": _w((lambda *s: torch.randn(*s, dtype=torch.bfloat16) * 0.05)(B, S, D)),
            "wqkv": _w((lambda *s: torch.randn(*s, dtype=torch.bfloat16) * 0.05)(D, 3 * D)),
            "wo": _w((lambda *s: torch.randn(*s, dtype=torch.bfloat16) * 0.05)(D, D)),
        }
    _A_in = _A_setup()

    def _B_setup():
        B, S, Dm, Df = 1, 2048, 640, 1728
        return {
            "x": _w((lambda *s: torch.randn(*s, dtype=torch.bfloat16) * 0.05)(B, S, Dm)),
            "w_gate": _w((lambda *s: torch.randn(*s, dtype=torch.bfloat16) * 0.8)(Dm, Df) * (Dm ** -0.5)),
            "w_up": _w((lambda *s: torch.randn(*s, dtype=torch.bfloat16) * 0.8)(Dm, Df) * (Dm ** -0.5)),
            "w_down": _w((lambda *s: torch.randn(*s, dtype=torch.bfloat16) * 0.8)(Df, Dm) * (Df ** -0.5)),
        }
    _B_in = _B_setup()

    return {
        "A_x": _A_in["x"],
        "A_wqkv": _A_in["wqkv"],
        "A_wo": _A_in["wo"],
        "B_x": _B_in["x"],
        "B_w_gate": _B_in["w_gate"],
        "B_w_up": _B_in["w_up"],
        "B_w_down": _B_in["w_down"],
    }

def reference(A_x, A_wqkv, A_wo, B_x, B_w_gate, B_w_up, B_w_down):
    def _A_ref(x, wqkv, wo):
        B, S, D = x.shape
        H = 32; Dh = D // H
        W, dil = 8, 2
        qkv = (lambda x, *d: x.permute(*d))((x @ wqkv).reshape(B, S, 3, H, Dh), 2, 0, 3, 1, 4)
        q, k, v = qkv[0], qkv[1], qkv[2]
        scale = Dh ** -0.5
        pos = torch.arange(S)
        off = torch.arange(W) * dil
        idx = pos[:, None] - off[None, :]
        mask = idx >= 0
        idx_c = torch.where(mask, idx, 0).reshape(-1)
        kg = k[:, :, idx_c, :].reshape(B, H, S, W, Dh)
        vg = v[:, :, idx_c, :].reshape(B, H, S, W, Dh)
        logits = torch.einsum("bhsd,bhswd->bhsw", q, kg) * scale
        logits = torch.where(mask[None, None, :, :], logits, -1e9)
        attn = _softmax(logits, axis=-1)
        o = torch.einsum("bhsw,bhswd->bhsd", attn, vg)
        return (lambda x, *d: x.permute(*d))(o, 0, 2, 1, 3).reshape(B, S, D) @ wo

    def _B_ref(x, w_gate, w_up, w_down):
        g = torch.einsum("bsd,df->bsf", x, w_gate)
        u = torch.einsum("bsd,df->bsf", x, w_up)
        h = _gelu(g) * u
        return torch.einsum("bsf,fd->bsd", h, w_down)

    x = A_x
    x = x + _A_ref(_layernorm(x, axis=-1), A_wqkv, A_wo)
    x = x + _B_ref(_layernorm(x, axis=-1), B_w_gate, B_w_up, B_w_down)
    x = x + _A_ref(_layernorm(x, axis=-1), A_wqkv, A_wo)
    x = x + _B_ref(_layernorm(x, axis=-1), B_w_gate, B_w_up, B_w_down)
    return x
```

```asm
; @launch grid=(256,1,1) block=(256,1,1) lds=163840
.amdgcn_target "amdgcn-amd-amdhsa--gfx950"
.text
.globl interleave_layers__sliding_local_dilated__glu_gated_geglu__prompt_kernel
.p2align 8
.type interleave_layers__sliding_local_dilated__glu_gated_geglu__prompt_kernel,@function
interleave_layers__sliding_local_dilated__glu_gated_geglu__prompt_kernel:
L_kstart:
s_cmp_ge_u32 s2, 256
s_cbranch_scc1 L_end_interleave_layers__sliding_local_dilated__glu_gated_geglu__prompt_kernel
s_getpc_b64 s[20:21]
v_lshlrev_b32_e64 v8, 7, v0
global_load_dword v250, v8, s[20:21]
s_add_u32 s3, s2, 246
s_and_b32 s3, s3, 255
s_load_dwordx16 s[48:63], s[0:1], 0
s_load_dwordx4 s[36:39], s[0:1], 64
s_getreg_b32 s33, hwreg(HW_REG_XCC_ID, 0, 4)
v_lshrrev_b32 v1, 6, v0
v_and_b32 v2, 63, v0
v_lshlrev_b32 v3, 4, v2
v_readfirstlane_b32 s16, v1
v_and_b32 v4, 3, v2
v_bfe_u32 v5, v2, 2, 2
v_lshrrev_b32 v6, 4, v2
s_and_b32 s33, s33, 7
s_cmp_lg_u32 s16, 3
s_cbranch_scc1 L_cp_1
s_getpc_b64 s[20:21]
L_cpbase:
s_lshr_b32 s17, s3, 3
s_mul_i32 s17, s17, 2176
v_lshlrev_b32 v8, 7, v2
v_add_u32 v8, s17, v8
v_min_u32 v8, 68224, v8
s_add_u32 s20, s20, L_kstart-L_cpbase
s_addc_u32 s21, s21, -1
s_mov_b64 s[22:23], exec
s_mov_b64 exec, 0x1ffff
global_load_dword v250, v8, s[20:21]
s_mov_b64 exec, s[22:23]
L_cp_1:
s_mov_b32 s34, 0xffff
s_mov_b32 s35, 0xffff
s_add_u32 s17, s3, 108
s_cmp_lt_u32 s3, 224
s_cselect_b32 s34, s17, s34
s_mov_b32 s17, s3
s_cmp_lt_u32 s3, 160
s_cbranch_scc1 L_ua_2
s_cmp_lt_u32 s3, 224
s_cbranch_scc1 L_units_3
s_cmp_ge_u32 s3, 246
s_cbranch_scc1 L_units_3
s_sub_u32 s17, s3, 64
L_ua_2:
s_add_u32 s35, s17, 386
s_cmp_lt_u32 s17, 20
s_cbranch_scc1 L_lb_4
s_sub_u32 s35, s17, 20
s_cmp_lt_u32 s17, 128
s_cbranch_scc1 L_lb_4
s_add_u32 s35, s17, 204
L_lb_4:
L_units_3:
s_waitcnt lgkmcnt(0)
s_mov_b32 s40, s36
s_mov_b32 s41, s37
s_mov_b32 s42, 256
s_mov_b32 s43, 0x20000
s_mov_b32 s44, s38
s_mov_b32 s45, s39
s_mov_b32 s46, 23719936
s_mov_b32 s47, 0x20000
s_cmp_lg_u32 s3, 246
s_cbranch_scc1 L_nonce_5
s_cmp_lg_u32 s16, 3
s_cbranch_scc1 L_nonce_5
v_mov_b32 v9, 23420928
v_lshlrev_b32 v13, 7, v2
v_add_u32 v13, 23416832, v13
v_mov_b32 v14, 0
s_mov_b64 s[38:39], exec
s_mov_b64 exec, 0xff
buffer_store_dword v14, v13, s[44:47], 0 offen sc1
s_mov_b64 exec, 1
buffer_load_dword v10, v9, s[44:47], 0 offen sc1
s_waitcnt vmcnt(0)
v_add_u32 v10, 1024, v10
v_mov_b32 v11, 1
v_mov_b32 v12, 64
buffer_store_dwordx2 v[10:11], v12, s[40:43], 0 offen sc1
buffer_store_dword v10, v9, s[44:47], 0 offen sc1
s_mov_b64 exec, s[38:39]
L_nonce_5:
s_cmp_eq_u32 s34, 0xffff
s_cbranch_scc1 L_iss1
s_mov_b32 s2, s34
s_mov_b32 s32, 0
s_cmp_lt_u32 s2, 108
s_cbranch_scc1 L_iss_6_wgu
s_cmp_lt_u32 s2, 268
s_cbranch_scc1 L_iss_6_wq
s_cmp_lt_u32 s2, 332
s_cbranch_scc1 L_iss_6_x
s_cmp_lt_u32 s2, 386
s_cbranch_scc1 L_iss_6_wd
s_mov_b32 s8, s52
s_mov_b32 s9, s53
s_mov_b32 s10, 819200
s_mov_b32 s11, 0x20000
s_sub_u32 s17, s2, 386
s_mul_i32 s20, s17, 40960
s_branch L_iss_6_rows_w
L_iss_6_wd:
s_mov_b32 s8, s60
s_mov_b32 s9, s61
s_mov_b32 s10, 2211840
s_mov_b32 s11, 0x20000
s_sub_u32 s17, s2, 332
s_mul_i32 s20, s17, 40960
L_iss_6_rows_w:
s_lshl_b32 s21, s16, 1
s_mul_i32 s22, s21, 5120
s_add_u32 s23, s22, s32
s_add_u32 s22, s22, s20
s_and_b32 s21, s21, 3
s_lshl_b32 s21, s21, 2
v_add_u32 v20, 0, v2
v_mul_u32_u24 v21, 205, v20
v_lshrrev_b32 v21, 14, v21
v_mul_u32_u24 v22, 80, v21
v_sub_u32 v22, v20, v22
v_mul_u32_u24 v24, 1280, v21
s_add_u32 s29, s21, 0
v_add_u32 v23, s29, v21
v_and_b32 v23, 7, v23
v_lshlrev_b32 v23, 1, v23
v_xor_b32 v23, v22, v23
v_lshlrev_b32 v23, 4, v23
v_add_u32 v10, v24, v23
s_add_u32 m0, s23, 0
s_add_u32 s30, s22, 0
buffer_load_dwordx4 v10, s[8:11], s30 offen lds
s_add_u32 s29, s21, 4
v_add_u32 v23, s29, v21
v_and_b32 v23, 7, v23
v_lshlrev_b32 v23, 1, v23
v_xor_b32 v23, v22, v23
v_lshlrev_b32 v23, 4, v23
v_add_u32 v15, v24, v23
s_add_u32 m0, s23, 5120
s_add_u32 s30, s22, 5120
buffer_load_dwordx4 v15, s[8:11], s30 offen lds
v_add_u32 v20, 64, v2
v_mul_u32_u24 v21, 205, v20
v_lshrrev_b32 v21, 14, v21
v_mul_u32_u24 v22, 80, v21
v_sub_u32 v22, v20, v22
v_mul_u32_u24 v24, 1280, v21
s_add_u32 s29, s21, 0
v_add_u32 v23, s29, v21
v_and_b32 v23, 7, v23
v_lshlrev_b32 v23, 1, v23
v_xor_b32 v23, v22, v23
v_lshlrev_b32 v23, 4, v23
v_add_u32 v11, v24, v23
s_add_u32 m0, s23, 1024
s_add_u32 s30, s22, 0
buffer_load_dwordx4 v11, s[8:11], s30 offen lds
s_add_u32 s29, s21, 4
v_add_u32 v23, s29, v21
v_and_b32 v23, 7, v23
v_lshlrev_b32 v23, 1, v23
v_xor_b32 v23, v22, v23
v_lshlrev_b32 v23, 4, v23
v_add_u32_e64 v16, v24, v23
s_add_u32 m0, s23, 6144
s_add_u32 s30, s22, 5120
buffer_load_dwordx4 v16, s[8:11], s30 offen lds
v_add_u32 v20, 128, v2
v_mul_u32_u24 v21, 205, v20
v_lshrrev_b32 v21, 14, v21
v_mul_u32_u24 v22, 80, v21
v_sub_u32 v22, v20, v22
v_mul_u32_u24 v24, 1280, v21
s_add_u32 s29, s21, 0
v_add_u32 v23, s29, v21
v_and_b32 v23, 7, v23
v_lshlrev_b32 v23, 1, v23
v_xor_b32 v23, v22, v23
v_lshlrev_b32 v23, 4, v23
v_add_u32 v12, v24, v23
s_add_u32 m0, s23, 2048
s_add_u32 s30, s22, 0
buffer_load_dwordx4 v12, s[8:11], s30 offen lds
s_add_u32 s29, s21, 4
v_add_u32 v23, s29, v21
v_and_b32 v23, 7, v23
v_lshlrev_b32 v23, 1, v23
v_xor_b32 v23, v22, v23
v_lshlrev_b32 v23, 4, v23
v_add_u32_e64 v17, v24, v23
s_add_u32 m0, s23, 7168
s_add_u32 s30, s22, 5120
buffer_load_dwordx4 v17, s[8:11], s30 offen lds
v_add_u32 v20, 192, v2
v_mul_u32_u24 v21, 205, v20
v_lshrrev_b32 v21, 14, v21
v_mul_u32_u24 v22, 80, v21
v_sub_u32 v22, v20, v22
v_mul_u32_u24 v24, 1280, v21
s_add_u32 s29, s21, 0
v_add_u32 v23, s29, v21
v_and_b32 v23, 7, v23
v_lshlrev_b32 v23, 1, v23
v_xor_b32 v23, v22, v23
v_lshlrev_b32 v23, 4, v23
v_add_u32 v13, v24, v23
s_add_u32 m0, s23, 3072
s_add_u32 s30, s22, 0
buffer_load_dwordx4 v13, s[8:11], s30 offen lds
s_add_u32 s29, s21, 4
v_add_u32 v23, s29, v21
v_and_b32 v23, 7, v23
v_lshlrev_b32 v23, 1, v23
v_xor_b32 v23, v22, v23
v_lshlrev_b32 v23, 4, v23
v_add_u32_e64 v18, v24, v23
s_add_u32 m0, s23, 8192
s_add_u32 s30, s22, 5120
buffer_load_dwordx4 v18, s[8:11], s30 offen lds
v_add_u32 v20, 256, v2
v_mul_u32_u24 v21, 205, v20
v_lshrrev_b32 v21, 14, v21
v_mul_u32_u24 v22, 80, v21
v_sub_u32 v22, v20, v22
v_mul_u32_u24 v24, 1280, v21
s_add_u32 s29, s21, 0
v_add_u32 v23, s29, v21
v_and_b32 v23, 7, v23
v_lshlrev_b32 v23, 1, v23
v_xor_b32 v23, v22, v23
v_lshlrev_b32 v23, 4, v23
v_add_u32 v14, v24, v23
s_add_u32 m0, s23, 4096
s_add_u32 s30, s22, 0
buffer_load_dwordx4 v14, s[8:11], s30 offen lds
s_add_u32 s29, s21, 4
v_add_u32 v23, s29, v21
v_and_b32 v23, 7, v23
v_lshlrev_b32 v23, 1, v23
v_xor_b32 v23, v22, v23
v_lshlrev_b32 v23, 4, v23
v_add_u32 v19, v24, v23
s_add_u32 m0, s23, 9216
s_add_u32 s30, s22, 5120
buffer_load_dwordx4 v19, s[8:11], s30 offen lds
s_branch L_iss1
L_iss_6_x:
s_mov_b32 s8, s48
s_mov_b32 s9, s49
s_mov_b32 s10, 2621440
s_mov_b32 s11, 0x20000
s_sub_u32 s17, s2, 268
s_mul_i32 s20, s17, 40960
s_lshl_b32 s21, s16, 1
s_mul_i32 s22, s21, 5120
s_add_u32 s23, s22, s32
s_add_u32 s22, s22, s20
s_and_b32 s21, s21, 3
s_lshl_b32 s21, s21, 2
v_add_u32 v20, 0, v2
v_mul_u32_u24 v21, 205, v20
v_lshrrev_b32 v21, 14, v21
v_mul_u32_u24 v22, 80, v21
v_sub_u32 v22, v20, v22
v_mul_u32_u24 v24, 1280, v21
s_add_u32 s29, s21, 0
v_add_u32 v23, s29, v21
v_xor_b32 v23, v22, v23
v_lshlrev_b32 v23, 4, v23
v_add_u32 v10, v24, v23
s_add_u32 m0, s23, 0
s_add_u32 s30, s22, 0
buffer_load_dwordx4 v10, s[8:11], s30 offen lds
s_add_u32 s29, s21, 4
v_add_u32 v23, s29, v21
v_xor_b32 v23, v22, v23
v_lshlrev_b32 v23, 4, v23
v_add_u32 v15, v24, v23
s_add_u32 m0, s23, 5120
s_add_u32 s30, s22, 5120
buffer_load_dwordx4 v15, s[8:11], s30 offen lds
v_add_u32 v20, 64, v2
v_mul_u32_u24 v21, 205, v20
v_lshrrev_b32 v21, 14, v21
v_mul_u32_u24 v22, 80, v21
v_sub_u32 v22, v20, v22
v_mul_u32_u24 v24, 1280, v21
s_add_u32 s29, s21, 0
v_add_u32 v23, s29, v21
v_xor_b32 v23, v22, v23
v_lshlrev_b32 v23, 4, v23
v_add_u32 v11, v24, v23
s_add_u32 m0, s23, 1024
s_add_u32 s30, s22, 0
buffer_load_dwordx4 v11, s[8:11], s30 offen lds
s_add_u32 s29, s21, 4
v_add_u32 v23, s29, v21
v_xor_b32 v23, v22, v23
v_lshlrev_b32 v23, 4, v23
v_add_u32 v16, v24, v23
s_add_u32 m0, s23, 6144
s_add_u32 s30, s22, 5120
buffer_load_dwordx4 v16, s[8:11], s30 offen lds
v_add_u32 v20, 128, v2
v_mul_u32_u24 v21, 205, v20
v_lshrrev_b32 v21, 14, v21
v_mul_u32_u24 v22, 80, v21
v_sub_u32 v22, v20, v22
v_mul_u32_u24 v24, 1280, v21
s_add_u32 s29, s21, 0
v_add_u32 v23, s29, v21
v_xor_b32 v23, v22, v23
v_lshlrev_b32 v23, 4, v23
v_add_u32 v12, v24, v23
s_add_u32 m0, s23, 2048
s_add_u32 s30, s22, 0
buffer_load_dwordx4 v12, s[8:11], s30 offen lds
s_add_u32 s29, s21, 4
v_add_u32 v23, s29, v21
v_xor_b32 v23, v22, v23
v_lshlrev_b32 v23, 4, v23
v_add_u32_e64 v17, v24, v23
s_add_u32 m0, s23, 7168
s_add_u32 s30, s22, 5120
buffer_load_dwordx4 v17, s[8:11], s30 offen lds
v_add_u32 v20, 192, v2
v_mul_u32_u24 v21, 205, v20
v_lshrrev_b32 v21, 14, v21
v_mul_u32_u24 v22, 80, v21
v_sub_u32 v22, v20, v22
v_mul_u32_u24 v24, 1280, v21
s_add_u32 s29, s21, 0
v_add_u32 v23, s29, v21
v_xor_b32 v23, v22, v23
v_lshlrev_b32 v23, 4, v23
v_add_u32 v13, v24, v23
s_add_u32 m0, s23, 3072
s_add_u32 s30, s22, 0
buffer_load_dwordx4 v13, s[8:11], s30 offen lds
s_add_u32 s29, s21, 4
v_add_u32 v23, s29, v21
v_xor_b32 v23, v22, v23
v_lshlrev_b32 v23, 4, v23
v_add_u32_e64 v18, v24, v23
s_add_u32 m0, s23, 8192
s_add_u32 s30, s22, 5120
buffer_load_dwordx4 v18, s[8:11], s30 offen lds
v_add_u32 v20, 256, v2
v_mul_u32_u24 v21, 205, v20
v_lshrrev_b32 v21, 14, v21
v_mul_u32_u24 v22, 80, v21
v_sub_u32 v22, v20, v22
v_mul_u32_u24 v24, 1280, v21
s_add_u32 s29, s21, 0
v_add_u32 v23, s29, v21
v_xor_b32 v23, v22, v23
v_lshlrev_b32 v23, 4, v23
v_add_u32 v14, v24, v23
s_add_u32 m0, s23, 4096
s_add_u32 s30, s22, 0
buffer_load_dwordx4 v14, s[8:11], s30 offen lds
s_add_u32 s29, s21, 4
v_add_u32 v23, s29, v21
v_xor_b32 v23, v22, v23
v_lshlrev_b32 v23, 4, v23
v_add_u32 v19, v24, v23
s_add_u32 m0, s23, 9216
s_add_u32 s30, s22, 5120
buffer_load_dwordx4 v19, s[8:11], s30 offen lds
s_branch L_iss1
L_iss_6_wgu:
s_cmp_ge_u32 s2, 54
s_cselect_b32 s17, 1, 0
s_cselect_b32 s6, s58, s56
s_cselect_b32 s7, s59, s57
s_mul_i32 s18, s17, 54
s_sub_u32 s18, s2, s18
s_lshr_b32 s19, s18, 1
s_and_b32 s18, s18, 1
s_mov_b32 s8, s6
s_mov_b32 s9, s7
s_mov_b32 s10, 2211840
s_mov_b32 s11, 0x20000
v_lshrrev_b32 v20, 3, v2
v_and_b32 v21, 7, v2
v_bfe_u32 v22, v20, 1, 2
v_lshlrev_b32 v22, 1, v22
v_xor_b32 v21, v21, v22
v_lshlrev_b32 v21, 4, v21
v_mul_u32_u24 v20, 3456, v20
v_add_u32 v10, v20, v21
s_mul_i32 s20, s18, 1105920
s_lshl_b32 s21, s19, 7
s_add_u32 s20, s20, s21
s_mul_i32 s21, s16, 276480
s_add_u32 s20, s20, s21
s_mul_i32 s23, s16, 10240
s_add_u32 s23, s23, s32
s_add_u32 m0, s23, 0
s_nop 0
buffer_load_dwordx4 v10, s[8:11], s20 offen lds
s_add_u32 m0, s23, 1024
s_add_u32 s20, s20, 27648
buffer_load_dwordx4 v10, s[8:11], s20 offen lds
s_add_u32 m0, s23, 2048
s_add_u32 s20, s20, 27648
buffer_load_dwordx4 v10, s[8:11], s20 offen lds
s_add_u32 m0, s23, 3072
s_add_u32 s20, s20, 27648
buffer_load_dwordx4 v10, s[8:11], s20 offen lds
s_add_u32 m0, s23, 4096
s_add_u32 s20, s20, 27648
buffer_load_dwordx4 v10, s[8:11], s20 offen lds
s_add_u32 m0, s23, 5120
s_add_u32 s20, s20, 27648
buffer_load_dwordx4 v10, s[8:11], s20 offen lds
s_add_u32 m0, s23, 6144
s_add_u32 s20, s20, 27648
buffer_load_dwordx4 v10, s[8:11], s20 offen lds
s_add_u32 m0, s23, 7168
s_add_u32 s20, s20, 27648
buffer_load_dwordx4 v10, s[8:11], s20 offen lds
s_add_u32 m0, s23, 8192
s_add_u32 s20, s20, 27648
buffer_load_dwordx4 v10, s[8:11], s20 offen lds
s_add_u32 m0, s23, 9216
s_add_u32 s20, s20, 27648
buffer_load_dwordx4 v10, s[8:11], s20 offen lds
s_branch L_iss1
L_iss_6_wq:
s_mov_b32 s8, s50
s_mov_b32 s9, s51
s_mov_b32 s10, 2457600
s_mov_b32 s11, 0x20000
s_sub_u32 s17, s2, 108
s_and_b32 s18, s17, 7
s_lshr_b32 s17, s17, 3
s_mul_i32 s19, s18, 160
s_and_b32 s26, s19, 0xffffff80
v_lshrrev_b32 v20, 4, v2
v_mul_u32_u24 v20, 3840, v20
v_and_b32 v21, 15, v2
v_lshlrev_b32 v21, 4, v21
v_add_u32 v10, v20, v21
s_mul_i32 s20, s17, 122880
s_add_u32 s20, s20, s26
s_mul_i32 s21, s16, 6
s_add_u32 s22, s21, 0
s_lshr_b32 s23, s22, 3
s_and_b32 s24, s22, 7
s_mul_i32 s24, s24, 15360
s_mul_i32 s23, s23, 1280
s_add_u32 s24, s24, s23
s_lshl_b32 m0, s22, 10
s_add_u32 s24, s24, s20
buffer_load_dwordx4 v10, s[8:11], s24 offen lds
s_add_u32 s22, s21, 1
s_lshr_b32 s23, s22, 3
s_and_b32 s24, s22, 7
s_mul_i32 s24, s24, 15360
s_mul_i32 s23, s23, 1280
s_add_u32 s24, s24, s23
s_lshl_b32 m0, s22, 10
s_add_u32 s24, s24, s20
buffer_load_dwordx4 v10, s[8:11], s24 offen lds
s_add_u32 s22, s21, 2
s_lshr_b32 s23, s22, 3
s_and_b32 s24, s22, 7
s_mul_i32 s24, s24, 15360
s_mul_i32 s23, s23, 1280
s_add_u32 s24, s24, s23
s_lshl_b32 m0, s22, 10
s_add_u32 s24, s24, s20
buffer_load_dwordx4 v10, s[8:11], s24 offen lds
s_add_u32 s22, s21, 3
s_lshr_b32 s23, s22, 3
s_and_b32 s24, s22, 7
s_mul_i32 s24, s24, 15360
s_mul_i32 s23, s23, 1280
s_add_u32 s24, s24, s23
s_lshl_b32 m0, s22, 10
s_add_u32 s24, s24, s20
buffer_load_dwordx4 v10, s[8:11], s24 offen lds
s_add_u32 s22, s21, 4
s_lshr_b32 s23, s22, 3
s_and_b32 s24, s22, 7
s_mul_i32 s24, s24, 15360
s_mul_i32 s23, s23, 1280
s_add_u32 s24, s24, s23
s_lshl_b32 m0, s22, 10
s_add_u32 s24, s24, s20
buffer_load_dwordx4 v10, s[8:11], s24 offen lds
s_add_u32 s22, s21, 5
s_lshr_b32 s23, s22, 3
s_and_b32 s24, s22, 7
s_mul_i32 s24, s24, 15360
s_mul_i32 s23, s23, 1280
s_add_u32 s24, s24, s23
s_lshl_b32 m0, s22, 10
s_add_u32 s24, s24, s20
buffer_load_dwordx4 v10, s[8:11], s24 offen lds
s_branch L_iss1
L_iss1:
s_cmp_eq_u32 s35, 0xffff
s_cbranch_scc1 L_iss2
s_mov_b32 s2, s35
s_mov_b32 s32, 90112
s_cmp_lt_u32 s2, 108
s_cbranch_scc1 L_iss_7_wgu
s_cmp_lt_u32 s2, 268
s_cbranch_scc1 L_iss_7_wq
s_cmp_lt_u32 s2, 332
s_cbranch_scc1 L_iss_7_x
s_cmp_lt_u32 s2, 386
s_cbranch_scc1 L_iss_7_wd
s_mov_b32 s8, s52
s_mov_b32 s9, s53
s_mov_b32 s10, 819200
s_mov_b32 s11, 0x20000
s_sub_u32 s17, s2, 386
s_mul_i32 s20, s17, 40960
s_branch L_iss_7_rows_w
L_iss_7_wd:
s_mov_b32 s8, s60
s_mov_b32 s9, s61
s_mov_b32 s10, 2211840
s_mov_b32 s11, 0x20000
s_sub_u32 s17, s2, 332
s_mul_i32 s20, s17, 40960
L_iss_7_rows_w:
s_lshl_b32 s21, s16, 1
s_mul_i32 s22, s21, 5120
s_add_u32 s23, s22, s32
s_add_u32 s22, s22, s20
s_and_b32 s21, s21, 3
s_lshl_b32 s21, s21, 2
v_add_u32 v20, 0, v2
v_mul_u32_u24 v21, 205, v20
v_lshrrev_b32 v21, 14, v21
v_mul_u32_u24 v22, 80, v21
v_sub_u32 v22, v20, v22
v_mul_u32_u24 v24, 1280, v21
s_add_u32 s29, s21, 0
v_add_u32 v23, s29, v21
v_and_b32 v23, 7, v23
v_lshlrev_b32 v23, 1, v23
v_xor_b32 v23, v22, v23
v_lshlrev_b32 v23, 4, v23
v_add_u32 v10, v24, v23
s_add_u32 m0, s23, 0
s_add_u32 s30, s22, 0
buffer_load_dwordx4 v10, s[8:11], s30 offen lds
s_add_u32 s29, s21, 4
v_add_u32 v23, s29, v21
v_and_b32 v23, 7, v23
v_lshlrev_b32 v23, 1, v23
v_xor_b32 v23, v22, v23
v_lshlrev_b32 v23, 4, v23
v_add_u32 v15, v24, v23
s_add_u32 m0, s23, 5120
s_add_u32 s30, s22, 5120
buffer_load_dwordx4 v15, s[8:11], s30 offen lds
v_add_u32 v20, 64, v2
v_mul_u32_u24 v21, 205, v20
v_lshrrev_b32 v21, 14, v21
v_mul_u32_u24 v22, 80, v21
v_sub_u32 v22, v20, v22
v_mul_u32_u24 v24, 1280, v21
s_add_u32 s29, s21, 0
v_add_u32 v23, s29, v21
v_and_b32 v23, 7, v23
v_lshlrev_b32 v23, 1, v23
v_xor_b32 v23, v22, v23
v_lshlrev_b32 v23, 4, v23
v_add_u32 v11, v24, v23
s_add_u32 m0, s23, 1024
s_add_u32 s30, s22, 0
buffer_load_dwordx4 v11, s[8:11], s30 offen lds
s_add_u32 s29, s21, 4
v_add_u32 v23, s29, v21
v_and_b32 v23, 7, v23
v_lshlrev_b32 v23, 1, v23
v_xor_b32 v23, v22, v23
v_lshlrev_b32 v23, 4, v23
v_add_u32_e64 v16, v24, v23
s_add_u32 m0, s23, 6144
s_add_u32 s30, s22, 5120
buffer_load_dwordx4 v16, s[8:11], s30 offen lds
v_add_u32 v20, 128, v2
v_mul_u32_u24 v21, 205, v20
v_lshrrev_b32 v21, 14, v21
v_mul_u32_u24 v22, 80, v21
v_sub_u32 v22, v20, v22
v_mul_u32_u24 v24, 1280, v21
s_add_u32 s29, s21, 0
v_add_u32 v23, s29, v21
v_and_b32 v23, 7, v23
v_lshlrev_b32 v23, 1, v23
v_xor_b32 v23, v22, v23
v_lshlrev_b32 v23, 4, v23
v_add_u32 v12, v24, v23
s_add_u32 m0, s23, 2048
s_add_u32 s30, s22, 0
buffer_load_dwordx4 v12, s[8:11], s30 offen lds
s_add_u32 s29, s21, 4
v_add_u32 v23, s29, v21
v_and_b32 v23, 7, v23
v_lshlrev_b32 v23, 1, v23
v_xor_b32 v23, v22, v23
v_lshlrev_b32 v23, 4, v23
v_add_u32_e64 v17, v24, v23
s_add_u32 m0, s23, 7168
s_add_u32 s30, s22, 5120
buffer_load_dwordx4 v17, s[8:11], s30 offen lds
v_add_u32 v20, 192, v2
v_mul_u32_u24 v21, 205, v20
v_lshrrev_b32 v21, 14, v21
v_mul_u32_u24 v22, 80, v21
v_sub_u32 v22, v20, v22
v_mul_u32_u24 v24, 1280, v21
s_add_u32 s29, s21, 0
v_add_u32 v23, s29, v21
v_and_b32 v23, 7, v23
v_lshlrev_b32 v23, 1, v23
v_xor_b32 v23, v22, v23
v_lshlrev_b32 v23, 4, v23
v_add_u32 v13, v24, v23
s_add_u32 m0, s23, 3072
s_add_u32 s30, s22, 0
buffer_load_dwordx4 v13, s[8:11], s30 offen lds
s_add_u32 s29, s21, 4
v_add_u32 v23, s29, v21
v_and_b32 v23, 7, v23
v_lshlrev_b32 v23, 1, v23
v_xor_b32 v23, v22, v23
v_lshlrev_b32 v23, 4, v23
v_add_u32_e64 v18, v24, v23
s_add_u32 m0, s23, 8192
s_add_u32 s30, s22, 5120
buffer_load_dwordx4 v18, s[8:11], s30 offen lds
v_add_u32 v20, 256, v2
v_mul_u32_u24 v21, 205, v20
v_lshrrev_b32 v21, 14, v21
v_mul_u32_u24 v22, 80, v21
v_sub_u32 v22, v20, v22
v_mul_u32_u24 v24, 1280, v21
s_add_u32 s29, s21, 0
v_add_u32 v23, s29, v21
v_and_b32 v23, 7, v23
v_lshlrev_b32 v23, 1, v23
v_xor_b32 v23, v22, v23
v_lshlrev_b32 v23, 4, v23
v_add_u32 v14, v24, v23
s_add_u32 m0, s23, 4096
s_add_u32 s30, s22, 0
buffer_load_dwordx4 v14, s[8:11], s30 offen lds
s_add_u32 s29, s21, 4
v_add_u32 v23, s29, v21
v_and_b32 v23, 7, v23
v_lshlrev_b32 v23, 1, v23
v_xor_b32 v23, v22, v23
v_lshlrev_b32 v23, 4, v23
v_add_u32 v19, v24, v23
s_add_u32 m0, s23, 9216
s_add_u32 s30, s22, 5120
buffer_load_dwordx4 v19, s[8:11], s30 offen lds
s_branch L_iss2
L_iss_7_x:
s_mov_b32 s8, s48
s_mov_b32 s9, s49
s_mov_b32 s10, 2621440
s_mov_b32 s11, 0x20000
s_sub_u32 s17, s2, 268
s_mul_i32 s20, s17, 40960
s_lshl_b32 s21, s16, 1
s_mul_i32 s22, s21, 5120
s_add_u32 s23, s22, s32
s_add_u32 s22, s22, s20
s_and_b32 s21, s21, 3
s_lshl_b32 s21, s21, 2
v_add_u32 v20, 0, v2
v_mul_u32_u24 v21, 205, v20
v_lshrrev_b32 v21, 14, v21
v_mul_u32_u24 v22, 80, v21
v_sub_u32 v22, v20, v22
v_mul_u32_u24 v24, 1280, v21
s_add_u32 s29, s21, 0
v_add_u32 v23, s29, v21
v_xor_b32 v23, v22, v23
v_lshlrev_b32 v23, 4, v23
v_add_u32 v10, v24, v23
s_add_u32 m0, s23, 0
s_add_u32 s30, s22, 0
buffer_load_dwordx4 v10, s[8:11], s30 offen lds
s_add_u32 s29, s21, 4
v_add_u32 v23, s29, v21
v_xor_b32 v23, v22, v23
v_lshlrev_b32 v23, 4, v23
v_add_u32 v15, v24, v23
s_add_u32 m0, s23, 5120
s_add_u32 s30, s22, 5120
buffer_load_dwordx4 v15, s[8:11], s30 offen lds
v_add_u32 v20, 64, v2
v_mul_u32_u24 v21, 205, v20
v_lshrrev_b32 v21, 14, v21
v_mul_u32_u24 v22, 80, v21
v_sub_u32 v22, v20, v22
v_mul_u32_u24 v24, 1280, v21
s_add_u32 s29, s21, 0
v_add_u32 v23, s29, v21
v_xor_b32 v23, v22, v23
v_lshlrev_b32 v23, 4, v23
v_add_u32 v11, v24, v23
s_add_u32 m0, s23, 1024
s_add_u32 s30, s22, 0
buffer_load_dwordx4 v11, s[8:11], s30 offen lds
s_add_u32 s29, s21, 4
v_add_u32 v23, s29, v21
v_xor_b32 v23, v22, v23
v_lshlrev_b32 v23, 4, v23
v_add_u32 v16, v24, v23
s_add_u32 m0, s23, 6144
s_add_u32 s30, s22, 5120
buffer_load_dwordx4 v16, s[8:11], s30 offen lds
v_add_u32 v20, 128, v2
v_mul_u32_u24 v21, 205, v20
v_lshrrev_b32 v21, 14, v21
v_mul_u32_u24 v22, 80, v21
v_sub_u32 v22, v20, v22
v_mul_u32_u24 v24, 1280, v21
s_add_u32 s29, s21, 0
v_add_u32 v23, s29, v21
v_xor_b32 v23, v22, v23
v_lshlrev_b32 v23, 4, v23
v_add_u32 v12, v24, v23
s_add_u32 m0, s23, 2048
s_add_u32 s30, s22, 0
buffer_load_dwordx4 v12, s[8:11], s30 offen lds
s_add_u32 s29, s21, 4
v_add_u32 v23, s29, v21
v_xor_b32 v23, v22, v23
v_lshlrev_b32 v23, 4, v23
v_add_u32_e64 v17, v24, v23
s_add_u32 m0, s23, 7168
s_add_u32 s30, s22, 5120
buffer_load_dwordx4 v17, s[8:11], s30 offen lds
v_add_u32 v20, 192, v2
v_mul_u32_u24 v21, 205, v20
v_lshrrev_b32 v21, 14, v21
v_mul_u32_u24 v22, 80, v21
v_sub_u32 v22, v20, v22
v_mul_u32_u24 v24, 1280, v21
s_add_u32 s29, s21, 0
v_add_u32 v23, s29, v21
v_xor_b32 v23, v22, v23
v_lshlrev_b32 v23, 4, v23
v_add_u32 v13, v24, v23
s_add_u32 m0, s23, 3072
s_add_u32 s30, s22, 0
buffer_load_dwordx4 v13, s[8:11], s30 offen lds
s_add_u32 s29, s21, 4
v_add_u32 v23, s29, v21
v_xor_b32 v23, v22, v23
v_lshlrev_b32 v23, 4, v23
v_add_u32_e64 v18, v24, v23
s_add_u32 m0, s23, 8192
s_add_u32 s30, s22, 5120
buffer_load_dwordx4 v18, s[8:11], s30 offen lds
v_add_u32 v20, 256, v2
v_mul_u32_u24 v21, 205, v20
v_lshrrev_b32 v21, 14, v21
v_mul_u32_u24 v22, 80, v21
v_sub_u32 v22, v20, v22
v_mul_u32_u24 v24, 1280, v21
s_add_u32 s29, s21, 0
v_add_u32 v23, s29, v21
v_xor_b32 v23, v22, v23
v_lshlrev_b32 v23, 4, v23
v_add_u32 v14, v24, v23
s_add_u32 m0, s23, 4096
s_add_u32 s30, s22, 0
buffer_load_dwordx4 v14, s[8:11], s30 offen lds
s_add_u32 s29, s21, 4
v_add_u32 v23, s29, v21
v_xor_b32 v23, v22, v23
v_lshlrev_b32 v23, 4, v23
v_add_u32 v19, v24, v23
s_add_u32 m0, s23, 9216
s_add_u32 s30, s22, 5120
buffer_load_dwordx4 v19, s[8:11], s30 offen lds
s_branch L_iss2
L_iss_7_wgu:
s_cmp_ge_u32 s2, 54
s_cselect_b32 s17, 1, 0
s_cselect_b32 s6, s58, s56
s_cselect_b32 s7, s59, s57
s_mul_i32 s18, s17, 54
s_sub_u32 s18, s2, s18
s_lshr_b32 s19, s18, 1
s_and_b32 s18, s18, 1
s_mov_b32 s8, s6
s_mov_b32 s9, s7
s_mov_b32 s10, 2211840
s_mov_b32 s11, 0x20000
v_lshrrev_b32 v20, 3, v2
v_and_b32 v21, 7, v2
v_bfe_u32 v22, v20, 1, 2
v_lshlrev_b32 v22, 1, v22
v_xor_b32 v21, v21, v22
v_lshlrev_b32 v21, 4, v21
v_mul_u32_u24 v20, 3456, v20
v_add_u32 v10, v20, v21
s_mul_i32 s20, s18, 1105920
s_lshl_b32 s21, s19, 7
s_add_u32 s20, s20, s21
s_mul_i32 s21, s16, 276480
s_add_u32 s20, s20, s21
s_mul_i32 s23, s16, 10240
s_add_u32 s23, s23, s32
s_add_u32 m0, s23, 0
s_nop 0
buffer_load_dwordx4 v10, s[8:11], s20 offen lds
s_add_u32 m0, s23, 1024
s_add_u32 s20, s20, 27648
buffer_load_dwordx4 v10, s[8:11], s20 offen lds
s_add_u32 m0, s23, 2048
s_add_u32 s20, s20, 27648
buffer_load_dwordx4 v10, s[8:11], s20 offen lds
s_add_u32 m0, s23, 3072
s_add_u32 s20, s20, 27648
buffer_load_dwordx4 v10, s[8:11], s20 offen lds
s_add_u32 m0, s23, 4096
s_add_u32 s20, s20, 27648
buffer_load_dwordx4 v10, s[8:11], s20 offen lds
s_add_u32 m0, s23, 5120
s_add_u32 s20, s20, 27648
buffer_load_dwordx4 v10, s[8:11], s20 offen lds
s_add_u32 m0, s23, 6144
s_add_u32 s20, s20, 27648
buffer_load_dwordx4 v10, s[8:11], s20 offen lds
s_add_u32 m0, s23, 7168
s_add_u32 s20, s20, 27648
buffer_load_dwordx4 v10, s[8:11], s20 offen lds
s_add_u32 m0, s23, 8192
s_add_u32 s20, s20, 27648
buffer_load_dwordx4 v10, s[8:11], s20 offen lds
s_add_u32 m0, s23, 9216
s_add_u32 s20, s20, 27648
buffer_load_dwordx4 v10, s[8:11], s20 offen lds
s_branch L_iss2
L_iss_7_wq:
s_mov_b32 s8, s50
s_mov_b32 s9, s51
s_mov_b32 s10, 2457600
s_mov_b32 s11, 0x20000
s_sub_u32 s17, s2, 108
s_and_b32 s18, s17, 7
s_lshr_b32 s17, s17, 3
s_mul_i32 s19, s18, 160
s_and_b32 s26, s19, 0xffffff80
v_lshrrev_b32 v20, 4, v2
v_mul_u32_u24 v20, 3840, v20
v_and_b32 v21, 15, v2
v_lshlrev_b32 v21, 4, v21
v_add_u32 v10, v20, v21
s_mul_i32 s20, s17, 122880
s_add_u32 s20, s20, s26
s_mul_i32 s21, s16, 6
s_add_u32 s22, s21, 0
s_lshr_b32 s23, s22, 3
s_and_b32 s24, s22, 7
s_mul_i32 s24, s24, 15360
s_mul_i32 s23, s23, 1280
s_add_u32 s24, s24, s23
s_lshl_b32 m0, s22, 10
s_add_u32 s24, s24, s20
buffer_load_dwordx4 v10, s[8:11], s24 offen lds
s_add_u32 s22, s21, 1
s_lshr_b32 s23, s22, 3
s_and_b32 s24, s22, 7
s_mul_i32 s24, s24, 15360
s_mul_i32 s23, s23, 1280
s_add_u32 s24, s24, s23
s_lshl_b32 m0, s22, 10
s_add_u32 s24, s24, s20
buffer_load_dwordx4 v10, s[8:11], s24 offen lds
s_add_u32 s22, s21, 2
s_lshr_b32 s23, s22, 3
s_and_b32 s24, s22, 7
s_mul_i32 s24, s24, 15360
s_mul_i32 s23, s23, 1280
s_add_u32 s24, s24, s23
s_lshl_b32 m0, s22, 10
s_add_u32 s24, s24, s20
buffer_load_dwordx4 v10, s[8:11], s24 offen lds
s_add_u32 s22, s21, 3
s_lshr_b32 s23, s22, 3
s_and_b32 s24, s22, 7
s_mul_i32 s24, s24, 15360
s_mul_i32 s23, s23, 1280
s_add_u32 s24, s24, s23
s_lshl_b32 m0, s22, 10
s_add_u32 s24, s24, s20
buffer_load_dwordx4 v10, s[8:11], s24 offen lds
s_add_u32 s22, s21, 4
s_lshr_b32 s23, s22, 3
s_and_b32 s24, s22, 7
s_mul_i32 s24, s24, 15360
s_mul_i32 s23, s23, 1280
s_add_u32 s24, s24, s23
s_lshl_b32 m0, s22, 10
s_add_u32 s24, s24, s20
buffer_load_dwordx4 v10, s[8:11], s24 offen lds
s_add_u32 s22, s21, 5
s_lshr_b32 s23, s22, 3
s_and_b32 s24, s22, 7
s_mul_i32 s24, s24, 15360
s_mul_i32 s23, s23, 1280
s_add_u32 s24, s24, s23
s_lshl_b32 m0, s22, 10
s_add_u32 s24, s24, s20
buffer_load_dwordx4 v10, s[8:11], s24 offen lds
s_branch L_iss2
L_iss2:
v_mov_b32 v201, 64
buffer_load_dwordx2 v[202:203], v201, s[40:43], 0 offen sc1
s_cmp_eq_u32 s35, 0xffff
s_cbranch_scc1 L_wA_8
s_waitcnt vmcnt(11)
s_branch L_wA2_9
L_wA_8:
s_waitcnt vmcnt(1)
L_wA2_9:
s_barrier
s_cmp_eq_u32 s34, 0xffff
s_cbranch_scc1 L_prc1
s_mov_b32 s2, s34
s_mov_b32 s32, 0
s_cmp_lt_u32 s2, 108
s_cbranch_scc1 L_prc_10_wgu
s_cmp_lt_u32 s2, 268
s_cbranch_scc1 L_prc_10_wq
s_cmp_lt_u32 s2, 332
s_cbranch_scc1 L_prc_10_x
s_cmp_lt_u32 s2, 386
s_cbranch_scc1 L_prc_10_wd
s_sub_u32 s17, s2, 386
s_mul_i32 s24, s17, 5120
s_add_u32 s24, s24, 2621440
s_add_u32 s27, s24, 4096
v_lshlrev_b32 v20, 2, v6
v_add_u32 v20, v20, v5
v_and_b32 v21, 7, v20
v_mul_u32_u24 v20, 1280, v20
v_lshlrev_b32 v22, 3, v4
v_add3_u32 v20, v20, v22, s32
v_xor_b32 v23, 0, v21
v_lshlrev_b32 v23, 5, v23
v_add_u32 v30, v20, v23
v_xor_b32 v23, 1, v21
v_lshlrev_b32 v23, 5, v23
v_add_u32 v31, v20, v23
v_xor_b32 v23, 2, v21
v_lshlrev_b32 v23, 5, v23
v_add_u32 v32, v20, v23
v_xor_b32 v23, 3, v21
v_lshlrev_b32 v23, 5, v23
v_add_u32 v33, v20, v23
v_xor_b32 v23, 4, v21
v_lshlrev_b32 v23, 5, v23
v_add_u32 v34, v20, v23
v_xor_b32 v23, 5, v21
v_lshlrev_b32 v23, 5, v23
v_add_u32 v35, v20, v23
v_xor_b32 v23, 6, v21
v_lshlrev_b32 v23, 5, v23
v_add_u32 v36, v20, v23
v_xor_b32 v23, 7, v21
v_lshlrev_b32 v23, 5, v23
v_add_u32 v37, v20, v23
s_cmp_lg_u32 s16, 0
s_cbranch_scc1 L_w640_12
ds_read_b64_tr_b16 v[40:41], v30 offset:0
ds_read_b64_tr_b16 v[42:43], v30 offset:20480
ds_read_b64_tr_b16 v[44:45], v31 offset:0
ds_read_b64_tr_b16 v[46:47], v31 offset:20480
ds_read_b64_tr_b16 v[48:49], v32 offset:0
ds_read_b64_tr_b16 v[50:51], v32 offset:20480
ds_read_b64_tr_b16 v[52:53], v33 offset:0
ds_read_b64_tr_b16 v[54:55], v33 offset:20480
ds_read_b64_tr_b16 v[56:57], v34 offset:0
ds_read_b64_tr_b16 v[58:59], v34 offset:20480
ds_read_b64_tr_b16 v[60:61], v35 offset:0
ds_read_b64_tr_b16 v[62:63], v35 offset:20480
ds_read_b64_tr_b16 v[64:65], v36 offset:0
ds_read_b64_tr_b16 v[66:67], v36 offset:20480
ds_read_b64_tr_b16 v[68:69], v37 offset:0
ds_read_b64_tr_b16 v[70:71], v37 offset:20480
ds_read_b64_tr_b16 v[72:73], v30 offset:256
ds_read_b64_tr_b16 v[74:75], v30 offset:20736
ds_read_b64_tr_b16 v[76:77], v31 offset:256
ds_read_b64_tr_b16 v[78:79], v31 offset:20736
s_branch L_wo_11
L_w640_12:
s_cmp_lg_u32 s16, 1
s_cbranch_scc1 L_w640_13
ds_read_b64_tr_b16 v[40:41], v32 offset:256
ds_read_b64_tr_b16 v[42:43], v32 offset:20736
ds_read_b64_tr_b16 v[44:45], v33 offset:256
ds_read_b64_tr_b16 v[46:47], v33 offset:20736
ds_read_b64_tr_b16 v[48:49], v34 offset:256
ds_read_b64_tr_b16 v[50:51], v34 offset:20736
ds_read_b64_tr_b16 v[52:53], v35 offset:256
ds_read_b64_tr_b16 v[54:55], v35 offset:20736
ds_read_b64_tr_b16 v[56:57], v36 offset:256
ds_read_b64_tr_b16 v[58:59], v36 offset:20736
ds_read_b64_tr_b16 v[60:61], v37 offset:256
ds_read_b64_tr_b16 v[62:63], v37 offset:20736
ds_read_b64_tr_b16 v[64:65], v30 offset:512
ds_read_b64_tr_b16 v[66:67], v30 offset:20992
ds_read_b64_tr_b16 v[68:69], v31 offset:512
ds_read_b64_tr_b16 v[70:71], v31 offset:20992
ds_read_b64_tr_b16 v[72:73], v32 offset:512
ds_read_b64_tr_b16 v[74:75], v32 offset:20992
ds_read_b64_tr_b16 v[76:77], v33 offset:512
ds_read_b64_tr_b16 v[78:79], v33 offset:20992
s_branch L_wo_11
L_w640_13:
s_cmp_lg_u32 s16, 2
s_cbranch_scc1 L_w640_14
ds_read_b64_tr_b16 v[40:41], v34 offset:512
ds_read_b64_tr_b16 v[42:43], v34 offset:20992
ds_read_b64_tr_b16 v[44:45], v35 offset:512
ds_read_b64_tr_b16 v[46:47], v35 offset:20992
ds_read_b64_tr_b16 v[48:49], v36 offset:512
ds_read_b64_tr_b16 v[50:51], v36 offset:20992
ds_read_b64_tr_b16 v[52:53], v37 offset:512
ds_read_b64_tr_b16 v[54:55], v37 offset:20992
ds_read_b64_tr_b16 v[56:57], v30 offset:768
ds_read_b64_tr_b16 v[58:59], v30 offset:21248
ds_read_b64_tr_b16 v[60:61], v31 offset:768
ds_read_b64_tr_b16 v[62:63], v31 offset:21248
ds_read_b64_tr_b16 v[64:65], v32 offset:768
ds_read_b64_tr_b16 v[66:67], v32 offset:21248
ds_read_b64_tr_b16 v[68:69], v33 offset:768
ds_read_b64_tr_b16 v[70:71], v33 offset:21248
ds_read_b64_tr_b16 v[72:73], v34 offset:768
ds_read_b64_tr_b16 v[74:75], v34 offset:21248
ds_read_b64_tr_b16 v[76:77], v35 offset:768
ds_read_b64_tr_b16 v[78:79], v35 offset:21248
s_branch L_wo_11
L_w640_14:
ds_read_b64_tr_b16 v[40:41], v36 offset:768
ds_read_b64_tr_b16 v[42:43], v36 offset:21248
ds_read_b64_tr_b16 v[44:45], v37 offset:768
ds_read_b64_tr_b16 v[46:47], v37 offset:21248
ds_read_b64_tr_b16 v[48:49], v30 offset:1024
ds_read_b64_tr_b16 v[50:51], v30 offset:21504
ds_read_b64_tr_b16 v[52:53], v31 offset:1024
ds_read_b64_tr_b16 v[54:55], v31 offset:21504
ds_read_b64_tr_b16 v[56:57], v32 offset:1024
ds_read_b64_tr_b16 v[58:59], v32 offset:21504
ds_read_b64_tr_b16 v[60:61], v33 offset:1024
ds_read_b64_tr_b16 v[62:63], v33 offset:21504
ds_read_b64_tr_b16 v[64:65], v34 offset:1024
ds_read_b64_tr_b16 v[66:67], v34 offset:21504
ds_read_b64_tr_b16 v[68:69], v35 offset:1024
ds_read_b64_tr_b16 v[70:71], v35 offset:21504
ds_read_b64_tr_b16 v[72:73], v36 offset:1024
ds_read_b64_tr_b16 v[74:75], v36 offset:21504
ds_read_b64_tr_b16 v[76:77], v37 offset:1024
ds_read_b64_tr_b16 v[78:79], v37 offset:21504
s_branch L_wo_11
L_wo_11:
s_mul_i32 s25, s16, 204800
s_add_u32 s24, s24, s25
s_add_u32 s27, s27, s25
s_waitcnt lgkmcnt(0)
s_add_u32 s25, s24, 0
s_nop 0
buffer_store_dwordx4 v[40:43], v3, s[44:47], s25 offen sc1
s_add_u32 s25, s24, 1024
buffer_store_dwordx4 v[44:47], v3, s[44:47], s25 offen sc1
s_add_u32 s25, s24, 2048
buffer_store_dwordx4 v[48:51], v3, s[44:47], s25 offen sc1
s_add_u32 s25, s24, 3072
buffer_store_dwordx4 v[52:55], v3, s[44:47], s25 offen sc1
s_add_u32 s25, s27, 0
s_nop 0
buffer_store_dwordx4 v[56:59], v3, s[44:47], s25 offen sc1
s_add_u32 s25, s24, 102400
buffer_store_dwordx4 v[60:63], v3, s[44:47], s25 offen sc1
s_add_u32 s25, s24, 103424
buffer_store_dwordx4 v[64:67], v3, s[44:47], s25 offen sc1
s_add_u32 s25, s24, 104448
buffer_store_dwordx4 v[68:71], v3, s[44:47], s25 offen sc1
s_add_u32 s25, s24, 105472
buffer_store_dwordx4 v[72:75], v3, s[44:47], s25 offen sc1
s_add_u32 s25, s27, 102400
buffer_store_dwordx4 v[76:79], v3, s[44:47], s25 offen sc1
s_branch L_prc1
L_prc_10_wd:
s_sub_u32 s17, s2, 332
s_cmp_ge_u32 s17, 27
s_cselect_b32 s26, 1, 0
s_mul_i32 s27, s26, 27
s_sub_u32 s27, s17, s27
s_mul_i32 s28, s27, 171
s_lshr_b32 s28, s28, 9
s_mul_i32 s29, s28, 3
s_sub_u32 s29, s27, s29
s_mul_i32 s28, s28, 30720
s_add_u32 s28, s28, 8028160
s_mul_i32 s24, s26, 14
s_mul_i32 s27, s29, 5
s_add_u32 s24, s24, s27
s_lshl_b32 s24, s24, 10
s_add_u32 s24, s24, s28
s_add_u32 s27, s24, 4096
s_add_u32 s25, s26, 28
s_lshl_b32 s25, s25, 10
s_add_u32 s25, s25, s28
s_cmp_eq_u32 s29, 2
s_cselect_b32 s27, s25, s27
v_lshlrev_b32 v20, 2, v6
v_add_u32 v20, v20, v5
v_and_b32 v21, 7, v20
v_mul_u32_u24 v20, 1280, v20
v_lshlrev_b32 v22, 3, v4
v_add3_u32 v20, v20, v22, s32
v_xor_b32 v23, 0, v21
v_lshlrev_b32 v23, 5, v23
v_add_u32 v30, v20, v23
v_xor_b32 v23, 1, v21
v_lshlrev_b32 v23, 5, v23
v_add_u32 v31, v20, v23
v_xor_b32 v23, 2, v21
v_lshlrev_b32 v23, 5, v23
v_add_u32 v32, v20, v23
v_xor_b32 v23, 3, v21
v_lshlrev_b32 v23, 5, v23
v_add_u32 v33, v20, v23
v_xor_b32 v23, 4, v21
v_lshlrev_b32 v23, 5, v23
v_add_u32 v34, v20, v23
v_xor_b32 v23, 5, v21
v_lshlrev_b32 v23, 5, v23
v_add_u32 v35, v20, v23
v_xor_b32 v23, 6, v21
v_lshlrev_b32 v23, 5, v23
v_add_u32 v36, v20, v23
v_xor_b32 v23, 7, v21
v_lshlrev_b32 v23, 5, v23
v_add_u32 v37, v20, v23
s_cmp_lg_u32 s16, 0
s_cbranch_scc1 L_w640_17
ds_read_b64_tr_b16 v[40:41], v30 offset:0
ds_read_b64_tr_b16 v[42:43], v30 offset:20480
ds_read_b64_tr_b16 v[44:45], v31 offset:0
ds_read_b64_tr_b16 v[46:47], v31 offset:20480
ds_read_b64_tr_b16 v[48:49], v32 offset:0
ds_read_b64_tr_b16 v[50:51], v32 offset:20480
ds_read_b64_tr_b16 v[52:53], v33 offset:0
ds_read_b64_tr_b16 v[54:55], v33 offset:20480
ds_read_b64_tr_b16 v[56:57], v34 offset:0
ds_read_b64_tr_b16 v[58:59], v34 offset:20480
ds_read_b64_tr_b16 v[60:61], v35 offset:0
ds_read_b64_tr_b16 v[62:63], v35 offset:20480
ds_read_b64_tr_b16 v[64:65], v36 offset:0
ds_read_b64_tr_b16 v[66:67], v36 offset:20480
ds_read_b64_tr_b16 v[68:69], v37 offset:0
ds_read_b64_tr_b16 v[70:71], v37 offset:20480
ds_read_b64_tr_b16 v[72:73], v30 offset:256
ds_read_b64_tr_b16 v[74:75], v30 offset:20736
ds_read_b64_tr_b16 v[76:77], v31 offset:256
ds_read_b64_tr_b16 v[78:79], v31 offset:20736
s_branch L_wd_16
L_w640_17:
s_cmp_lg_u32 s16, 1
s_cbranch_scc1 L_w640_18
ds_read_b64_tr_b16 v[40:41], v32 offset:256
ds_read_b64_tr_b16 v[42:43], v32 offset:20736
ds_read_b64_tr_b16 v[44:45], v33 offset:256
ds_read_b64_tr_b16 v[46:47], v33 offset:20736
ds_read_b64_tr_b16 v[48:49], v34 offset:256
ds_read_b64_tr_b16 v[50:51], v34 offset:20736
ds_read_b64_tr_b16 v[52:53], v35 offset:256
ds_read_b64_tr_b16 v[54:55], v35 offset:20736
ds_read_b64_tr_b16 v[56:57], v36 offset:256
ds_read_b64_tr_b16 v[58:59], v36 offset:20736
ds_read_b64_tr_b16 v[60:61], v37 offset:256
ds_read_b64_tr_b16 v[62:63], v37 offset:20736
ds_read_b64_tr_b16 v[64:65], v30 offset:512
ds_read_b64_tr_b16 v[66:67], v30 offset:20992
ds_read_b64_tr_b16 v[68:69], v31 offset:512
ds_read_b64_tr_b16 v[70:71], v31 offset:20992
ds_read_b64_tr_b16 v[72:73], v32 offset:512
ds_read_b64_tr_b16 v[74:75], v32 offset:20992
ds_read_b64_tr_b16 v[76:77], v33 offset:512
ds_read_b64_tr_b16 v[78:79], v33 offset:20992
s_branch L_wd_16
L_w640_18:
s_cmp_lg_u32 s16, 2
s_cbranch_scc1 L_w640_19
ds_read_b64_tr_b16 v[40:41], v34 offset:512
ds_read_b64_tr_b16 v[42:43], v34 offset:20992
ds_read_b64_tr_b16 v[44:45], v35 offset:512
ds_read_b64_tr_b16 v[46:47], v35 offset:20992
ds_read_b64_tr_b16 v[48:49], v36 offset:512
ds_read_b64_tr_b16 v[50:51], v36 offset:20992
ds_read_b64_tr_b16 v[52:53], v37 offset:512
ds_read_b64_tr_b16 v[54:55], v37 offset:20992
ds_read_b64_tr_b16 v[56:57], v30 offset:768
ds_read_b64_tr_b16 v[58:59], v30 offset:21248
ds_read_b64_tr_b16 v[60:61], v31 offset:768
ds_read_b64_tr_b16 v[62:63], v31 offset:21248
ds_read_b64_tr_b16 v[64:65], v32 offset:768
ds_read_b64_tr_b16 v[66:67], v32 offset:21248
ds_read_b64_tr_b16 v[68:69], v33 offset:768
ds_read_b64_tr_b16 v[70:71], v33 offset:21248
ds_read_b64_tr_b16 v[72:73], v34 offset:768
ds_read_b64_tr_b16 v[74:75], v34 offset:21248
ds_read_b64_tr_b16 v[76:77], v35 offset:768
ds_read_b64_tr_b16 v[78:79], v35 offset:21248
s_branch L_wd_16
L_w640_19:
ds_read_b64_tr_b16 v[40:41], v36 offset:768
ds_read_b64_tr_b16 v[42:43], v36 offset:21248
ds_read_b64_tr_b16 v[44:45], v37 offset:768
ds_read_b64_tr_b16 v[46:47], v37 offset:21248
ds_read_b64_tr_b16 v[48:49], v30 offset:1024
ds_read_b64_tr_b16 v[50:51], v30 offset:21504
ds_read_b64_tr_b16 v[52:53], v31 offset:1024
ds_read_b64_tr_b16 v[54:55], v31 offset:21504
ds_read_b64_tr_b16 v[56:57], v32 offset:1024
ds_read_b64_tr_b16 v[58:59], v32 offset:21504
ds_read_b64_tr_b16 v[60:61], v33 offset:1024
ds_read_b64_tr_b16 v[62:63], v33 offset:21504
ds_read_b64_tr_b16 v[64:65], v34 offset:1024
ds_read_b64_tr_b16 v[66:67], v34 offset:21504
ds_read_b64_tr_b16 v[68:69], v35 offset:1024
ds_read_b64_tr_b16 v[70:71], v35 offset:21504
ds_read_b64_tr_b16 v[72:73], v36 offset:1024
ds_read_b64_tr_b16 v[74:75], v36 offset:21504
ds_read_b64_tr_b16 v[76:77], v37 offset:1024
ds_read_b64_tr_b16 v[78:79], v37 offset:21504
s_branch L_wd_16
L_wd_16:
s_mul_i32 s25, s16, 552960
s_add_u32 s24, s24, s25
s_add_u32 s27, s27, s25
s_waitcnt lgkmcnt(0)
s_add_u32 s25, s24, 0
buffer_store_dwordx4 v[40:43], v3, s[44:47], s25 offen sc1
s_add_u32 s25, s24, 1024
buffer_store_dwordx4 v[44:47], v3, s[44:47], s25 offen sc1
s_add_u32 s25, s24, 2048
buffer_store_dwordx4 v[48:51], v3, s[44:47], s25 offen sc1
s_add_u32 s25, s24, 3072
buffer_store_dwordx4 v[52:55], v3, s[44:47], s25 offen sc1
s_add_u32 s25, s27, 0
s_nop 0
buffer_store_dwordx4 v[56:59], v3, s[44:47], s25 offen sc1
s_add_u32 s25, s24, 276480
buffer_store_dwordx4 v[60:63], v3, s[44:47], s25 offen sc1
s_add_u32 s25, s24, 277504
buffer_store_dwordx4 v[64:67], v3, s[44:47], s25 offen sc1
s_add_u32 s25, s24, 278528
buffer_store_dwordx4 v[68:71], v3, s[44:47], s25 offen sc1
s_add_u32 s25, s24, 279552
buffer_store_dwordx4 v[72:75], v3, s[44:47], s25 offen sc1
s_add_u32 s25, s27, 276480
buffer_store_dwordx4 v[76:79], v3, s[44:47], s25 offen sc1
s_branch L_prc1
L_prc_10_wgu:
s_cmp_ge_u32 s2, 54
s_cselect_b32 s17, 1, 0
s_mul_i32 s18, s17, 54
s_sub_u32 s18, s2, s18
s_lshr_b32 s19, s18, 1
s_and_b32 s18, s18, 1
v_lshlrev_b32 v20, 2, v6
v_add_u32 v20, v20, v5
v_bfe_u32 v21, v20, 1, 2
v_xor_b32 v21, s16, v21
v_lshlrev_b32 v21, 5, v21
v_lshlrev_b32 v20, 7, v20
v_add_u32 v20, v20, v21
v_lshlrev_b32 v22, 3, v4
v_add3_u32 v30, v20, v22, s32
ds_read_b64_tr_b16 v[40:41], v30 offset:0
ds_read_b64_tr_b16 v[42:43], v30 offset:2048
ds_read_b64_tr_b16 v[44:45], v30 offset:4096
ds_read_b64_tr_b16 v[46:47], v30 offset:6144
ds_read_b64_tr_b16 v[48:49], v30 offset:8192
ds_read_b64_tr_b16 v[50:51], v30 offset:10240
ds_read_b64_tr_b16 v[52:53], v30 offset:12288
ds_read_b64_tr_b16 v[54:55], v30 offset:14336
ds_read_b64_tr_b16 v[56:57], v30 offset:16384
ds_read_b64_tr_b16 v[58:59], v30 offset:18432
ds_read_b64_tr_b16 v[60:61], v30 offset:20480
ds_read_b64_tr_b16 v[62:63], v30 offset:22528
ds_read_b64_tr_b16 v[64:65], v30 offset:24576
ds_read_b64_tr_b16 v[66:67], v30 offset:26624
ds_read_b64_tr_b16 v[68:69], v30 offset:28672
ds_read_b64_tr_b16 v[70:71], v30 offset:30720
ds_read_b64_tr_b16 v[72:73], v30 offset:32768
ds_read_b64_tr_b16 v[74:75], v30 offset:34816
ds_read_b64_tr_b16 v[76:77], v30 offset:36864
ds_read_b64_tr_b16 v[78:79], v30 offset:38912
s_lshl_b32 s24, s19, 2
s_add_u32 s24, s24, s16
s_mul_i32 s25, s24, 147
s_lshr_b32 s25, s25, 10
s_mul_i32 s26, s25, 7
s_sub_u32 s26, s24, s26
s_mul_i32 s27, s25, 20
s_mul_i32 s28, s18, 10
s_add_u32 s27, s27, s28
s_mul_i32 s27, s27, 7
s_add_u32 s27, s27, s26
s_lshl_b32 s27, s27, 11
s_lshl_b32 s28, s17, 10
s_add_u32 s27, s27, s28
s_add_u32 s27, s27, 3440640
s_mul_i32 s28, s18, 112
s_add_u32 s28, s28, s24
s_lshl_b32 s28, s28, 1
s_add_u32 s28, s28, s17
s_lshl_b32 s28, s28, 6
s_add_u32 s28, s28, 10240000
v_mov_b32 v80, 0x3f803f80
v_mov_b32 v81, 0x3f803f80
v_mov_b32 v82, 0x3f803f80
v_mov_b32 v83, 0x3f803f80
s_waitcnt lgkmcnt(0)
buffer_store_dwordx4 v[40:43], v3, s[44:47], s27 offen sc1
v_mfma_f32_16x16x32_bf16 v[84:87], v[40:43], v[80:83], 0
s_add_u32 s27, s27, 14336
buffer_store_dwordx4 v[44:47], v3, s[44:47], s27 offen sc1
v_mfma_f32_16x16x32_bf16 v[84:87], v[44:47], v[80:83], v[84:87]
s_add_u32 s27, s27, 14336
buffer_store_dwordx4 v[48:51], v3, s[44:47], s27 offen sc1
v_mfma_f32_16x16x32_bf16 v[84:87], v[48:51], v[80:83], v[84:87]
s_add_u32 s27, s27, 14336
buffer_store_dwordx4 v[52:55], v3, s[44:47], s27 offen sc1
v_mfma_f32_16x16x32_bf16 v[84:87], v[52:55], v[80:83], v[84:87]
s_add_u32 s27, s27, 14336
buffer_store_dwordx4 v[56:59], v3, s[44:47], s27 offen sc1
v_mfma_f32_16x16x32_bf16 v[84:87], v[56:59], v[80:83], v[84:87]
s_add_u32 s27, s27, 14336
buffer_store_dwordx4 v[60:63], v3, s[44:47], s27 offen sc1
v_mfma_f32_16x16x32_bf16 v[84:87], v[60:63], v[80:83], v[84:87]
s_add_u32 s27, s27, 14336
buffer_store_dwordx4 v[64:67], v3, s[44:47], s27 offen sc1
v_mfma_f32_16x16x32_bf16 v[84:87], v[64:67], v[80:83], v[84:87]
s_add_u32 s27, s27, 14336
buffer_store_dwordx4 v[68:71], v3, s[44:47], s27 offen sc1
v_mfma_f32_16x16x32_bf16 v[84:87], v[68:71], v[80:83], v[84:87]
s_add_u32 s27, s27, 14336
buffer_store_dwordx4 v[72:75], v3, s[44:47], s27 offen sc1
v_mfma_f32_16x16x32_bf16 v[84:87], v[72:75], v[80:83], v[84:87]
s_add_u32 s27, s27, 14336
buffer_store_dwordx4 v[76:79], v3, s[44:47], s27 offen sc1
v_mfma_f32_16x16x32_bf16 v[84:87], v[76:79], v[80:83], v[84:87]
v_and_b32 v20, 15, v2
v_lshlrev_b32 v21, 4, v6
v_cmp_eq_u32 vcc, 0, v20
s_nop 7
s_and_saveexec_b64 s[30:31], vcc
buffer_store_dwordx4 v[84:87], v21, s[44:47], s28 offen sc1
s_mov_b64 exec, s[30:31]
s_branch L_prc1
L_prc_10_wq:
s_sub_u32 s17, s2, 108
s_and_b32 s18, s17, 7
s_lshr_b32 s17, s17, 3
s_mul_i32 s19, s18, 160
s_and_b32 s19, s19, 127
v_lshlrev_b32 v20, 2, v6
v_add_u32 v20, v20, v5
v_lshlrev_b32 v20, 8, v20
s_and_b32 s21, s16, 1
s_mul_i32 s22, s21, 80
s_add_u32 s22, s22, s19
v_add_u32 v20, s22, v20
s_lshr_b32 s23, s16, 1
s_lshl_b32 s23, s23, 4
s_add_u32 s25, s23, 0
v_add_u32 v21, s25, v4
v_min_u32 v21, 29, v21
v_mul_u32_u24 v22, 52, v21
v_lshrrev_b32 v22, 8, v22
v_mul_u32_u24 v23, 5, v22
v_sub_u32 v23, v21, v23
v_cmp_le_u32 vcc, 3, v22
v_lshlrev_b32 v23, 3, v23
s_nop 0
v_cndmask_b32 v24, 0, 1, vcc
v_mul_u32_u24 v25, 3, v24
v_sub_u32 v25, v22, v25
v_lshlrev_b32 v25, 13, v25
v_mul_u32_u24 v24, 40, v24
v_add3_u32 v23, v23, v24, v25
v_add_u32 v30, v20, v23
ds_read_b64_tr_b16 v[40:41], v30
ds_read_b64_tr_b16 v[42:43], v30 offset:4096
s_add_u32 s25, s23, 4
v_add_u32 v21, s25, v4
v_min_u32 v21, 29, v21
v_mul_u32_u24 v22, 52, v21
v_lshrrev_b32 v22, 8, v22
v_mul_u32_u24 v23, 5, v22
v_sub_u32 v23, v21, v23
v_cmp_le_u32 vcc, 3, v22
v_lshlrev_b32 v23, 3, v23
s_nop 0
v_cndmask_b32 v24, 0, 1, vcc
v_mul_u32_u24 v25, 3, v24
v_sub_u32 v25, v22, v25
v_lshlrev_b32 v25, 13, v25
v_mul_u32_u24 v24, 40, v24
v_add3_u32 v23, v23, v24, v25
v_add_u32 v31, v20, v23
ds_read_b64_tr_b16 v[44:45], v31
ds_read_b64_tr_b16 v[46:47], v31 offset:4096
s_add_u32 s25, s23, 8
v_add_u32 v21, s25, v4
v_min_u32 v21, 29, v21
v_mul_u32_u24 v22, 52, v21
v_lshrrev_b32 v22, 8, v22
v_mul_u32_u24 v23, 5, v22
v_sub_u32 v23, v21, v23
v_cmp_le_u32 vcc, 3, v22
v_lshlrev_b32 v23, 3, v23
s_nop 0
v_cndmask_b32 v24, 0, 1, vcc
v_mul_u32_u24 v25, 3, v24
v_sub_u32 v25, v22, v25
v_lshlrev_b32 v25, 13, v25
v_mul_u32_u24 v24, 40, v24
v_add3_u32 v23, v23, v24, v25
v_add_u32 v32, v20, v23
ds_read_b64_tr_b16 v[48:49], v32
ds_read_b64_tr_b16 v[50:51], v32 offset:4096
s_add_u32 s25, s23, 12
v_add_u32 v21, s25, v4
v_min_u32 v21, 29, v21
v_mul_u32_u24 v22, 52, v21
v_lshrrev_b32 v22, 8, v22
v_mul_u32_u24 v23, 5, v22
v_sub_u32 v23, v21, v23
v_cmp_le_u32 vcc, 3, v22
v_lshlrev_b32 v23, 3, v23
s_nop 0
v_cndmask_b32 v24, 0, 1, vcc
v_mul_u32_u24 v25, 3, v24
v_sub_u32 v25, v22, v25
v_lshlrev_b32 v25, 13, v25
v_mul_u32_u24 v24, 40, v24
v_add3_u32 v23, v23, v24, v25
v_add_u32 v33, v20, v23
ds_read_b64_tr_b16 v[52:53], v33
ds_read_b64_tr_b16 v[54:55], v33 offset:4096
s_lshl_b32 s24, s18, 1
s_add_u32 s24, s24, s21
s_mul_i32 s24, s24, 163840
s_lshl_b32 s25, s17, 11
s_add_u32 s24, s24, s25
s_lshr_b32 s25, s16, 1
s_mul_i32 s25, s25, 81920
s_add_u32 s24, s24, s25
s_add_u32 s24, s24, 0
s_waitcnt lgkmcnt(0)
s_add_u32 s25, s24, 0
buffer_store_dwordx4 v[40:43], v3, s[44:47], s25 offen sc1
s_add_u32 s25, s24, 1024
buffer_store_dwordx4 v[44:47], v3, s[44:47], s25 offen sc1
s_add_u32 s25, s24, 40960
buffer_store_dwordx4 v[48:51], v3, s[44:47], s25 offen sc1
s_add_u32 s25, s24, 41984
buffer_store_dwordx4 v[52:55], v3, s[44:47], s25 offen sc1
s_branch L_prc1
L_prc_10_x:
s_sub_u32 s17, s2, 268
v_and_b32 v20, 15, v2
v_mul_u32_u24 v21, 1280, v20
v_and_b32 v22, 1, v6
v_lshlrev_b32 v22, 3, v22
v_add_u32 v21, v21, v22
s_lshr_b32 s21, s16, 1
s_mul_i32 s21, s21, 20480
s_and_b32 s26, s16, 1
v_add_u32 v21, s21, v21
v_lshrrev_b32 v22, 1, v6
v_add_u32 v23, 0, v22
v_xor_b32 v23, v23, v20
v_lshlrev_b32 v23, 4, v23
v_add_u32 v30, v21, v23
v_add_u32 v23, 2, v22
v_xor_b32 v23, v23, v20
v_lshlrev_b32 v23, 4, v23
v_add_u32 v31, v21, v23
v_add_u32 v23, 4, v22
v_xor_b32 v23, v23, v20
v_lshlrev_b32 v23, 4, v23
v_add_u32 v32, v21, v23
v_add_u32 v23, 6, v22
v_xor_b32 v23, v23, v20
v_lshlrev_b32 v23, 4, v23
v_add_u32 v33, v21, v23
v_add_u32 v23, 8, v22
v_xor_b32 v23, v23, v20
v_lshlrev_b32 v23, 4, v23
v_add_u32 v34, v21, v23
v_add_u32 v23, 10, v22
v_xor_b32 v23, v23, v20
v_lshlrev_b32 v23, 4, v23
v_add_u32 v35, v21, v23
v_add_u32 v23, 12, v22
v_xor_b32 v23, v23, v20
v_lshlrev_b32 v23, 4, v23
v_add_u32 v36, v21, v23
v_add_u32 v23, 14, v22
v_xor_b32 v23, v23, v20
v_lshlrev_b32 v23, 4, v23
v_add_u32 v37, v21, v23
s_cmp_lg_u32 s26, 0
s_cbranch_scc1 L_xh_22
ds_read_b64 v[40:41], v30 offset:0
ds_read_b64 v[42:43], v31 offset:0
ds_read_b64 v[44:45], v32 offset:0
ds_read_b64 v[46:47], v33 offset:0
ds_read_b64 v[48:49], v34 offset:0
ds_read_b64 v[50:51], v35 offset:0
ds_read_b64 v[52:53], v36 offset:0
ds_read_b64 v[54:55], v37 offset:0
ds_read_b64 v[56:57], v30 offset:256
ds_read_b64 v[58:59], v31 offset:256
ds_read_b64 v[60:61], v32 offset:256
ds_read_b64 v[62:63], v33 offset:256
ds_read_b64 v[64:65], v34 offset:256
ds_read_b64 v[66:67], v35 offset:256
ds_read_b64 v[68:69], v36 offset:256
ds_read_b64 v[70:71], v37 offset:256
ds_read_b64 v[72:73], v30 offset:512
ds_read_b64 v[74:75], v31 offset:512
ds_read_b64 v[76:77], v32 offset:512
ds_read_b64 v[78:79], v33 offset:512
s_branch L_xrd_21
L_xh_22:
ds_read_b64 v[40:41], v34 offset:512
ds_read_b64 v[42:43], v35 offset:512
ds_read_b64 v[44:45], v36 offset:512
ds_read_b64 v[46:47], v37 offset:512
ds_read_b64 v[48:49], v30 offset:768
ds_read_b64 v[50:51], v31 offset:768
ds_read_b64 v[52:53], v32 offset:768
ds_read_b64 v[54:55], v33 offset:768
ds_read_b64 v[56:57], v34 offset:768
ds_read_b64 v[58:59], v35 offset:768
ds_read_b64 v[60:61], v36 offset:768
ds_read_b64 v[62:63], v37 offset:768
ds_read_b64 v[64:65], v30 offset:1024
ds_read_b64 v[66:67], v31 offset:1024
ds_read_b64 v[68:69], v32 offset:1024
ds_read_b64 v[70:71], v33 offset:1024
ds_read_b64 v[72:73], v34 offset:1024
ds_read_b64 v[74:75], v35 offset:1024
ds_read_b64 v[76:77], v36 offset:1024
ds_read_b64 v[78:79], v37 offset:1024
s_branch L_xrd_21
L_xrd_21:
s_lshl_b32 s24, s17, 1
s_lshr_b32 s25, s16, 1
s_add_u32 s24, s24, s25
s_lshr_b32 s25, s24, 3
s_mul_i32 s25, s25, 163840
s_and_b32 s31, s24, 7
s_lshl_b32 s27, s31, 10
s_add_u32 s25, s25, s27
s_mul_i32 s27, s26, 81920
s_add_u32 s25, s25, s27
s_add_u32 s25, s25, 10268672
s_lshl_b32 s28, s24, 10
s_lshl_b32 s27, s26, 3
s_add_u32 s28, s28, s27
s_add_u32 s28, s28, 22589440
s_lshr_b32 s30, s24, 3
s_mul_i32 s30, s30, 20480
s_mul_i32 s29, s26, 10240
s_add_u32 s30, s30, s29
s_add_u32 s30, s30, 22720512
v_mov_b32 v80, 0x3f803f80
s_waitcnt lgkmcnt(0)
s_nop 0
buffer_store_dwordx4 v[40:43], v3, s[44:47], s25 offen sc1
s_add_u32 s25, s25, 8192
v_dot2_f32_bf16 v84, v40, v80, 0
v_dot2_f32_bf16 v85, v40, v40, 0
v_dot2_f32_bf16 v84, v41, v80, v84
v_dot2_f32_bf16 v85, v41, v41, v85
v_dot2_f32_bf16 v84, v42, v80, v84
v_dot2_f32_bf16 v85, v42, v42, v85
v_dot2_f32_bf16 v84, v43, v80, v84
v_dot2_f32_bf16 v85, v43, v43, v85
buffer_store_dwordx4 v[44:47], v3, s[44:47], s25 offen sc1
s_add_u32 s25, s25, 8192
v_dot2_f32_bf16 v84, v44, v80, v84
v_dot2_f32_bf16 v85, v44, v44, v85
v_dot2_f32_bf16 v84, v45, v80, v84
v_dot2_f32_bf16 v85, v45, v45, v85
v_dot2_f32_bf16 v84, v46, v80, v84
v_dot2_f32_bf16 v85, v46, v46, v85
v_dot2_f32_bf16 v84, v47, v80, v84
v_dot2_f32_bf16 v85, v47, v47, v85
buffer_store_dwordx4 v[48:51], v3, s[44:47], s25 offen sc1
s_add_u32 s25, s25, 8192
v_dot2_f32_bf16 v84, v48, v80, v84
v_dot2_f32_bf16 v85, v48, v48, v85
v_dot2_f32_bf16 v84, v49, v80, v84
v_dot2_f32_bf16 v85, v49, v49, v85
v_dot2_f32_bf16 v84, v50, v80, v84
v_dot2_f32_bf16 v85, v50, v50, v85
v_dot2_f32_bf16 v84, v51, v80, v84
v_dot2_f32_bf16 v85, v51, v51, v85
buffer_store_dwordx4 v[52:55], v3, s[44:47], s25 offen sc1
s_add_u32 s25, s25, 8192
v_dot2_f32_bf16 v84, v52, v80, v84
v_dot2_f32_bf16 v85, v52, v52, v85
v_dot2_f32_bf16 v84, v53, v80, v84
v_dot2_f32_bf16 v85, v53, v53, v85
v_dot2_f32_bf16 v84, v54, v80, v84
v_dot2_f32_bf16 v85, v54, v54, v85
v_dot2_f32_bf16 v84, v55, v80, v84
v_dot2_f32_bf16 v85, v55, v55, v85
buffer_store_dwordx4 v[56:59], v3, s[44:47], s25 offen sc1
s_add_u32 s25, s25, 8192
v_dot2_f32_bf16 v84, v56, v80, v84
v_dot2_f32_bf16 v85, v56, v56, v85
v_dot2_f32_bf16 v84, v57, v80, v84
v_dot2_f32_bf16 v85, v57, v57, v85
v_dot2_f32_bf16 v84, v58, v80, v84
v_dot2_f32_bf16 v85, v58, v58, v85
v_dot2_f32_bf16 v84, v59, v80, v84
v_dot2_f32_bf16 v85, v59, v59, v85
buffer_store_dwordx4 v[60:63], v3, s[44:47], s25 offen sc1
s_add_u32 s25, s25, 8192
v_dot2_f32_bf16 v84, v60, v80, v84
v_dot2_f32_bf16 v85, v60, v60, v85
v_dot2_f32_bf16 v84, v61, v80, v84
v_dot2_f32_bf16 v85, v61, v61, v85
v_dot2_f32_bf16 v84, v62, v80, v84
v_dot2_f32_bf16 v85, v62, v62, v85
v_dot2_f32_bf16 v84, v63, v80, v84
v_dot2_f32_bf16 v85, v63, v63, v85
buffer_store_dwordx4 v[64:67], v3, s[44:47], s25 offen sc1
s_add_u32 s25, s25, 8192
v_dot2_f32_bf16 v84, v64, v80, v84
v_dot2_f32_bf16 v85, v64, v64, v85
v_dot2_f32_bf16 v84, v65, v80, v84
v_dot2_f32_bf16 v85, v65, v65, v85
v_dot2_f32_bf16 v84, v66, v80, v84
v_dot2_f32_bf16 v85, v66, v66, v85
v_dot2_f32_bf16 v84, v67, v80, v84
v_dot2_f32_bf16 v85, v67, v67, v85
buffer_store_dwordx4 v[68:71], v3, s[44:47], s25 offen sc1
s_add_u32 s25, s25, 8192
v_dot2_f32_bf16 v84, v68, v80, v84
v_dot2_f32_bf16 v85, v68, v68, v85
v_dot2_f32_bf16 v84, v69, v80, v84
v_dot2_f32_bf16 v85, v69, v69, v85
v_dot2_f32_bf16 v84, v70, v80, v84
v_dot2_f32_bf16 v85, v70, v70, v85
v_dot2_f32_bf16 v84, v71, v80, v84
v_dot2_f32_bf16 v85, v71, v71, v85
buffer_store_dwordx4 v[72:75], v3, s[44:47], s25 offen sc1
s_add_u32 s25, s25, 8192
v_dot2_f32_bf16 v84, v72, v80, v84
v_dot2_f32_bf16 v85, v72, v72, v85
v_dot2_f32_bf16 v84, v73, v80, v84
v_dot2_f32_bf16 v85, v73, v73, v85
v_dot2_f32_bf16 v84, v74, v80, v84
v_dot2_f32_bf16 v85, v74, v74, v85
v_dot2_f32_bf16 v84, v75, v80, v84
v_dot2_f32_bf16 v85, v75, v75, v85
buffer_store_dwordx4 v[76:79], v3, s[44:47], s25 offen sc1
v_dot2_f32_bf16 v84, v76, v80, v84
v_dot2_f32_bf16 v85, v76, v76, v85
v_dot2_f32_bf16 v84, v77, v80, v84
v_dot2_f32_bf16 v85, v77, v77, v85
v_dot2_f32_bf16 v84, v78, v80, v84
v_dot2_f32_bf16 v85, v78, v78, v85
v_dot2_f32_bf16 v84, v79, v80, v84
v_dot2_f32_bf16 v85, v79, v79, v85
s_cmp_lg_u32 s31, 7
s_cbranch_scc1 L_xnohalo_24
buffer_store_dwordx4 v[40:43], v3, s[44:47], s30 offen sc1
s_add_u32 s30, s30, 1024
buffer_store_dwordx4 v[44:47], v3, s[44:47], s30 offen sc1
s_add_u32 s30, s30, 1024
buffer_store_dwordx4 v[48:51], v3, s[44:47], s30 offen sc1
s_add_u32 s30, s30, 1024
buffer_store_dwordx4 v[52:55], v3, s[44:47], s30 offen sc1
s_add_u32 s30, s30, 1024
buffer_store_dwordx4 v[56:59], v3, s[44:47], s30 offen sc1
s_add_u32 s30, s30, 1024
buffer_store_dwordx4 v[60:63], v3, s[44:47], s30 offen sc1
s_add_u32 s30, s30, 1024
buffer_store_dwordx4 v[64:67], v3, s[44:47], s30 offen sc1
s_add_u32 s30, s30, 1024
buffer_store_dwordx4 v[68:71], v3, s[44:47], s30 offen sc1
s_add_u32 s30, s30, 1024
buffer_store_dwordx4 v[72:75], v3, s[44:47], s30 offen sc1
s_add_u32 s30, s30, 1024
buffer_store_dwordx4 v[76:79], v3, s[44:47], s30 offen sc1
s_add_u32 s30, s30, 1024
L_xnohalo_24:
s_nop 2
v_mov_b32 v86, v84
v_mov_b32 v87, v85
s_nop 1
v_permlane16_swap_b32 v84, v86
v_permlane16_swap_b32 v85, v87
s_nop 1
v_add_f32 v84, v84, v86
v_add_f32 v85, v85, v87
v_mov_b32 v86, v84
v_mov_b32 v87, v85
s_nop 1
v_permlane32_swap_b32 v84, v86
v_permlane32_swap_b32 v85, v87
s_nop 1
v_add_f32 v84, v84, v86
v_add_f32 v85, v85, v87
v_cmp_eq_u32 vcc, 0, v6
s_nop 1
v_cndmask_b32 v84, 0, v84, vcc
v_cndmask_b32 v85, 0, v85, vcc
buffer_store_dwordx2 v[84:85], v3, s[44:47], s28 offen sc1
s_cmp_lg_u32 s31, 7
s_cbranch_scc1 L_prc1
s_lshr_b32 s30, s24, 3
s_lshl_b32 s30, s30, 10
s_add_u32 s30, s30, s27
s_add_u32 s30, s30, 23375872
buffer_store_dwordx2 v[84:85], v3, s[44:47], s30 offen sc1
s_branch L_prc1
L_prc1:
s_mov_b32 s7, 0
s_mov_b32 s46, 0
L_B_again:
s_cmp_eq_u32 s35, 0xffff
s_cbranch_scc1 L_prc2x
s_mov_b32 s2, s35
s_mov_b32 s32, 90112
s_cmp_lt_u32 s2, 108
s_cbranch_scc1 L_prc_25_wgu
s_cmp_lt_u32 s2, 268
s_cbranch_scc1 L_prc_25_wq
s_cmp_lt_u32 s2, 332
s_cbranch_scc1 L_prc_25_x
s_cmp_lt_u32 s2, 386
s_cbranch_scc1 L_prc_25_wd
s_sub_u32 s17, s2, 386
s_mul_i32 s24, s17, 5120
s_add_u32 s24, s24, 2621440
s_add_u32 s27, s24, 4096
v_lshlrev_b32 v20, 2, v6
v_add_u32 v20, v20, v5
v_and_b32 v21, 7, v20
v_mul_u32_u24 v20, 1280, v20
v_lshlrev_b32 v22, 3, v4
v_add3_u32 v20, v20, v22, s32
v_xor_b32 v23, 0, v21
v_lshlrev_b32 v23, 5, v23
v_add_u32 v30, v20, v23
v_xor_b32 v23, 1, v21
v_lshlrev_b32 v23, 5, v23
v_add_u32 v31, v20, v23
v_xor_b32 v23, 2, v21
v_lshlrev_b32 v23, 5, v23
v_add_u32 v32, v20, v23
v_xor_b32 v23, 3, v21
v_lshlrev_b32 v23, 5, v23
v_add_u32 v33, v20, v23
v_xor_b32 v23, 4, v21
v_lshlrev_b32 v23, 5, v23
v_add_u32 v34, v20, v23
v_xor_b32 v23, 5, v21
v_lshlrev_b32 v23, 5, v23
v_add_u32 v35, v20, v23
v_xor_b32 v23, 6, v21
v_lshlrev_b32 v23, 5, v23
v_add_u32 v36, v20, v23
v_xor_b32 v23, 7, v21
v_lshlrev_b32 v23, 5, v23
v_add_u32 v37, v20, v23
s_cmp_lg_u32 s16, 0
s_cbranch_scc1 L_w640_27
ds_read_b64_tr_b16 v[40:41], v30 offset:0
ds_read_b64_tr_b16 v[42:43], v30 offset:20480
ds_read_b64_tr_b16 v[44:45], v31 offset:0
ds_read_b64_tr_b16 v[46:47], v31 offset:20480
ds_read_b64_tr_b16 v[48:49], v32 offset:0
ds_read_b64_tr_b16 v[50:51], v32 offset:20480
ds_read_b64_tr_b16 v[52:53], v33 offset:0
ds_read_b64_tr_b16 v[54:55], v33 offset:20480
ds_read_b64_tr_b16 v[56:57], v34 offset:0
ds_read_b64_tr_b16 v[58:59], v34 offset:20480
ds_read_b64_tr_b16 v[60:61], v35 offset:0
ds_read_b64_tr_b16 v[62:63], v35 offset:20480
ds_read_b64_tr_b16 v[64:65], v36 offset:0
ds_read_b64_tr_b16 v[66:67], v36 offset:20480
ds_read_b64_tr_b16 v[68:69], v37 offset:0
ds_read_b64_tr_b16 v[70:71], v37 offset:20480
ds_read_b64_tr_b16 v[72:73], v30 offset:256
ds_read_b64_tr_b16 v[74:75], v30 offset:20736
ds_read_b64_tr_b16 v[76:77], v31 offset:256
ds_read_b64_tr_b16 v[78:79], v31 offset:20736
s_branch L_wo_26
L_w640_27:
s_cmp_lg_u32 s16, 1
s_cbranch_scc1 L_w640_28
ds_read_b64_tr_b16 v[40:41], v32 offset:256
ds_read_b64_tr_b16 v[42:43], v32 offset:20736
ds_read_b64_tr_b16 v[44:45], v33 offset:256
ds_read_b64_tr_b16 v[46:47], v33 offset:20736
ds_read_b64_tr_b16 v[48:49], v34 offset:256
ds_read_b64_tr_b16 v[50:51], v34 offset:20736
ds_read_b64_tr_b16 v[52:53], v35 offset:256
ds_read_b64_tr_b16 v[54:55], v35 offset:20736
ds_read_b64_tr_b16 v[56:57], v36 offset:256
ds_read_b64_tr_b16 v[58:59], v36 offset:20736
ds_read_b64_tr_b16 v[60:61], v37 offset:256
ds_read_b64_tr_b16 v[62:63], v37 offset:20736
ds_read_b64_tr_b16 v[64:65], v30 offset:512
ds_read_b64_tr_b16 v[66:67], v30 offset:20992
ds_read_b64_tr_b16 v[68:69], v31 offset:512
ds_read_b64_tr_b16 v[70:71], v31 offset:20992
ds_read_b64_tr_b16 v[72:73], v32 offset:512
ds_read_b64_tr_b16 v[74:75], v32 offset:20992
ds_read_b64_tr_b16 v[76:77], v33 offset:512
ds_read_b64_tr_b16 v[78:79], v33 offset:20992
s_branch L_wo_26
L_w640_28:
s_cmp_lg_u32 s16, 2
s_cbranch_scc1 L_w640_29
ds_read_b64_tr_b16 v[40:41], v34 offset:512
ds_read_b64_tr_b16 v[42:43], v34 offset:20992
ds_read_b64_tr_b16 v[44:45], v35 offset:512
ds_read_b64_tr_b16 v[46:47], v35 offset:20992
ds_read_b64_tr_b16 v[48:49], v36 offset:512
ds_read_b64_tr_b16 v[50:51], v36 offset:20992
ds_read_b64_tr_b16 v[52:53], v37 offset:512
ds_read_b64_tr_b16 v[54:55], v37 offset:20992
ds_read_b64_tr_b16 v[56:57], v30 offset:768
ds_read_b64_tr_b16 v[58:59], v30 offset:21248
ds_read_b64_tr_b16 v[60:61], v31 offset:768
ds_read_b64_tr_b16 v[62:63], v31 offset:21248
ds_read_b64_tr_b16 v[64:65], v32 offset:768
ds_read_b64_tr_b16 v[66:67], v32 offset:21248
ds_read_b64_tr_b16 v[68:69], v33 offset:768
ds_read_b64_tr_b16 v[70:71], v33 offset:21248
ds_read_b64_tr_b16 v[72:73], v34 offset:768
ds_read_b64_tr_b16 v[74:75], v34 offset:21248
ds_read_b64_tr_b16 v[76:77], v35 offset:768
ds_read_b64_tr_b16 v[78:79], v35 offset:21248
s_branch L_wo_26
L_w640_29:
ds_read_b64_tr_b16 v[40:41], v36 offset:768
ds_read_b64_tr_b16 v[42:43], v36 offset:21248
ds_read_b64_tr_b16 v[44:45], v37 offset:768
ds_read_b64_tr_b16 v[46:47], v37 offset:21248
ds_read_b64_tr_b16 v[48:49], v30 offset:1024
ds_read_b64_tr_b16 v[50:51], v30 offset:21504
ds_read_b64_tr_b16 v[52:53], v31 offset:1024
ds_read_b64_tr_b16 v[54:55], v31 offset:21504
ds_read_b64_tr_b16 v[56:57], v32 offset:1024
ds_read_b64_tr_b16 v[58:59], v32 offset:21504
ds_read_b64_tr_b16 v[60:61], v33 offset:1024
ds_read_b64_tr_b16 v[62:63], v33 offset:21504
ds_read_b64_tr_b16 v[64:65], v34 offset:1024
ds_read_b64_tr_b16 v[66:67], v34 offset:21504
ds_read_b64_tr_b16 v[68:69], v35 offset:1024
ds_read_b64_tr_b16 v[70:71], v35 offset:21504
ds_read_b64_tr_b16 v[72:73], v36 offset:1024
ds_read_b64_tr_b16 v[74:75], v36 offset:21504
ds_read_b64_tr_b16 v[76:77], v37 offset:1024
ds_read_b64_tr_b16 v[78:79], v37 offset:21504
s_branch L_wo_26
L_wo_26:
s_mul_i32 s25, s16, 204800
s_add_u32 s24, s24, s25
s_add_u32 s27, s27, s25
s_waitcnt lgkmcnt(0)
s_add_u32 s25, s24, 0
s_nop 0
buffer_store_dwordx4 v[40:43], v3, s[44:47], s25 offen sc1
s_add_u32 s25, s24, 1024
buffer_store_dwordx4 v[44:47], v3, s[44:47], s25 offen sc1
s_add_u32 s25, s24, 2048
buffer_store_dwordx4 v[48:51], v3, s[44:47], s25 offen sc1
s_add_u32 s25, s24, 3072
buffer_store_dwordx4 v[52:55], v3, s[44:47], s25 offen sc1
s_add_u32 s25, s27, 0
s_nop 0
buffer_store_dwordx4 v[56:59], v3, s[44:47], s25 offen sc1
s_add_u32 s25, s24, 102400
buffer_store_dwordx4 v[60:63], v3, s[44:47], s25 offen sc1
s_add_u32 s25, s24, 103424
buffer_store_dwordx4 v[64:67], v3, s[44:47], s25 offen sc1
s_add_u32 s25, s24, 104448
buffer_store_dwordx4 v[68:71], v3, s[44:47], s25 offen sc1
s_add_u32 s25, s24, 105472
buffer_store_dwordx4 v[72:75], v3, s[44:47], s25 offen sc1
s_add_u32 s25, s27, 102400
buffer_store_dwordx4 v[76:79], v3, s[44:47], s25 offen sc1
s_branch L_prc2x
L_prc_25_wd:
s_sub_u32 s17, s2, 332
s_cmp_ge_u32 s17, 27
s_cselect_b32 s26, 1, 0
s_mul_i32 s27, s26, 27
s_sub_u32 s27, s17, s27
s_mul_i32 s28, s27, 171
s_lshr_b32 s28, s28, 9
s_mul_i32 s29, s28, 3
s_sub_u32 s29, s27, s29
s_mul_i32 s28, s28, 30720
s_add_u32 s28, s28, 8028160
s_mul_i32 s24, s26, 14
s_mul_i32 s27, s29, 5
s_add_u32 s24, s24, s27
s_lshl_b32 s24, s24, 10
s_add_u32 s24, s24, s28
s_add_u32 s27, s24, 4096
s_add_u32 s25, s26, 28
s_lshl_b32 s25, s25, 10
s_add_u32 s25, s25, s28
s_cmp_eq_u32 s29, 2
s_cselect_b32 s27, s25, s27
v_lshlrev_b32 v20, 2, v6
v_add_u32 v20, v20, v5
v_and_b32 v21, 7, v20
v_mul_u32_u24 v20, 1280, v20
v_lshlrev_b32 v22, 3, v4
v_add3_u32 v20, v20, v22, s32
v_xor_b32 v23, 0, v21
v_lshlrev_b32 v23, 5, v23
v_add_u32 v30, v20, v23
v_xor_b32 v23, 1, v21
v_lshlrev_b32 v23, 5, v23
v_add_u32 v31, v20, v23
v_xor_b32 v23, 2, v21
v_lshlrev_b32 v23, 5, v23
v_add_u32 v32, v20, v23
v_xor_b32 v23, 3, v21
v_lshlrev_b32 v23, 5, v23
v_add_u32 v33, v20, v23
v_xor_b32 v23, 4, v21
v_lshlrev_b32 v23, 5, v23
v_add_u32 v34, v20, v23
v_xor_b32 v23, 5, v21
v_lshlrev_b32 v23, 5, v23
v_add_u32 v35, v20, v23
v_xor_b32 v23, 6, v21
v_lshlrev_b32 v23, 5, v23
v_add_u32 v36, v20, v23
v_xor_b32 v23, 7, v21
v_lshlrev_b32 v23, 5, v23
v_add_u32 v37, v20, v23
s_cmp_lg_u32 s16, 0
s_cbranch_scc1 L_w640_32
ds_read_b64_tr_b16 v[40:41], v30 offset:0
ds_read_b64_tr_b16 v[42:43], v30 offset:20480
ds_read_b64_tr_b16 v[44:45], v31 offset:0
ds_read_b64_tr_b16 v[46:47], v31 offset:20480
ds_read_b64_tr_b16 v[48:49], v32 offset:0
ds_read_b64_tr_b16 v[50:51], v32 offset:20480
ds_read_b64_tr_b16 v[52:53], v33 offset:0
ds_read_b64_tr_b16 v[54:55], v33 offset:20480
ds_read_b64_tr_b16 v[56:57], v34 offset:0
ds_read_b64_tr_b16 v[58:59], v34 offset:20480
ds_read_b64_tr_b16 v[60:61], v35 offset:0
ds_read_b64_tr_b16 v[62:63], v35 offset:20480
ds_read_b64_tr_b16 v[64:65], v36 offset:0
ds_read_b64_tr_b16 v[66:67], v36 offset:20480
ds_read_b64_tr_b16 v[68:69], v37 offset:0
ds_read_b64_tr_b16 v[70:71], v37 offset:20480
ds_read_b64_tr_b16 v[72:73], v30 offset:256
ds_read_b64_tr_b16 v[74:75], v30 offset:20736
ds_read_b64_tr_b16 v[76:77], v31 offset:256
ds_read_b64_tr_b16 v[78:79], v31 offset:20736
s_branch L_wd_31
L_w640_32:
s_cmp_lg_u32 s16, 1
s_cbranch_scc1 L_w640_33
ds_read_b64_tr_b16 v[40:41], v32 offset:256
ds_read_b64_tr_b16 v[42:43], v32 offset:20736
ds_read_b64_tr_b16 v[44:45], v33 offset:256
ds_read_b64_tr_b16 v[46:47], v33 offset:20736
ds_read_b64_tr_b16 v[48:49], v34 offset:256
ds_read_b64_tr_b16 v[50:51], v34 offset:20736
ds_read_b64_tr_b16 v[52:53], v35 offset:256
ds_read_b64_tr_b16 v[54:55], v35 offset:20736
ds_read_b64_tr_b16 v[56:57], v36 offset:256
ds_read_b64_tr_b16 v[58:59], v36 offset:20736
ds_read_b64_tr_b16 v[60:61], v37 offset:256
ds_read_b64_tr_b16 v[62:63], v37 offset:20736
ds_read_b64_tr_b16 v[64:65], v30 offset:512
ds_read_b64_tr_b16 v[66:67], v30 offset:20992
ds_read_b64_tr_b16 v[68:69], v31 offset:512
ds_read_b64_tr_b16 v[70:71], v31 offset:20992
ds_read_b64_tr_b16 v[72:73], v32 offset:512
ds_read_b64_tr_b16 v[74:75], v32 offset:20992
ds_read_b64_tr_b16 v[76:77], v33 offset:512
ds_read_b64_tr_b16 v[78:79], v33 offset:20992
s_branch L_wd_31
L_w640_33:
s_cmp_lg_u32 s16, 2
s_cbranch_scc1 L_w640_34
ds_read_b64_tr_b16 v[40:41], v34 offset:512
ds_read_b64_tr_b16 v[42:43], v34 offset:20992
ds_read_b64_tr_b16 v[44:45], v35 offset:512
ds_read_b64_tr_b16 v[46:47], v35 offset:20992
ds_read_b64_tr_b16 v[48:49], v36 offset:512
ds_read_b64_tr_b16 v[50:51], v36 offset:20992
ds_read_b64_tr_b16 v[52:53], v37 offset:512
ds_read_b64_tr_b16 v[54:55], v37 offset:20992
ds_read_b64_tr_b16 v[56:57], v30 offset:768
ds_read_b64_tr_b16 v[58:59], v30 offset:21248
ds_read_b64_tr_b16 v[60:61], v31 offset:768
ds_read_b64_tr_b16 v[62:63], v31 offset:21248
ds_read_b64_tr_b16 v[64:65], v32 offset:768
ds_read_b64_tr_b16 v[66:67], v32 offset:21248
ds_read_b64_tr_b16 v[68:69], v33 offset:768
ds_read_b64_tr_b16 v[70:71], v33 offset:21248
ds_read_b64_tr_b16 v[72:73], v34 offset:768
ds_read_b64_tr_b16 v[74:75], v34 offset:21248
ds_read_b64_tr_b16 v[76:77], v35 offset:768
ds_read_b64_tr_b16 v[78:79], v35 offset:21248
s_branch L_wd_31
L_w640_34:
ds_read_b64_tr_b16 v[40:41], v36 offset:768
ds_read_b64_tr_b16 v[42:43], v36 offset:21248
ds_read_b64_tr_b16 v[44:45], v37 offset:768
ds_read_b64_tr_b16 v[46:47], v37 offset:21248
ds_read_b64_tr_b16 v[48:49], v30 offset:1024
ds_read_b64_tr_b16 v[50:51], v30 offset:21504
ds_read_b64_tr_b16 v[52:53], v31 offset:1024
ds_read_b64_tr_b16 v[54:55], v31 offset:21504
ds_read_b64_tr_b16 v[56:57], v32 offset:1024
ds_read_b64_tr_b16 v[58:59], v32 offset:21504
ds_read_b64_tr_b16 v[60:61], v33 offset:1024
ds_read_b64_tr_b16 v[62:63], v33 offset:21504
ds_read_b64_tr_b16 v[64:65], v34 offset:1024
ds_read_b64_tr_b16 v[66:67], v34 offset:21504
ds_read_b64_tr_b16 v[68:69], v35 offset:1024
ds_read_b64_tr_b16 v[70:71], v35 offset:21504
ds_read_b64_tr_b16 v[72:73], v36 offset:1024
ds_read_b64_tr_b16 v[74:75], v36 offset:21504
ds_read_b64_tr_b16 v[76:77], v37 offset:1024
ds_read_b64_tr_b16 v[78:79], v37 offset:21504
s_branch L_wd_31
L_wd_31:
s_mul_i32 s25, s16, 552960
s_add_u32 s24, s24, s25
s_add_u32 s27, s27, s25
s_waitcnt lgkmcnt(0)
s_add_u32 s25, s24, 0
buffer_store_dwordx4 v[40:43], v3, s[44:47], s25 offen sc1
s_add_u32 s25, s24, 1024
buffer_store_dwordx4 v[44:47], v3, s[44:47], s25 offen sc1
s_add_u32 s25, s24, 2048
buffer_store_dwordx4 v[48:51], v3, s[44:47], s25 offen sc1
s_add_u32 s25, s24, 3072
buffer_store_dwordx4 v[52:55], v3, s[44:47], s25 offen sc1
s_add_u32 s25, s27, 0
s_nop 0
buffer_store_dwordx4 v[56:59], v3, s[44:47], s25 offen sc1
s_add_u32 s25, s24, 276480
buffer_store_dwordx4 v[60:63], v3, s[44:47], s25 offen sc1
s_add_u32 s25, s24, 277504
buffer_store_dwordx4 v[64:67], v3, s[44:47], s25 offen sc1
s_add_u32 s25, s24, 278528
buffer_store_dwordx4 v[68:71], v3, s[44:47], s25 offen sc1
s_add_u32 s25, s24, 279552
buffer_store_dwordx4 v[72:75], v3, s[44:47], s25 offen sc1
s_add_u32 s25, s27, 276480
buffer_store_dwordx4 v[76:79], v3, s[44:47], s25 offen sc1
s_branch L_prc2x
L_prc_25_wgu:
s_cmp_ge_u32 s2, 54
s_cselect_b32 s17, 1, 0
s_mul_i32 s18, s17, 54
s_sub_u32 s18, s2, s18
s_lshr_b32 s19, s18, 1
s_and_b32 s18, s18, 1
v_lshlrev_b32 v20, 2, v6
v_add_u32 v20, v20, v5
v_bfe_u32 v21, v20, 1, 2
v_xor_b32 v21, s16, v21
v_lshlrev_b32 v21, 5, v21
v_lshlrev_b32 v20, 7, v20
v_add_u32 v20, v20, v21
v_lshlrev_b32 v22, 3, v4
v_add3_u32 v30, v20, v22, s32
ds_read_b64_tr_b16 v[40:41], v30 offset:0
ds_read_b64_tr_b16 v[42:43], v30 offset:2048
ds_read_b64_tr_b16 v[44:45], v30 offset:4096
ds_read_b64_tr_b16 v[46:47], v30 offset:6144
ds_read_b64_tr_b16 v[48:49], v30 offset:8192
ds_read_b64_tr_b16 v[50:51], v30 offset:10240
ds_read_b64_tr_b16 v[52:53], v30 offset:12288
ds_read_b64_tr_b16 v[54:55], v30 offset:14336
ds_read_b64_tr_b16 v[56:57], v30 offset:16384
ds_read_b64_tr_b16 v[58:59], v30 offset:18432
ds_read_b64_tr_b16 v[60:61], v30 offset:20480
ds_read_b64_tr_b16 v[62:63], v30 offset:22528
ds_read_b64_tr_b16 v[64:65], v30 offset:24576
ds_read_b64_tr_b16 v[66:67], v30 offset:26624
ds_read_b64_tr_b16 v[68:69], v30 offset:28672
ds_read_b64_tr_b16 v[70:71], v30 offset:30720
ds_read_b64_tr_b16 v[72:73], v30 offset:32768
ds_read_b64_tr_b16 v[74:75], v30 offset:34816
ds_read_b64_tr_b16 v[76:77], v30 offset:36864
ds_read_b64_tr_b16 v[78:79], v30 offset:38912
s_lshl_b32 s24, s19, 2
s_add_u32 s24, s24, s16
s_mul_i32 s25, s24, 147
s_lshr_b32 s25, s25, 10
s_mul_i32 s26, s25, 7
s_sub_u32 s26, s24, s26
s_mul_i32 s27, s25, 20
s_mul_i32 s28, s18, 10
s_add_u32 s27, s27, s28
s_mul_i32 s27, s27, 7
s_add_u32 s27, s27, s26
s_lshl_b32 s27, s27, 11
s_lshl_b32 s28, s17, 10
s_add_u32 s27, s27, s28
s_add_u32 s27, s27, 3440640
s_mul_i32 s28, s18, 112
s_add_u32 s28, s28, s24
s_lshl_b32 s28, s28, 1
s_add_u32 s28, s28, s17
s_lshl_b32 s28, s28, 6
s_add_u32 s28, s28, 10240000
v_mov_b32 v80, 0x3f803f80
v_mov_b32 v81, 0x3f803f80
v_mov_b32 v82, 0x3f803f80
v_mov_b32 v83, 0x3f803f80
s_waitcnt lgkmcnt(0)
buffer_store_dwordx4 v[40:43], v3, s[44:47], s27 offen sc1
v_mfma_f32_16x16x32_bf16 v[84:87], v[40:43], v[80:83], 0
s_add_u32 s27, s27, 14336
buffer_store_dwordx4 v[44:47], v3, s[44:47], s27 offen sc1
v_mfma_f32_16x16x32_bf16 v[84:87], v[44:47], v[80:83], v[84:87]
s_add_u32 s27, s27, 14336
buffer_store_dwordx4 v[48:51], v3, s[44:47], s27 offen sc1
v_mfma_f32_16x16x32_bf16 v[84:87], v[48:51], v[80:83], v[84:87]
s_add_u32 s27, s27, 14336
buffer_store_dwordx4 v[52:55], v3, s[44:47], s27 offen sc1
v_mfma_f32_16x16x32_bf16 v[84:87], v[52:55], v[80:83], v[84:87]
s_add_u32 s27, s27, 14336
buffer_store_dwordx4 v[56:59], v3, s[44:47], s27 offen sc1
v_mfma_f32_16x16x32_bf16 v[84:87], v[56:59], v[80:83], v[84:87]
s_add_u32 s27, s27, 14336
buffer_store_dwordx4 v[60:63], v3, s[44:47], s27 offen sc1
v_mfma_f32_16x16x32_bf16 v[84:87], v[60:63], v[80:83], v[84:87]
s_add_u32 s27, s27, 14336
buffer_store_dwordx4 v[64:67], v3, s[44:47], s27 offen sc1
v_mfma_f32_16x16x32_bf16 v[84:87], v[64:67], v[80:83], v[84:87]
s_add_u32 s27, s27, 14336
buffer_store_dwordx4 v[68:71], v3, s[44:47], s27 offen sc1
v_mfma_f32_16x16x32_bf16 v[84:87], v[68:71], v[80:83], v[84:87]
s_add_u32 s27, s27, 14336
buffer_store_dwordx4 v[72:75], v3, s[44:47], s27 offen sc1
v_mfma_f32_16x16x32_bf16 v[84:87], v[72:75], v[80:83], v[84:87]
s_add_u32 s27, s27, 14336
buffer_store_dwordx4 v[76:79], v3, s[44:47], s27 offen sc1
v_mfma_f32_16x16x32_bf16 v[84:87], v[76:79], v[80:83], v[84:87]
v_and_b32 v20, 15, v2
v_lshlrev_b32 v21, 4, v6
v_cmp_eq_u32 vcc, 0, v20
s_nop 7
s_and_saveexec_b64 s[30:31], vcc
buffer_store_dwordx4 v[84:87], v21, s[44:47], s28 offen sc1
s_mov_b64 exec, s[30:31]
s_branch L_prc2x
L_prc_25_wq:
s_sub_u32 s17, s2, 108
s_and_b32 s18, s17, 7
s_lshr_b32 s17, s17, 3
s_mul_i32 s19, s18, 160
s_and_b32 s19, s19, 127
v_lshlrev_b32 v20, 2, v6
v_add_u32 v20, v20, v5
v_lshlrev_b32 v20, 8, v20
s_and_b32 s21, s16, 1
s_mul_i32 s22, s21, 80
s_add_u32 s22, s22, s19
v_add_u32 v20, s22, v20
s_lshr_b32 s23, s16, 1
s_lshl_b32 s23, s23, 4
s_add_u32 s25, s23, 0
v_add_u32 v21, s25, v4
v_min_u32 v21, 29, v21
v_mul_u32_u24 v22, 52, v21
v_lshrrev_b32 v22, 8, v22
v_mul_u32_u24 v23, 5, v22
v_sub_u32 v23, v21, v23
v_cmp_le_u32 vcc, 3, v22
v_lshlrev_b32 v23, 3, v23
s_nop 0
v_cndmask_b32 v24, 0, 1, vcc
v_mul_u32_u24 v25, 3, v24
v_sub_u32 v25, v22, v25
v_lshlrev_b32 v25, 13, v25
v_mul_u32_u24 v24, 40, v24
v_add3_u32 v23, v23, v24, v25
v_add_u32 v30, v20, v23
ds_read_b64_tr_b16 v[40:41], v30
ds_read_b64_tr_b16 v[42:43], v30 offset:4096
s_add_u32 s25, s23, 4
v_add_u32 v21, s25, v4
v_min_u32 v21, 29, v21
v_mul_u32_u24 v22, 52, v21
v_lshrrev_b32 v22, 8, v22
v_mul_u32_u24 v23, 5, v22
v_sub_u32 v23, v21, v23
v_cmp_le_u32 vcc, 3, v22
v_lshlrev_b32 v23, 3, v23
s_nop 0
v_cndmask_b32 v24, 0, 1, vcc
v_mul_u32_u24 v25, 3, v24
v_sub_u32 v25, v22, v25
v_lshlrev_b32 v25, 13, v25
v_mul_u32_u24 v24, 40, v24
v_add3_u32 v23, v23, v24, v25
v_add_u32 v31, v20, v23
ds_read_b64_tr_b16 v[44:45], v31
ds_read_b64_tr_b16 v[46:47], v31 offset:4096
s_add_u32 s25, s23, 8
v_add_u32 v21, s25, v4
v_min_u32 v21, 29, v21
v_mul_u32_u24 v22, 52, v21
v_lshrrev_b32 v22, 8, v22
v_mul_u32_u24 v23, 5, v22
v_sub_u32 v23, v21, v23
v_cmp_le_u32 vcc, 3, v22
v_lshlrev_b32 v23, 3, v23
s_nop 0
v_cndmask_b32 v24, 0, 1, vcc
v_mul_u32_u24 v25, 3, v24
v_sub_u32 v25, v22, v25
v_lshlrev_b32 v25, 13, v25
v_mul_u32_u24 v24, 40, v24
v_add3_u32 v23, v23, v24, v25
v_add_u32 v32, v20, v23
ds_read_b64_tr_b16 v[48:49], v32
ds_read_b64_tr_b16 v[50:51], v32 offset:4096
s_add_u32 s25, s23, 12
v_add_u32 v21, s25, v4
v_min_u32 v21, 29, v21
v_mul_u32_u24 v22, 52, v21
v_lshrrev_b32 v22, 8, v22
v_mul_u32_u24 v23, 5, v22
v_sub_u32 v23, v21, v23
v_cmp_le_u32 vcc, 3, v22
v_lshlrev_b32 v23, 3, v23
s_nop 0
v_cndmask_b32 v24, 0, 1, vcc
v_mul_u32_u24 v25, 3, v24
v_sub_u32 v25, v22, v25
v_lshlrev_b32 v25, 13, v25
v_mul_u32_u24 v24, 40, v24
v_add3_u32 v23, v23, v24, v25
v_add_u32 v33, v20, v23
ds_read_b64_tr_b16 v[52:53], v33
ds_read_b64_tr_b16 v[54:55], v33 offset:4096
s_lshl_b32 s24, s18, 1
s_add_u32 s24, s24, s21
s_mul_i32 s24, s24, 163840
s_lshl_b32 s25, s17, 11
s_add_u32 s24, s24, s25
s_lshr_b32 s25, s16, 1
s_mul_i32 s25, s25, 81920
s_add_u32 s24, s24, s25
s_add_u32 s24, s24, 0
s_waitcnt lgkmcnt(0)
s_add_u32 s25, s24, 0
buffer_store_dwordx4 v[40:43], v3, s[44:47], s25 offen sc1
s_add_u32 s25, s24, 1024
buffer_store_dwordx4 v[44:47], v3, s[44:47], s25 offen sc1
s_add_u32 s25, s24, 40960
buffer_store_dwordx4 v[48:51], v3, s[44:47], s25 offen sc1
s_add_u32 s25, s24, 41984
buffer_store_dwordx4 v[52:55], v3, s[44:47], s25 offen sc1
s_branch L_prc2x
L_prc_25_x:
s_sub_u32 s17, s2, 268
v_and_b32 v20, 15, v2
v_mul_u32_u24 v21, 1280, v20
v_and_b32 v22, 1, v6
v_lshlrev_b32 v22, 3, v22
v_add_u32 v21, v21, v22
s_lshr_b32 s21, s16, 1
s_mul_i32 s21, s21, 20480
s_and_b32 s26, s16, 1
v_add_u32 v21, s21, v21
v_lshrrev_b32 v22, 1, v6
v_add_u32 v23, 0, v22
v_xor_b32 v23, v23, v20
v_lshlrev_b32 v23, 4, v23
v_add_u32 v30, v21, v23
v_add_u32 v23, 2, v22
v_xor_b32 v23, v23, v20
v_lshlrev_b32 v23, 4, v23
v_add_u32 v31, v21, v23
v_add_u32 v23, 4, v22
v_xor_b32 v23, v23, v20
v_lshlrev_b32 v23, 4, v23
v_add_u32 v32, v21, v23
v_add_u32 v23, 6, v22
v_xor_b32 v23, v23, v20
v_lshlrev_b32 v23, 4, v23
v_add_u32 v33, v21, v23
v_add_u32 v23, 8, v22
v_xor_b32 v23, v23, v20
v_lshlrev_b32 v23, 4, v23
v_add_u32 v34, v21, v23
v_add_u32 v23, 10, v22
v_xor_b32 v23, v23, v20
v_lshlrev_b32 v23, 4, v23
v_add_u32 v35, v21, v23
v_add_u32 v23, 12, v22
v_xor_b32 v23, v23, v20
v_lshlrev_b32 v23, 4, v23
v_add_u32 v36, v21, v23
v_add_u32 v23, 14, v22
v_xor_b32 v23, v23, v20
v_lshlrev_b32 v23, 4, v23
v_add_u32 v37, v21, v23
s_cmp_lg_u32 s26, 0
s_cbranch_scc1 L_xh_37
ds_read_b64 v[40:41], v30 offset:0
ds_read_b64 v[42:43], v31 offset:0
ds_read_b64 v[44:45], v32 offset:0
ds_read_b64 v[46:47], v33 offset:0
ds_read_b64 v[48:49], v34 offset:0
ds_read_b64 v[50:51], v35 offset:0
ds_read_b64 v[52:53], v36 offset:0
ds_read_b64 v[54:55], v37 offset:0
ds_read_b64 v[56:57], v30 offset:256
ds_read_b64 v[58:59], v31 offset:256
ds_read_b64 v[60:61], v32 offset:256
ds_read_b64 v[62:63], v33 offset:256
ds_read_b64 v[64:65], v34 offset:256
ds_read_b64 v[66:67], v35 offset:256
ds_read_b64 v[68:69], v36 offset:256
ds_read_b64 v[70:71], v37 offset:256
ds_read_b64 v[72:73], v30 offset:512
ds_read_b64 v[74:75], v31 offset:512
ds_read_b64 v[76:77], v32 offset:512
ds_read_b64 v[78:79], v33 offset:512
s_branch L_xrd_36
L_xh_37:
ds_read_b64 v[40:41], v34 offset:512
ds_read_b64 v[42:43], v35 offset:512
ds_read_b64 v[44:45], v36 offset:512
ds_read_b64 v[46:47], v37 offset:512
ds_read_b64 v[48:49], v30 offset:768
ds_read_b64 v[50:51], v31 offset:768
ds_read_b64 v[52:53], v32 offset:768
ds_read_b64 v[54:55], v33 offset:768
ds_read_b64 v[56:57], v34 offset:768
ds_read_b64 v[58:59], v35 offset:768
ds_read_b64 v[60:61], v36 offset:768
ds_read_b64 v[62:63], v37 offset:768
ds_read_b64 v[64:65], v30 offset:1024
ds_read_b64 v[66:67], v31 offset:1024
ds_read_b64 v[68:69], v32 offset:1024
ds_read_b64 v[70:71], v33 offset:1024
ds_read_b64 v[72:73], v34 offset:1024
ds_read_b64 v[74:75], v35 offset:1024
ds_read_b64 v[76:77], v36 offset:1024
ds_read_b64 v[78:79], v37 offset:1024
s_branch L_xrd_36
L_xrd_36:
s_lshl_b32 s24, s17, 1
s_lshr_b32 s25, s16, 1
s_add_u32 s24, s24, s25
s_lshr_b32 s25, s24, 3
s_mul_i32 s25, s25, 163840
s_and_b32 s31, s24, 7
s_lshl_b32 s27, s31, 10
s_add_u32 s25, s25, s27
s_mul_i32 s27, s26, 81920
s_add_u32 s25, s25, s27
s_add_u32 s25, s25, 10268672
s_lshl_b32 s28, s24, 10
s_lshl_b32 s27, s26, 3
s_add_u32 s28, s28, s27
s_add_u32 s28, s28, 22589440
s_lshr_b32 s30, s24, 3
s_mul_i32 s30, s30, 20480
s_mul_i32 s29, s26, 10240
s_add_u32 s30, s30, s29
s_add_u32 s30, s30, 22720512
v_mov_b32 v80, 0x3f803f80
s_waitcnt lgkmcnt(0)
s_nop 0
buffer_store_dwordx4 v[40:43], v3, s[44:47], s25 offen sc1
s_add_u32 s25, s25, 8192
v_dot2_f32_bf16 v84, v40, v80, 0
v_dot2_f32_bf16 v85, v40, v40, 0
v_dot2_f32_bf16 v84, v41, v80, v84
v_dot2_f32_bf16 v85, v41, v41, v85
v_dot2_f32_bf16 v84, v42, v80, v84
v_dot2_f32_bf16 v85, v42, v42, v85
v_dot2_f32_bf16 v84, v43, v80, v84
v_dot2_f32_bf16 v85, v43, v43, v85
buffer_store_dwordx4 v[44:47], v3, s[44:47], s25 offen sc1
s_add_u32 s25, s25, 8192
v_dot2_f32_bf16 v84, v44, v80, v84
v_dot2_f32_bf16 v85, v44, v44, v85
v_dot2_f32_bf16 v84, v45, v80, v84
v_dot2_f32_bf16 v85, v45, v45, v85
v_dot2_f32_bf16 v84, v46, v80, v84
v_dot2_f32_bf16 v85, v46, v46, v85
v_dot2_f32_bf16 v84, v47, v80, v84
v_dot2_f32_bf16 v85, v47, v47, v85
buffer_store_dwordx4 v[48:51], v3, s[44:47], s25 offen sc1
s_add_u32 s25, s25, 8192
v_dot2_f32_bf16 v84, v48, v80, v84
v_dot2_f32_bf16 v85, v48, v48, v85
v_dot2_f32_bf16 v84, v49, v80, v84
v_dot2_f32_bf16 v85, v49, v49, v85
v_dot2_f32_bf16 v84, v50, v80, v84
v_dot2_f32_bf16 v85, v50, v50, v85
v_dot2_f32_bf16 v84, v51, v80, v84
v_dot2_f32_bf16 v85, v51, v51, v85
buffer_store_dwordx4 v[52:55], v3, s[44:47], s25 offen sc1
s_add_u32 s25, s25, 8192
v_dot2_f32_bf16 v84, v52, v80, v84
v_dot2_f32_bf16 v85, v52, v52, v85
v_dot2_f32_bf16 v84, v53, v80, v84
v_dot2_f32_bf16 v85, v53, v53, v85
v_dot2_f32_bf16 v84, v54, v80, v84
v_dot2_f32_bf16 v85, v54, v54, v85
v_dot2_f32_bf16 v84, v55, v80, v84
v_dot2_f32_bf16 v85, v55, v55, v85
buffer_store_dwordx4 v[56:59], v3, s[44:47], s25 offen sc1
s_add_u32 s25, s25, 8192
v_dot2_f32_bf16 v84, v56, v80, v84
v_dot2_f32_bf16 v85, v56, v56, v85
v_dot2_f32_bf16 v84, v57, v80, v84
v_dot2_f32_bf16 v85, v57, v57, v85
v_dot2_f32_bf16 v84, v58, v80, v84
v_dot2_f32_bf16 v85, v58, v58, v85
v_dot2_f32_bf16 v84, v59, v80, v84
v_dot2_f32_bf16 v85, v59, v59, v85
buffer_store_dwordx4 v[60:63], v3, s[44:47], s25 offen sc1
s_add_u32 s25, s25, 8192
v_dot2_f32_bf16 v84, v60, v80, v84
v_dot2_f32_bf16 v85, v60, v60, v85
v_dot2_f32_bf16 v84, v61, v80, v84
v_dot2_f32_bf16 v85, v61, v61, v85
v_dot2_f32_bf16 v84, v62, v80, v84
v_dot2_f32_bf16 v85, v62, v62, v85
v_dot2_f32_bf16 v84, v63, v80, v84
v_dot2_f32_bf16 v85, v63, v63, v85
buffer_store_dwordx4 v[64:67], v3, s[44:47], s25 offen sc1
s_add_u32 s25, s25, 8192
v_dot2_f32_bf16 v84, v64, v80, v84
v_dot2_f32_bf16 v85, v64, v64, v85
v_dot2_f32_bf16 v84, v65, v80, v84
v_dot2_f32_bf16 v85, v65, v65, v85
v_dot2_f32_bf16 v84, v66, v80, v84
v_dot2_f32_bf16 v85, v66, v66, v85
v_dot2_f32_bf16 v84, v67, v80, v84
v_dot2_f32_bf16 v85, v67, v67, v85
buffer_store_dwordx4 v[68:71], v3, s[44:47], s25 offen sc1
s_add_u32 s25, s25, 8192
v_dot2_f32_bf16 v84, v68, v80, v84
v_dot2_f32_bf16 v85, v68, v68, v85
v_dot2_f32_bf16 v84, v69, v80, v84
v_dot2_f32_bf16 v85, v69, v69, v85
v_dot2_f32_bf16 v84, v70, v80, v84
v_dot2_f32_bf16 v85, v70, v70, v85
v_dot2_f32_bf16 v84, v71, v80, v84
v_dot2_f32_bf16 v85, v71, v71, v85
buffer_store_dwordx4 v[72:75], v3, s[44:47], s25 offen sc1
s_add_u32 s25, s25, 8192
v_dot2_f32_bf16 v84, v72, v80, v84
v_dot2_f32_bf16 v85, v72, v72, v85
v_dot2_f32_bf16 v84, v73, v80, v84
v_dot2_f32_bf16 v85, v73, v73, v85
v_dot2_f32_bf16 v84, v74, v80, v84
v_dot2_f32_bf16 v85, v74, v74, v85
v_dot2_f32_bf16 v84, v75, v80, v84
v_dot2_f32_bf16 v85, v75, v75, v85
buffer_store_dwordx4 v[76:79], v3, s[44:47], s25 offen sc1
v_dot2_f32_bf16 v84, v76, v80, v84
v_dot2_f32_bf16 v85, v76, v76, v85
v_dot2_f32_bf16 v84, v77, v80, v84
v_dot2_f32_bf16 v85, v77, v77, v85
v_dot2_f32_bf16 v84, v78, v80, v84
v_dot2_f32_bf16 v85, v78, v78, v85
v_dot2_f32_bf16 v84, v79, v80, v84
v_dot2_f32_bf16 v85, v79, v79, v85
s_cmp_lg_u32 s31, 7
s_cbranch_scc1 L_xnohalo_39
buffer_store_dwordx4 v[40:43], v3, s[44:47], s30 offen sc1
s_add_u32 s30, s30, 1024
buffer_store_dwordx4 v[44:47], v3, s[44:47], s30 offen sc1
s_add_u32 s30, s30, 1024
buffer_store_dwordx4 v[48:51], v3, s[44:47], s30 offen sc1
s_add_u32 s30, s30, 1024
buffer_store_dwordx4 v[52:55], v3, s[44:47], s30 offen sc1
s_add_u32 s30, s30, 1024
buffer_store_dwordx4 v[56:59], v3, s[44:47], s30 offen sc1
s_add_u32 s30, s30, 1024
buffer_store_dwordx4 v[60:63], v3, s[44:47], s30 offen sc1
s_add_u32 s30, s30, 1024
buffer_store_dwordx4 v[64:67], v3, s[44:47], s30 offen sc1
s_add_u32 s30, s30, 1024
buffer_store_dwordx4 v[68:71], v3, s[44:47], s30 offen sc1
s_add_u32 s30, s30, 1024
buffer_store_dwordx4 v[72:75], v3, s[44:47], s30 offen sc1
s_add_u32 s30, s30, 1024
buffer_store_dwordx4 v[76:79], v3, s[44:47], s30 offen sc1
s_add_u32 s30, s30, 1024
L_xnohalo_39:
s_nop 2
v_mov_b32 v86, v84
v_mov_b32 v87, v85
s_nop 1
v_permlane16_swap_b32 v84, v86
v_permlane16_swap_b32 v85, v87
s_nop 1
v_add_f32 v84, v84, v86
v_add_f32 v85, v85, v87
v_mov_b32 v86, v84
v_mov_b32 v87, v85
s_nop 1
v_permlane32_swap_b32 v84, v86
v_permlane32_swap_b32 v85, v87
s_nop 1
v_add_f32 v84, v84, v86
v_add_f32 v85, v85, v87
v_cmp_eq_u32 vcc, 0, v6
s_nop 1
v_cndmask_b32 v84, 0, v84, vcc
v_cndmask_b32 v85, 0, v85, vcc
buffer_store_dwordx2 v[84:85], v3, s[44:47], s28 offen sc1
s_cmp_lg_u32 s31, 7
s_cbranch_scc1 L_prc2x
s_lshr_b32 s30, s24, 3
s_lshl_b32 s30, s30, 10
s_add_u32 s30, s30, s27
s_add_u32 s30, s30, 23375872
buffer_store_dwordx2 v[84:85], v3, s[44:47], s30 offen sc1
s_branch L_prc2x
L_prc2x:
s_cmp_lg_u32 s7, 0
s_cbranch_scc1 L_B_done
s_mov_b32 s7, 1
s_mov_b32 s46, 23719936
s_waitcnt vmcnt(0)
s_barrier
v_readfirstlane_b32 s17, v203
v_readfirstlane_b32 s59, v202
s_mov_b32 s18, 0
s_cmp_lg_u32 s17, 0
s_cbranch_scc1 L_npolld_41
L_npoll_40:
buffer_load_dwordx2 v[202:203], v201, s[40:43], 0 offen sc1
s_waitcnt vmcnt(0)
v_readfirstlane_b32 s17, v203
v_readfirstlane_b32 s59, v202
s_add_u32 s18, s18, 1
s_cmp_gt_u32 s18, 40000
s_cbranch_scc1 L_npolld_41
s_cmp_eq_u32 s17, 0
s_cbranch_scc1 L_npoll_40
L_npolld_41:
s_cmp_lg_u32 s16, 0
s_cbranch_scc1 L_uflag_42
s_cmp_eq_u32 s34, 0xffff
s_cbranch_scc1 L_uflag_42
s_sub_u32 s17, s34, 108
s_and_b32 s18, s17, 7
s_mul_i32 s18, s18, 20
s_lshr_b32 s17, s17, 3
s_add_u32 s17, s17, s18
s_add_u32 s17, s17, 108
s_cmp_lt_u32 s34, 268
s_cselect_b32 s17, s17, s34
s_cmp_lt_u32 s34, 108
s_cselect_b32 s17, s34, s17
s_lshl_b32 s17, s17, 2
s_add_u32 s17, s17, 23418880
v_mov_b32 v12, s17
v_mov_b32 v10, s59
s_mov_b64 s[38:39], exec
s_mov_b64 exec, 1
buffer_store_dword v10, v12, s[44:47], 0 offen sc1
s_mov_b64 exec, s[38:39]
L_uflag_42:
s_cmp_lg_u32 s16, 0
s_cbranch_scc1 L_tick_43
s_lshl_b32 s17, s33, 7
s_add_u32 s17, s17, 23416832
v_mov_b32 v200, 1
v_mov_b32 v9, s17
s_mov_b64 s[38:39], exec
s_mov_b64 exec, 1
buffer_atomic_add v200, v9, s[44:47], 0 offen sc0
s_mov_b64 exec, s[38:39]
L_tick_43:
s_branch L_B_again
L_B_done:
s_cmp_eq_u32 s35, 0xffff
s_cbranch_scc1 L_wT_44
s_waitcnt vmcnt(10)
s_branch L_wT2_45
L_wT_44:
s_waitcnt vmcnt(0)
L_wT2_45:
s_mov_b32 s19, s35
s_mov_b32 s6, s62
s_mov_b32 s7, s63
s_mov_b32 s4, s44
s_mov_b32 s5, s45
v_and_b32 v2, 63, v0
v_lshlrev_b32 v1, 4, v2
v_and_b32 v3, 15, v2
v_lshrrev_b32 v4, 4, v2
v_lshlrev_b32 v249, 7, v2
s_mov_b32 s8, s44
s_mov_b32 s9, s45
s_mov_b32 s10, 23719936
s_mov_b32 s11, 0x20000
v_mov_b32 v10, 133120
s_cmp_lg_u32 s16, 0
s_cbranch_scc1 L_tick2_46
s_lshl_b32 s34, s33, 5
v_add_u32 v8, s34, v200
s_mov_b64 s[38:39], exec
s_mov_b64 exec, 1
ds_write_b32 v10, v8
s_mov_b64 exec, s[38:39]
L_tick2_46:
s_waitcnt lgkmcnt(0)
s_mov_b32 s12, s6
s_mov_b32 s13, s7
s_mov_b32 s14, 2621440
s_mov_b32 s15, 0x20000
s_barrier
ds_read_b32 v8, v10
s_waitcnt lgkmcnt(0)
v_readfirstlane_b32 s32, v8
s_nop 3
s_min_u32 s32, s32, 255
s_lshr_b32 s17, s32, 4
s_and_b32 s18, s32, 15
s_lshl_b32 s58, s17, 8
s_add_u32 s58, s58, 23408640
s_lshl_b32 s57, s18, 2
s_add_u32 s57, s57, s16
s_lshl_b32 s57, s57, 2
s_add_u32 s57, s57, s58
s_mov_b32 s56, s59
s_lshr_b32 s96, s16, 1
s_and_b32 s97, s16, 1
s_lshr_b32 s32, s18, 3
s_and_b32 s98, s18, 7
s_lshl_b32 s32, s32, 2
s_lshl_b32 s33, s97, 1
s_add_u32 s99, s32, s33
s_add_u32 s100, s99, s96
s_mul_i32 s101, s98, 5
s_lshl_b32 s32, s18, 2
s_add_u32 s32, s32, s16
s_mul_i32 s32, s32, 40960
s_add_u32 s23, s32, 0
s_mul_i32 s32, s18, 286720
s_mul_i32 s30, s16, 7168
s_add_u32 s32, s32, s30
s_add_u32 s27, s32, 3440640
s_mul_i32 s32, s98, 276480
s_add_u32 s32, s32, 8028160
s_add_u32 s60, s32, s30
s_and_b32 s61, s16, 1
s_lshl_b32 s61, s61, 10
s_add_u32 s62, s32, s61
s_add_u32 s62, s62, 28672
s_mul_i32 s32, s17, 163840
s_lshl_b32 s33, s17, 13
s_mul_i32 s34, s17, 442368
s_add_u32 s20, s32, 10268672
s_add_u32 s25, s32, 12890112
s_add_u32 s26, s32, 10268672
s_add_u32 s29, s32, 12890112
s_add_u32 s21, s33, 22589440
s_add_u32 s28, s34, 15511552
s_mov_b32 s31, 0
s_max_u32 s35, s17, 1
s_sub_u32 s35, s35, 1
s_mul_i32 s36, s35, 20480
s_add_u32 s22, s36, 22720512
s_lshl_b32 s36, s35, 10
s_add_u32 s24, s36, 23375872
s_and_b32 s36, s16, 1
s_lshr_b32 s37, s16, 1
s_lshl_b32 s36, s36, 12
v_lshlrev_b32 v8, 10, v4
v_lshlrev_b32 v9, 4, v3
v_add3_u32 v8, v8, v9, s36
s_mul_i32 s40, s18, 10
s_mul_i32 s41, s37, 5
s_add_u32 s40, s40, s41
s_add_u32 s41, s40, 0
s_lshr_b32 s44, s41, 3
s_lshl_b32 s44, s44, 13
s_and_b32 s45, s41, 3
s_lshl_b32 s45, s45, 8
s_add_u32 s44, s44, s45
s_bfe_u32 s45, s41, 0x10002
s_lshl_b32 s45, s45, 3
s_add_u32 s44, s44, s45
v_add_u32 v232, s44, v8
s_add_u32 s41, s40, 1
s_lshr_b32 s44, s41, 3
s_lshl_b32 s44, s44, 13
s_and_b32 s45, s41, 3
s_lshl_b32 s45, s45, 8
s_add_u32 s44, s44, s45
s_bfe_u32 s45, s41, 0x10002
s_lshl_b32 s45, s45, 3
s_add_u32 s44, s44, s45
v_add_u32 v233, s44, v8
s_add_u32 s41, s40, 2
s_lshr_b32 s44, s41, 3
s_lshl_b32 s44, s44, 13
s_and_b32 s45, s41, 3
s_lshl_b32 s45, s45, 8
s_add_u32 s44, s44, s45
s_bfe_u32 s45, s41, 0x10002
s_lshl_b32 s45, s45, 3
s_add_u32 s44, s44, s45
v_add_u32 v234, s44, v8
s_add_u32 s41, s40, 3
s_lshr_b32 s44, s41, 3
s_lshl_b32 s44, s44, 13
s_and_b32 s45, s41, 3
s_lshl_b32 s45, s45, 8
s_add_u32 s44, s44, s45
s_bfe_u32 s45, s41, 0x10002
s_lshl_b32 s45, s45, 3
s_add_u32 s44, s44, s45
v_add_u32 v235, s44, v8
s_add_u32 s41, s40, 4
s_lshr_b32 s44, s41, 3
s_lshl_b32 s44, s44, 13
s_and_b32 s45, s41, 3
s_lshl_b32 s45, s45, 8
s_add_u32 s44, s44, s45
s_bfe_u32 s45, s41, 0x10002
s_lshl_b32 s45, s45, 3
s_add_u32 s44, s44, s45
v_add_u32 v236, s44, v8
s_add_u32 s50, s101, 0
s_lshr_b32 s51, s50, 1
s_lshl_b32 s51, s51, 13
s_and_b32 s50, s50, 1
s_lshl_b32 s50, s50, 3
s_add_u32 s51, s51, s50
s_lshl_b32 s50, s100, 10
s_add_u32 s51, s51, s50
v_add_u32 v237, s51, v1
s_add_u32 s50, s101, 1
s_lshr_b32 s51, s50, 1
s_lshl_b32 s51, s51, 13
s_and_b32 s50, s50, 1
s_lshl_b32 s50, s50, 3
s_add_u32 s51, s51, s50
s_lshl_b32 s50, s100, 10
s_add_u32 s51, s51, s50
v_add_u32 v238, s51, v1
s_add_u32 s50, s101, 2
s_lshr_b32 s51, s50, 1
s_lshl_b32 s51, s51, 13
s_and_b32 s50, s50, 1
s_lshl_b32 s50, s50, 3
s_add_u32 s51, s51, s50
s_lshl_b32 s50, s100, 10
s_add_u32 s51, s51, s50
v_add_u32 v239, s51, v1
s_add_u32 s50, s101, 3
s_lshr_b32 s51, s50, 1
s_lshl_b32 s51, s51, 13
s_and_b32 s50, s50, 1
s_lshl_b32 s50, s50, 3
s_add_u32 s51, s51, s50
s_lshl_b32 s50, s100, 10
s_add_u32 s51, s51, s50
v_add_u32 v240, s51, v1
s_add_u32 s50, s101, 4
s_lshr_b32 s51, s50, 1
s_lshl_b32 s51, s51, 13
s_and_b32 s50, s50, 1
s_lshl_b32 s50, s50, 3
s_add_u32 s51, s51, s50
s_lshl_b32 s50, s100, 10
s_add_u32 s51, s51, s50
v_add_u32 v241, s51, v1
s_lshl_b32 s36, s16, 3
s_add_u32 s36, s36, 0
v_add_u32 v8, s36, v4
v_mul_u32_u24 v9, 52, v8
v_lshrrev_b32 v9, 8, v9
v_mul_u32_u24 v10, 5, v9
v_sub_u32 v10, v8, v10
v_mul_u32_u24 v9, 48, v9
v_lshlrev_b32 v10, 3, v10
v_add_u32 v9, v9, v10
v_mul_u32_u24 v10, 304, v3
v_add_u32 v252, v9, v10
s_lshl_b32 s36, s16, 3
s_add_u32 s36, s36, 4
v_add_u32 v8, s36, v4
v_mul_u32_u24 v9, 52, v8
v_lshrrev_b32 v9, 8, v9
v_mul_u32_u24 v10, 5, v9
v_sub_u32 v10, v8, v10
v_mul_u32_u24 v9, 48, v9
v_lshlrev_b32 v10, 3, v10
v_add_u32 v9, v9, v10
v_mul_u32_u24 v10, 304, v3
v_add_u32 v253, v9, v10
s_lshr_b32 s51, s98, 1
s_lshl_b32 s51, s51, 8
s_and_b32 s50, s98, 1
s_lshl_b32 s50, s50, 3
s_add_u32 s51, s51, s50
s_lshl_b32 s50, s100, 10
s_add_u32 s51, s51, s50
v_lshlrev_b32 v251, 4, v3
v_add_u32 v251, s51, v251
s_mul_i32 s48, s18, 7
s_lshl_b32 s49, s16, 11
s_add_u32 s50, s48, 0
s_lshr_b32 s51, s50, 1
s_lshl_b32 s51, s51, 13
s_and_b32 s52, s50, 1
s_lshl_b32 s52, s52, 3
s_add_u32 s51, s51, s52
s_add_u32 s51, s51, s49
v_add_u32 v242, s51, v1
s_add_u32 s50, s48, 1
s_lshr_b32 s51, s50, 1
s_lshl_b32 s51, s51, 13
s_and_b32 s52, s50, 1
s_lshl_b32 s52, s52, 3
s_add_u32 s51, s51, s52
s_add_u32 s51, s51, s49
v_add_u32 v243, s51, v1
s_add_u32 s50, s48, 2
s_lshr_b32 s51, s50, 1
s_lshl_b32 s51, s51, 13
s_and_b32 s52, s50, 1
s_lshl_b32 s52, s52, 3
s_add_u32 s51, s51, s52
s_add_u32 s51, s51, s49
v_add_u32 v244, s51, v1
s_add_u32 s50, s48, 3
s_lshr_b32 s51, s50, 1
s_lshl_b32 s51, s51, 13
s_and_b32 s52, s50, 1
s_lshl_b32 s52, s52, 3
s_add_u32 s51, s51, s52
s_add_u32 s51, s51, s49
s_cmp_ge_u32 s50, 108
s_cselect_b32 s51, 1073741824, s51
v_add_u32 v245, s51, v1
s_add_u32 s50, s48, 4
s_lshr_b32 s51, s50, 1
s_lshl_b32 s51, s51, 13
s_and_b32 s52, s50, 1
s_lshl_b32 s52, s52, 3
s_add_u32 s51, s51, s52
s_add_u32 s51, s51, s49
s_cmp_ge_u32 s50, 108
s_cselect_b32 s51, 1073741824, s51
v_add_u32 v246, s51, v1
s_add_u32 s50, s48, 5
s_lshr_b32 s51, s50, 1
s_lshl_b32 s51, s51, 13
s_and_b32 s52, s50, 1
s_lshl_b32 s52, s52, 3
s_add_u32 s51, s51, s52
s_add_u32 s51, s51, s49
s_cmp_ge_u32 s50, 108
s_cselect_b32 s51, 1073741824, s51
v_add_u32 v247, s51, v1
s_add_u32 s50, s48, 6
s_lshr_b32 s51, s50, 1
s_lshl_b32 s51, s51, 13
s_and_b32 s52, s50, 1
s_lshl_b32 s52, s52, 3
s_add_u32 s51, s51, s52
s_add_u32 s51, s51, s49
s_cmp_ge_u32 s50, 108
s_cselect_b32 s51, 1073741824, s51
v_add_u32 v248, s51, v1
s_cmp_eq_u32 s16, 0
s_cbranch_scc1 L_ps0_47
buffer_store_dwordx2 v[16:17], v232, s[8:11], s25 offen
buffer_store_dwordx2 v[18:19], v233, s[8:11], s25 offen
buffer_store_dwordx2 v[20:21], v234, s[8:11], s25 offen
buffer_store_dwordx2 v[22:23], v235, s[8:11], s25 offen
buffer_store_dwordx2 v[24:25], v236, s[8:11], s25 offen
buffer_store_dwordx2 v[16:17], v242, s[8:11], s28 offen offset:0
buffer_store_dwordx2 v[16:17], v242, s[8:11], s28 offen offset:1024
buffer_store_dwordx2 v[16:17], v243, s[8:11], s28 offen offset:0
buffer_store_dwordx2 v[16:17], v243, s[8:11], s28 offen offset:1024
buffer_store_dwordx2 v[16:17], v244, s[8:11], s28 offen offset:0
buffer_store_dwordx2 v[16:17], v244, s[8:11], s28 offen offset:1024
buffer_store_dwordx2 v[16:17], v245, s[8:11], s28 offen offset:0
buffer_store_dwordx2 v[16:17], v245, s[8:11], s28 offen offset:1024
buffer_store_dwordx2 v[16:17], v246, s[8:11], s28 offen offset:0
buffer_store_dwordx2 v[16:17], v246, s[8:11], s28 offen offset:1024
buffer_store_dwordx2 v[16:17], v247, s[8:11], s28 offen offset:0
buffer_store_dwordx2 v[16:17], v247, s[8:11], s28 offen offset:1024
buffer_store_dwordx2 v[16:17], v248, s[8:11], s28 offen offset:0
buffer_store_dwordx2 v[16:17], v248, s[8:11], s28 offen offset:1024
L_ps0_47:
s_cmp_lg_u32 s16, 0
s_cbranch_scc1 L_pp_49
s_mov_b64 s[38:39], exec
s_lshr_b32 s40, s18, 1
s_mul_i32 s40, s40, 20
s_add_u32 s40, s40, 108
v_add_u32 v12, s40, v2
s_lshl_b32 s41, s17, 2
s_add_u32 s41, s41, 247
v_add_u32 v13, s41, v2
v_max_u32 v13, 268, v13
v_cmp_gt_u32 vcc, 20, v2
s_nop 1
v_cndmask_b32 v12, v13, v12, vcc
v_lshlrev_b32 v12, 2, v12
v_add_u32 v12, 23418880, v12
s_mov_b64 exec, 0x1ffffff
s_mov_b32 s41, 0
L_ppoll_50:
buffer_load_dword v20, v12, s[8:11], 0 offen sc1
s_waitcnt vmcnt(0)
v_xor_b32 v20, s59, v20
v_cmp_ne_u32 vcc, 0, v20
s_add_u32 s41, s41, 1
s_cmp_gt_u32 s41, 40000
s_cbranch_scc1 L_ppolld_51
s_cbranch_vccnz L_ppoll_50
L_ppolld_51:
s_mov_b64 exec, s[38:39]
L_pp_49:
s_cmp_lg_u32 s16, 0
s_cbranch_scc1 L_ps1_48
buffer_store_dwordx2 v[16:17], v232, s[8:11], s25 offen
buffer_store_dwordx2 v[18:19], v233, s[8:11], s25 offen
buffer_store_dwordx2 v[20:21], v234, s[8:11], s25 offen
buffer_store_dwordx2 v[22:23], v235, s[8:11], s25 offen
buffer_store_dwordx2 v[24:25], v236, s[8:11], s25 offen
buffer_store_dwordx2 v[16:17], v242, s[8:11], s28 offen offset:0
buffer_store_dwordx2 v[16:17], v242, s[8:11], s28 offen offset:1024
buffer_store_dwordx2 v[16:17], v243, s[8:11], s28 offen offset:0
buffer_store_dwordx2 v[16:17], v243, s[8:11], s28 offen offset:1024
buffer_store_dwordx2 v[16:17], v244, s[8:11], s28 offen offset:0
buffer_store_dwordx2 v[16:17], v244, s[8:11], s28 offen offset:1024
buffer_store_dwordx2 v[16:17], v245, s[8:11], s28 offen offset:0
buffer_store_dwordx2 v[16:17], v245, s[8:11], s28 offen offset:1024
buffer_store_dwordx2 v[16:17], v246, s[8:11], s28 offen offset:0
buffer_store_dwordx2 v[16:17], v246, s[8:11], s28 offen offset:1024
buffer_store_dwordx2 v[16:17], v247, s[8:11], s28 offen offset:0
buffer_store_dwordx2 v[16:17], v247, s[8:11], s28 offen offset:1024
buffer_store_dwordx2 v[16:17], v248, s[8:11], s28 offen offset:0
buffer_store_dwordx2 v[16:17], v248, s[8:11], s28 offen offset:1024
L_ps1_48:
s_barrier
s_lshl_b32 s34, s16, 13
s_add_u32 s35, s34, s20
s_add_u32 s34, s34, 0
s_add_u32 m0, s34, 0
s_add_u32 s36, s35, 0
s_nop 0
buffer_load_dwordx4 v1, s[8:11], s36 offen offset:0 sc1 lds
buffer_load_dwordx4 v1, s[8:11], s36 offen offset:1024 sc1 lds
buffer_load_dwordx4 v1, s[8:11], s36 offen offset:2048 sc1 lds
buffer_load_dwordx4 v1, s[8:11], s36 offen offset:3072 sc1 lds
s_add_u32 m0, s34, 4096
s_add_u32 s36, s35, 4096
buffer_load_dwordx4 v1, s[8:11], s36 offen offset:0 sc1 lds
buffer_load_dwordx4 v1, s[8:11], s36 offen offset:1024 sc1 lds
buffer_load_dwordx4 v1, s[8:11], s36 offen offset:2048 sc1 lds
buffer_load_dwordx4 v1, s[8:11], s36 offen offset:3072 sc1 lds
s_add_u32 s37, s23, 0
buffer_load_dwordx4 a[0:3], v1, s[8:11], s37 offen offset:0
s_add_u32 s37, s23, 0
buffer_load_dwordx4 a[4:7], v1, s[8:11], s37 offen offset:1024
s_add_u32 s37, s23, 2048
buffer_load_dwordx4 a[8:11], v1, s[8:11], s37 offen offset:0
s_add_u32 s37, s23, 2048
buffer_load_dwordx4 a[12:15], v1, s[8:11], s37 offen offset:1024
s_add_u32 s37, s23, 4096
buffer_load_dwordx4 a[16:19], v1, s[8:11], s37 offen offset:0
s_add_u32 s37, s23, 4096
buffer_load_dwordx4 a[20:23], v1, s[8:11], s37 offen offset:1024
s_add_u32 s37, s23, 6144
buffer_load_dwordx4 a[24:27], v1, s[8:11], s37 offen offset:0
s_add_u32 s37, s23, 6144
buffer_load_dwordx4 a[28:31], v1, s[8:11], s37 offen offset:1024
s_add_u32 m0, s34, 32768
s_add_u32 s36, s35, 32768
buffer_load_dwordx4 v1, s[8:11], s36 offen offset:0 sc1 lds
buffer_load_dwordx4 v1, s[8:11], s36 offen offset:1024 sc1 lds
buffer_load_dwordx4 v1, s[8:11], s36 offen offset:2048 sc1 lds
buffer_load_dwordx4 v1, s[8:11], s36 offen offset:3072 sc1 lds
s_add_u32 m0, s34, 36864
s_add_u32 s36, s35, 36864
buffer_load_dwordx4 v1, s[8:11], s36 offen offset:0 sc1 lds
buffer_load_dwordx4 v1, s[8:11], s36 offen offset:1024 sc1 lds
buffer_load_dwordx4 v1, s[8:11], s36 offen offset:2048 sc1 lds
buffer_load_dwordx4 v1, s[8:11], s36 offen offset:3072 sc1 lds
s_lshl_b32 s33, s16, 10
s_add_u32 s33, s33, s21
buffer_load_dwordx4 v[8:11], v1, s[8:11], s33 offen sc1
s_add_u32 s33, s33, 4096
buffer_load_dwordx4 v[12:15], v1, s[8:11], s33 offen sc1
v_lshrrev_b32 v28, 2, v0
v_lshlrev_b32 v28, 10, v28
v_and_b32 v29, 3, v0
v_lshlrev_b32 v29, 8, v29
v_add3_u32 v28, v28, v29, 0
v_add_u32 v28, 143360, v28
v_mov_b32 v16, 0x3f803f80
v_mov_b32 v17, 0x3f803f80
v_mov_b32 v18, 0x3f803f80
v_mov_b32 v19, 0x3f803f80
v_cmp_gt_u32 vcc, 80, v0
s_and_saveexec_b64 s[38:39], vcc
s_cbranch_execz L_g1ones_52
ds_write_b128 v28, v[16:19]
L_g1ones_52:
s_mov_b64 exec, s[38:39]
buffer_load_dwordx2 a[246:247], v237, s[8:11], s20 offen
buffer_load_dwordx2 a[248:249], v238, s[8:11], s20 offen
buffer_load_dwordx2 a[250:251], v239, s[8:11], s20 offen
buffer_load_dwordx2 a[252:253], v240, s[8:11], s20 offen
buffer_load_dwordx2 a[254:255], v241, s[8:11], s20 offen
v_add_u32 v5, 0, v1
v_add_u32 v6, 65536, v1
v_add_u32 v7, 143360, v1
s_waitcnt vmcnt(23)
s_barrier
s_cmp_lg_u32 s16, 0
s_cbranch_scc1 L_bflag_53
s_cmp_eq_u32 s19, 0xffff
s_cbranch_scc1 L_bflag_53
s_lshl_b32 s40, s19, 2
s_add_u32 s40, s40, 23418880
v_mov_b32 v30, s40
v_mov_b32 v31, s59
s_mov_b64 s[38:39], exec
s_mov_b64 exec, 1
buffer_store_dword v31, v30, s[8:11], 0 offen sc1
s_mov_b64 exec, s[38:39]
s_nop 0
L_bflag_53:
ds_read_b128 v[104:107], v5 offset:0
ds_read_b128 v[108:111], v5 offset:1024
ds_read_b128 v[112:115], v5 offset:2048
ds_read_b128 v[116:119], v5 offset:3072
ds_read_b128 v[120:123], v5 offset:4096
ds_read_b128 v[124:127], v5 offset:5120
s_waitcnt lgkmcnt(5) vmcnt(21)
v_mfma_f32_16x16x32_bf16 v[40:43], a[0:3], v[104:107], 0
ds_read_b128 v[128:131], v5 offset:6144
s_add_u32 s37, s23, 8192
v_mfma_f32_16x16x32_bf16 v[44:47], a[4:7], v[104:107], 0
s_waitcnt lgkmcnt(5)
buffer_load_dwordx4 a[32:35], v1, s[8:11], s37 offen offset:0
v_mfma_f32_16x16x32_bf16 v[48:51], a[0:3], v[108:111], 0
ds_read_b128 v[104:107], v5 offset:7168
v_mfma_f32_16x16x32_bf16 v[52:55], a[4:7], v[108:111], 0
s_waitcnt lgkmcnt(5)
v_mfma_f32_16x16x32_bf16 v[56:59], a[0:3], v[112:115], 0
ds_read_b128 v[108:111], v5 offset:8192
s_add_u32 s37, s23, 8192
v_mfma_f32_16x16x32_bf16 v[60:63], a[4:7], v[112:115], 0
s_waitcnt lgkmcnt(5)
buffer_load_dwordx4 a[36:39], v1, s[8:11], s37 offen offset:1024
v_mfma_f32_16x16x32_bf16 v[64:67], a[0:3], v[116:119], 0
ds_read_b128 v[112:115], v5 offset:9216
v_mfma_f32_16x16x32_bf16 v[68:71], a[4:7], v[116:119], 0
s_waitcnt lgkmcnt(5)
v_mfma_f32_16x16x32_bf16 v[72:75], a[0:3], v[120:123], 0
ds_read_b128 v[116:119], v5 offset:10240
s_add_u32 s37, s23, 10240
v_mfma_f32_16x16x32_bf16 v[76:79], a[4:7], v[120:123], 0
s_waitcnt lgkmcnt(5)
buffer_load_dwordx4 a[40:43], v1, s[8:11], s37 offen offset:0
v_mfma_f32_16x16x32_bf16 v[80:83], a[0:3], v[124:127], 0
ds_read_b128 v[120:123], v5 offset:11264
v_mfma_f32_16x16x32_bf16 v[84:87], a[4:7], v[124:127], 0
s_waitcnt lgkmcnt(5)
v_mfma_f32_16x16x32_bf16 v[88:91], a[0:3], v[128:131], 0
ds_read_b128 v[124:127], v5 offset:12288
s_add_u32 s37, s23, 10240
v_mfma_f32_16x16x32_bf16 v[92:95], a[4:7], v[128:131], 0
s_waitcnt lgkmcnt(5)
buffer_load_dwordx4 a[44:47], v1, s[8:11], s37 offen offset:1024
v_mfma_f32_16x16x32_bf16 v[96:99], a[0:3], v[104:107], 0
ds_read_b128 v[128:131], v5 offset:13312
v_mfma_f32_16x16x32_bf16 v[100:103], a[4:7], v[104:107], 0
s_waitcnt lgkmcnt(5) vmcnt(23)
v_mfma_f32_16x16x32_bf16 v[40:43], a[8:11], v[108:111], v[40:43]
ds_read_b128 v[104:107], v5 offset:14336
s_add_u32 s37, s23, 12288
v_mfma_f32_16x16x32_bf16 v[44:47], a[12:15], v[108:111], v[44:47]
s_waitcnt lgkmcnt(5)
buffer_load_dwordx4 a[48:51], v1, s[8:11], s37 offen offset:0
v_mfma_f32_16x16x32_bf16 v[48:51], a[8:11], v[112:115], v[48:51]
ds_read_b128 v[108:111], v5 offset:15360
v_mfma_f32_16x16x32_bf16 v[52:55], a[12:15], v[112:115], v[52:55]
s_waitcnt lgkmcnt(5)
v_mfma_f32_16x16x32_bf16 v[56:59], a[8:11], v[116:119], v[56:59]
ds_read_b128 v[112:115], v5 offset:16384
s_add_u32 s37, s23, 12288
v_mfma_f32_16x16x32_bf16 v[60:63], a[12:15], v[116:119], v[60:63]
s_waitcnt lgkmcnt(5)
buffer_load_dwordx4 a[52:55], v1, s[8:11], s37 offen offset:1024
v_mfma_f32_16x16x32_bf16 v[64:67], a[8:11], v[120:123], v[64:67]
ds_read_b128 v[116:119], v5 offset:17408
v_mfma_f32_16x16x32_bf16 v[68:71], a[12:15], v[120:123], v[68:71]
s_waitcnt lgkmcnt(5)
v_mfma_f32_16x16x32_bf16 v[72:75], a[8:11], v[124:127], v[72:75]
ds_read_b128 v[120:123], v5 offset:18432
s_add_u32 s37, s23, 14336
v_mfma_f32_16x16x32_bf16 v[76:79], a[12:15], v[124:127], v[76:79]
s_waitcnt lgkmcnt(5)
buffer_load_dwordx4 a[56:59], v1, s[8:11], s37 offen offset:0
v_mfma_f32_16x16x32_bf16 v[80:83], a[8:11], v[128:131], v[80:83]
ds_read_b128 v[124:127], v5 offset:19456
v_mfma_f32_16x16x32_bf16 v[84:87], a[12:15], v[128:131], v[84:87]
s_waitcnt lgkmcnt(5)
v_mfma_f32_16x16x32_bf16 v[88:91], a[8:11], v[104:107], v[88:91]
ds_read_b128 v[128:131], v5 offset:20480
s_add_u32 s37, s23, 14336
v_mfma_f32_16x16x32_bf16 v[92:95], a[12:15], v[104:107], v[92:95]
s_waitcnt lgkmcnt(5)
buffer_load_dwordx4 a[60:63], v1, s[8:11], s37 offen offset:1024
v_mfma_f32_16x16x32_bf16 v[96:99], a[8:11], v[108:111], v[96:99]
ds_read_b128 v[104:107], v5 offset:21504
v_mfma_f32_16x16x32_bf16 v[100:103], a[12:15], v[108:111], v[100:103]
s_waitcnt lgkmcnt(5) vmcnt(25)
v_mfma_f32_16x16x32_bf16 v[40:43], a[16:19], v[112:115], v[40:43]
ds_read_b128 v[108:111], v5 offset:22528
s_add_u32 m0, s34, 65536
v_mfma_f32_16x16x32_bf16 v[44:47], a[20:23], v[112:115], v[44:47]
s_waitcnt lgkmcnt(5)
s_add_u32 s36, s35, 65536
v_mfma_f32_16x16x32_bf16 v[48:51], a[16:19], v[116:119], v[48:51]
ds_read_b128 v[112:115], v5 offset:23552
buffer_load_dwordx4 v1, s[8:11], s36 offen offset:0 sc1 lds
v_mfma_f32_16x16x32_bf16 v[52:55], a[20:23], v[116:119], v[52:55]
s_waitcnt lgkmcnt(5)
v_mfma_f32_16x16x32_bf16 v[56:59], a[16:19], v[120:123], v[56:59]
ds_read_b128 v[116:119], v5 offset:24576
buffer_load_dwordx4 v1, s[8:11], s36 offen offset:1024 sc1 lds
v_mfma_f32_16x16x32_bf16 v[60:63], a[20:23], v[120:123], v[60:63]
s_waitcnt lgkmcnt(5)
v_mfma_f32_16x16x32_bf16 v[64:67], a[16:19], v[124:127], v[64:67]
ds_read_b128 v[120:123], v5 offset:25600
v_mfma_f32_16x16x32_bf16 v[68:71], a[20:23], v[124:127], v[68:71]
s_waitcnt lgkmcnt(5)
v_mfma_f32_16x16x32_bf16 v[72:75], a[16:19], v[128:131], v[72:75]
ds_read_b128 v[124:127], v5 offset:26624
s_waitcnt vmcnt(15)
v_mfma_f32_16x16x32_bf16 v[76:79], a[20:23], v[128:131], v[76:79]
s_waitcnt lgkmcnt(5)
v_mfma_f32_16x16x32_bf16 v[80:83], a[16:19], v[104:107], v[80:83]
ds_read_b128 v[128:131], v5 offset:27648
buffer_load_dwordx4 v1, s[8:11], s36 offen offset:2048 sc1 lds
v_mfma_f32_16x16x32_bf16 v[84:87], a[20:23], v[104:107], v[84:87]
s_waitcnt lgkmcnt(5)
v_mfma_f32_16x16x32_bf16 v[88:91], a[16:19], v[108:111], v[88:91]
ds_read_b128 v[104:107], v5 offset:28672
v_add_f32 v24, v8, v10
v_mfma_f32_16x16x32_bf16 v[92:95], a[20:23], v[108:111], v[92:95]
s_waitcnt lgkmcnt(5)
v_add_f32 v25, v9, v11
v_mfma_f32_16x16x32_bf16 v[96:99], a[16:19], v[112:115], v[96:99]
ds_read_b128 v[108:111], v5 offset:29696
v_add_f32 v26, v12, v14
v_mfma_f32_16x16x32_bf16 v[100:103], a[20:23], v[112:115], v[100:103]
s_waitcnt lgkmcnt(5)
v_add_f32 v27, v13, v15
v_mfma_f32_16x16x32_bf16 v[40:43], a[24:27], v[116:119], v[40:43]
ds_read_b128 v[112:115], v5 offset:30720
v_mov_b32 v28, v24
v_mfma_f32_16x16x32_bf16 v[44:47], a[28:31], v[116:119], v[44:47]
s_waitcnt lgkmcnt(5)
v_mov_b32 v29, v25
v_mfma_f32_16x16x32_bf16 v[48:51], a[24:27], v[120:123], v[48:51]
ds_read_b128 v[116:119], v5 offset:31744
v_mov_b32 v30, v26
v_mfma_f32_16x16x32_bf16 v[52:55], a[28:31], v[120:123], v[52:55]
s_waitcnt lgkmcnt(5)
v_mov_b32 v31, v27
v_mfma_f32_16x16x32_bf16 v[56:59], a[24:27], v[124:127], v[56:59]
s_barrier
ds_read_b128 v[120:123], v5 offset:32768
buffer_load_dwordx4 v1, s[8:11], s36 offen offset:3072 sc1 lds
v_mfma_f32_16x16x32_bf16 v[60:63], a[28:31], v[124:127], v[60:63]
s_waitcnt lgkmcnt(5)
s_nop 1
v_mfma_f32_16x16x32_bf16 v[64:67], a[24:27], v[128:131], v[64:67]
ds_read_b128 v[124:127], v5 offset:33792
v_permlane16_swap_b32 v24, v28
v_mfma_f32_16x16x32_bf16 v[68:71], a[28:31], v[128:131], v[68:71]
s_waitcnt lgkmcnt(5)
v_permlane16_swap_b32 v25, v29
v_mfma_f32_16x16x32_bf16 v[72:75], a[24:27], v[104:107], v[72:75]
ds_read_b128 v[128:131], v5 offset:34816
v_permlane16_swap_b32 v26, v30
v_mfma_f32_16x16x32_bf16 v[76:79], a[28:31], v[104:107], v[76:79]
s_waitcnt lgkmcnt(5)
v_permlane16_swap_b32 v27, v31
v_mfma_f32_16x16x32_bf16 v[80:83], a[24:27], v[108:111], v[80:83]
ds_read_b128 v[104:107], v5 offset:35840
s_add_u32 m0, s34, 69632
v_mfma_f32_16x16x32_bf16 v[84:87], a[28:31], v[108:111], v[84:87]
s_waitcnt lgkmcnt(5)
s_add_u32 s36, s35, 69632
v_mfma_f32_16x16x32_bf16 v[88:91], a[24:27], v[112:115], v[88:91]
ds_read_b128 v[108:111], v5 offset:36864
buffer_load_dwordx4 v1, s[8:11], s36 offen offset:0 sc1 lds
v_mfma_f32_16x16x32_bf16 v[92:95], a[28:31], v[112:115], v[92:95]
s_waitcnt lgkmcnt(5)
s_nop 1
v_mfma_f32_16x16x32_bf16 v[96:99], a[24:27], v[116:119], v[96:99]
ds_read_b128 v[112:115], v5 offset:37888
v_add_f32 v24, v24, v28
v_mfma_f32_16x16x32_bf16 v[100:103], a[28:31], v[116:119], v[100:103]
s_waitcnt lgkmcnt(5) vmcnt(11)
v_add_f32 v25, v25, v29
v_mfma_f32_16x16x32_bf16 v[40:43], a[32:35], v[120:123], v[40:43]
ds_read_b128 v[116:119], v5 offset:38912
v_add_f32 v26, v26, v30
v_mfma_f32_16x16x32_bf16 v[44:47], a[36:39], v[120:123], v[44:47]
s_waitcnt lgkmcnt(5)
v_add_f32 v27, v27, v31
v_mfma_f32_16x16x32_bf16 v[48:51], a[32:35], v[124:127], v[48:51]
ds_read_b128 v[120:123], v5 offset:39936
v_mov_b32 v28, v24
v_mfma_f32_16x16x32_bf16 v[52:55], a[36:39], v[124:127], v[52:55]
s_waitcnt lgkmcnt(5)
v_mov_b32 v29, v25
v_mfma_f32_16x16x32_bf16 v[56:59], a[32:35], v[128:131], v[56:59]
ds_read_b128 v[124:127], v5 offset:40960
v_mov_b32 v30, v26
v_mfma_f32_16x16x32_bf16 v[60:63], a[36:39], v[128:131], v[60:63]
s_waitcnt lgkmcnt(5)
v_mov_b32 v31, v27
v_mfma_f32_16x16x32_bf16 v[64:67], a[32:35], v[104:107], v[64:67]
ds_read_b128 v[128:131], v5 offset:41984
buffer_load_dwordx4 v1, s[8:11], s36 offen offset:1024 sc1 lds
v_mfma_f32_16x16x32_bf16 v[68:71], a[36:39], v[104:107], v[68:71]
s_waitcnt lgkmcnt(5)
s_nop 1
v_mfma_f32_16x16x32_bf16 v[72:75], a[32:35], v[108:111], v[72:75]
ds_read_b128 v[104:107], v5 offset:43008
v_permlane32_swap_b32 v24, v28
v_mfma_f32_16x16x32_bf16 v[76:79], a[36:39], v[108:111], v[76:79]
s_waitcnt lgkmcnt(5)
v_permlane32_swap_b32 v25, v29
v_mfma_f32_16x16x32_bf16 v[80:83], a[32:35], v[112:115], v[80:83]
ds_read_b128 v[108:111], v5 offset:44032
v_permlane32_swap_b32 v26, v30
v_mfma_f32_16x16x32_bf16 v[84:87], a[36:39], v[112:115], v[84:87]
s_waitcnt lgkmcnt(5)
v_permlane32_swap_b32 v27, v31
v_mfma_f32_16x16x32_bf16 v[88:91], a[32:35], v[116:119], v[88:91]
ds_read_b128 v[112:115], v5 offset:45056
buffer_load_dwordx4 v1, s[8:11], s36 offen offset:2048 sc1 lds
v_mfma_f32_16x16x32_bf16 v[92:95], a[36:39], v[116:119], v[92:95]
s_waitcnt lgkmcnt(5)
s_nop 1
v_mfma_f32_16x16x32_bf16 v[96:99], a[32:35], v[120:123], v[96:99]
ds_read_b128 v[116:119], v5 offset:46080
v_add_f32 v24, v24, v28
v_mfma_f32_16x16x32_bf16 v[100:103], a[36:39], v[120:123], v[100:103]
s_waitcnt lgkmcnt(5) vmcnt(11)
v_add_f32 v25, v25, v29
v_mfma_f32_16x16x32_bf16 v[40:43], a[40:43], v[124:127], v[40:43]
ds_read_b128 v[120:123], v5 offset:47104
v_add_f32 v26, v26, v30
v_mfma_f32_16x16x32_bf16 v[44:47], a[44:47], v[124:127], v[44:47]
s_waitcnt lgkmcnt(5)
v_add_f32 v27, v27, v31
v_mfma_f32_16x16x32_bf16 v[48:51], a[40:43], v[128:131], v[48:51]
ds_read_b128 v[124:127], v5 offset:48128
v_mul_f32 v24, 0.0015625, v24
v_mfma_f32_16x16x32_bf16 v[52:55], a[44:47], v[128:131], v[52:55]
s_waitcnt lgkmcnt(5)
v_mul_f32 v25, 0.0015625, v25
v_mfma_f32_16x16x32_bf16 v[56:59], a[40:43], v[104:107], v[56:59]
ds_read_b128 v[128:131], v5 offset:49152
v_mul_f32 v26, 0.0015625, v26
v_mfma_f32_16x16x32_bf16 v[60:63], a[44:47], v[104:107], v[60:63]
s_waitcnt lgkmcnt(5)
v_mul_f32 v27, 0.0015625, v27
v_mfma_f32_16x16x32_bf16 v[64:67], a[40:43], v[108:111], v[64:67]
ds_read_b128 v[104:107], v5 offset:50176
buffer_load_dwordx4 v1, s[8:11], s36 offen offset:3072 sc1 lds
v_mfma_f32_16x16x32_bf16 v[68:71], a[44:47], v[108:111], v[68:71]
s_waitcnt lgkmcnt(5)
v_fma_f32 v25, -v24, v24, v25
v_mfma_f32_16x16x32_bf16 v[72:75], a[40:43], v[112:115], v[72:75]
ds_read_b128 v[108:111], v5 offset:51200
v_max_f32 v25, 0, v25
v_mfma_f32_16x16x32_bf16 v[76:79], a[44:47], v[112:115], v[76:79]
s_waitcnt lgkmcnt(5)
v_add_f32 v25, 0x3727c5ac, v25
v_mfma_f32_16x16x32_bf16 v[80:83], a[40:43], v[116:119], v[80:83]
ds_read_b128 v[112:115], v5 offset:52224
v_rsq_f32 v25, v25
v_mfma_f32_16x16x32_bf16 v[84:87], a[44:47], v[116:119], v[84:87]
s_waitcnt lgkmcnt(5)
v_fma_f32 v27, -v26, v26, v27
v_mfma_f32_16x16x32_bf16 v[88:91], a[40:43], v[120:123], v[88:91]
ds_read_b128 v[116:119], v5 offset:53248
v_max_f32 v27, 0, v27
v_mfma_f32_16x16x32_bf16 v[92:95], a[44:47], v[120:123], v[92:95]
s_waitcnt lgkmcnt(5)
v_add_f32 v27, 0x3727c5ac, v27
v_mfma_f32_16x16x32_bf16 v[96:99], a[40:43], v[124:127], v[96:99]
ds_read_b128 v[120:123], v5 offset:54272
v_rsq_f32 v27, v27
v_mfma_f32_16x16x32_bf16 v[100:103], a[44:47], v[124:127], v[100:103]
s_waitcnt lgkmcnt(5) vmcnt(10)
s_nop 0
v_mfma_f32_16x16x32_bf16 v[40:43], a[48:51], v[128:131], v[40:43]
ds_read_b128 v[124:127], v5 offset:55296
s_add_u32 s37, s23, 16384
v_mfma_f32_16x16x32_bf16 v[44:47], a[52:55], v[128:131], v[44:47]
s_waitcnt lgkmcnt(5)
buffer_load_dwordx4 a[64:67], v1, s[8:11], s37 offen offset:0
v_mfma_f32_16x16x32_bf16 v[48:51], a[48:51], v[104:107], v[48:51]
ds_read_b128 v[128:131], v5 offset:56320
s_lshl_b32 s33, s16, 7
s_add_u32 s33, s33, 131200
v_lshlrev_b32 v16, 3, v3
v_add_u32 v16, s33, v16
s_mov_b64 s[38:39], exec
s_mov_b64 exec, 0xffff
ds_write_b64 v16, v[24:25]
ds_write_b64 v16, v[26:27] offset:512
s_mov_b64 exec, s[38:39]
v_mfma_f32_16x16x32_bf16 v[52:55], a[52:55], v[104:107], v[52:55]
s_waitcnt lgkmcnt(7)
s_add_u32 s37, s23, 16384
v_mfma_f32_16x16x32_bf16 v[56:59], a[48:51], v[108:111], v[56:59]
ds_read_b128 v[104:107], v5 offset:57344
buffer_load_dwordx4 a[68:71], v1, s[8:11], s37 offen offset:1024
v_mfma_f32_16x16x32_bf16 v[60:63], a[52:55], v[108:111], v[60:63]
s_waitcnt lgkmcnt(7)
s_add_u32 s37, s23, 18432
v_mfma_f32_16x16x32_bf16 v[64:67], a[48:51], v[112:115], v[64:67]
ds_read_b128 v[108:111], v5 offset:58368
buffer_load_dwordx4 a[72:75], v1, s[8:11], s37 offen offset:0
v_mfma_f32_16x16x32_bf16 v[68:71], a[52:55], v[112:115], v[68:71]
s_waitcnt lgkmcnt(7)
s_add_u32 s37, s23, 18432
v_mfma_f32_16x16x32_bf16 v[72:75], a[48:51], v[116:119], v[72:75]
ds_read_b128 v[112:115], v5 offset:59392
buffer_load_dwordx4 a[76:79], v1, s[8:11], s37 offen offset:1024
v_mfma_f32_16x16x32_bf16 v[76:79], a[52:55], v[116:119], v[76:79]
s_waitcnt lgkmcnt(7)
s_add_u32 s37, s23, 20480
v_mfma_f32_16x16x32_bf16 v[80:83], a[48:51], v[120:123], v[80:83]
ds_read_b128 v[116:119], v5 offset:60416
buffer_load_dwordx4 a[80:83], v1, s[8:11], s37 offen offset:0
v_mfma_f32_16x16x32_bf16 v[84:87], a[52:55], v[120:123], v[84:87]
s_waitcnt lgkmcnt(7)
s_add_u32 s37, s23, 20480
v_mfma_f32_16x16x32_bf16 v[88:91], a[48:51], v[124:127], v[88:91]
ds_read_b128 v[120:123], v5 offset:61440
buffer_load_dwordx4 a[84:87], v1, s[8:11], s37 offen offset:1024
v_mfma_f32_16x16x32_bf16 v[92:95], a[52:55], v[124:127], v[92:95]
s_waitcnt lgkmcnt(7)
s_add_u32 s37, s23, 22528
v_mfma_f32_16x16x32_bf16 v[96:99], a[48:51], v[128:131], v[96:99]
ds_read_b128 v[124:127], v5 offset:62464
buffer_load_dwordx4 a[88:91], v1, s[8:11], s37 offen offset:0
v_mfma_f32_16x16x32_bf16 v[100:103], a[52:55], v[128:131], v[100:103]
s_waitcnt lgkmcnt(5) vmcnt(15)
s_add_u32 s37, s23, 22528
v_mfma_f32_16x16x32_bf16 v[40:43], a[56:59], v[104:107], v[40:43]
ds_read_b128 v[128:131], v5 offset:63488
buffer_load_dwordx4 a[92:95], v1, s[8:11], s37 offen offset:1024
v_mfma_f32_16x16x32_bf16 v[44:47], a[60:63], v[104:107], v[44:47]
s_waitcnt lgkmcnt(5)
s_add_u32 m0, s34, 98304
v_mfma_f32_16x16x32_bf16 v[48:51], a[56:59], v[108:111], v[48:51]
ds_read_b128 v[104:107], v5 offset:64512
s_add_u32 s36, s35, 98304
v_mfma_f32_16x16x32_bf16 v[52:55], a[60:63], v[108:111], v[52:55]
s_waitcnt lgkmcnt(5)
buffer_load_dwordx4 v1, s[8:11], s36 offen offset:0 sc1 lds
v_mfma_f32_16x16x32_bf16 v[56:59], a[56:59], v[112:115], v[56:59]
s_waitcnt vmcnt(9)
s_barrier
ds_read_b128 v[108:111], v6 offset:0
buffer_load_dwordx4 v1, s[8:11], s36 offen offset:1024 sc1 lds
v_mfma_f32_16x16x32_bf16 v[60:63], a[60:63], v[112:115], v[60:63]
s_waitcnt lgkmcnt(5)
buffer_load_dwordx4 v1, s[8:11], s36 offen offset:2048 sc1 lds
v_mfma_f32_16x16x32_bf16 v[64:67], a[56:59], v[116:119], v[64:67]
ds_read_b128 v[112:115], v6 offset:1024
buffer_load_dwordx4 v1, s[8:11], s36 offen offset:3072 sc1 lds
v_mfma_f32_16x16x32_bf16 v[68:71], a[60:63], v[116:119], v[68:71]
s_waitcnt lgkmcnt(5)
s_add_u32 m0, s34, 102400
v_mfma_f32_16x16x32_bf16 v[72:75], a[56:59], v[120:123], v[72:75]
ds_read_b128 v[116:119], v6 offset:2048
s_add_u32 s36, s35, 102400
v_mfma_f32_16x16x32_bf16 v[76:79], a[60:63], v[120:123], v[76:79]
s_waitcnt lgkmcnt(5)
buffer_load_dwordx4 v1, s[8:11], s36 offen offset:0 sc1 lds
v_mfma_f32_16x16x32_bf16 v[80:83], a[56:59], v[124:127], v[80:83]
ds_read_b128 v[120:123], v6 offset:3072
buffer_load_dwordx4 v1, s[8:11], s36 offen offset:1024 sc1 lds
v_mfma_f32_16x16x32_bf16 v[84:87], a[60:63], v[124:127], v[84:87]
s_waitcnt lgkmcnt(5)
v_mfma_f32_16x16x32_bf16 v[88:91], a[56:59], v[128:131], v[88:91]
ds_read_b128 v[124:127], v6 offset:4096
v_mfma_f32_16x16x32_bf16 v[92:95], a[60:63], v[128:131], v[92:95]
s_waitcnt lgkmcnt(5)
v_mfma_f32_16x16x32_bf16 v[96:99], a[56:59], v[104:107], v[96:99]
ds_read_b128 v[128:131], v6 offset:5120
buffer_load_dwordx4 v1, s[8:11], s36 offen offset:2048 sc1 lds
v_mfma_f32_16x16x32_bf16 v[100:103], a[60:63], v[104:107], v[100:103]
s_waitcnt lgkmcnt(5) vmcnt(13)
v_mfma_f32_16x16x32_bf16 v[40:43], a[64:67], v[108:111], v[40:43]
ds_read_b128 v[104:107], v6 offset:6144
v_mfma_f32_16x16x32_bf16 v[44:47], a[68:71], v[108:111], v[44:47]
s_waitcnt lgkmcnt(5)
v_mfma_f32_16x16x32_bf16 v[48:51], a[64:67], v[112:115], v[48:51]
ds_read_b128 v[108:111], v6 offset:7168
buffer_load_dwordx4 v1, s[8:11], s36 offen offset:3072 sc1 lds
v_mfma_f32_16x16x32_bf16 v[52:55], a[68:71], v[112:115], v[52:55]
s_waitcnt lgkmcnt(5)
v_mfma_f32_16x16x32_bf16 v[56:59], a[64:67], v[116:119], v[56:59]
ds_read_b128 v[112:115], v6 offset:8192
v_mfma_f32_16x16x32_bf16 v[60:63], a[68:71], v[116:119], v[60:63]
s_waitcnt lgkmcnt(5)
v_mfma_f32_16x16x32_bf16 v[64:67], a[64:67], v[120:123], v[64:67]
ds_read_b128 v[116:119], v6 offset:9216
s_add_u32 s37, s23, 24576
v_mfma_f32_16x16x32_bf16 v[68:71], a[68:71], v[120:123], v[68:71]
s_waitcnt lgkmcnt(5)
buffer_load_dwordx4 a[96:99], v1, s[8:11], s37 offen offset:0
v_mfma_f32_16x16x32_bf16 v[72:75], a[64:67], v[124:127], v[72:75]
ds_read_b128 v[120:123], v6 offset:10240
v_mfma_f32_16x16x32_bf16 v[76:79], a[68:71], v[124:127], v[76:79]
s_waitcnt lgkmcnt(5)
v_mfma_f32_16x16x32_bf16 v[80:83], a[64:67], v[128:131], v[80:83]
ds_read_b128 v[124:127], v6 offset:11264
s_add_u32 s37, s23, 24576
v_mfma_f32_16x16x32_bf16 v[84:87], a[68:71], v[128:131], v[84:87]
s_waitcnt lgkmcnt(5)
buffer_load_dwordx4 a[100:103], v1, s[8:11], s37 offen offset:1024
v_mfma_f32_16x16x32_bf16 v[88:91], a[64:67], v[104:107], v[88:91]
ds_read_b128 v[128:131], v6 offset:12288
v_mfma_f32_16x16x32_bf16 v[92:95], a[68:71], v[104:107], v[92:95]
s_waitcnt lgkmcnt(5)
v_mfma_f32_16x16x32_bf16 v[96:99], a[64:67], v[108:111], v[96:99]
ds_read_b128 v[104:107], v6 offset:13312
s_add_u32 s37, s23, 26624
v_mfma_f32_16x16x32_bf16 v[100:103], a[68:71], v[108:111], v[100:103]
s_waitcnt lgkmcnt(5) vmcnt(14)
buffer_load_dwordx4 a[104:107], v1, s[8:11], s37 offen offset:0
v_mfma_f32_16x16x32_bf16 v[40:43], a[72:75], v[112:115], v[40:43]
ds_read_b128 v[108:111], v6 offset:14336
v_mfma_f32_16x16x32_bf16 v[44:47], a[76:79], v[112:115], v[44:47]
s_waitcnt lgkmcnt(5)
v_mfma_f32_16x16x32_bf16 v[48:51], a[72:75], v[116:119], v[48:51]
ds_read_b128 v[112:115], v6 offset:15360
s_add_u32 s37, s23, 26624
v_mfma_f32_16x16x32_bf16 v[52:55], a[76:79], v[116:119], v[52:55]
s_waitcnt lgkmcnt(5)
buffer_load_dwordx4 a[108:111], v1, s[8:11], s37 offen offset:1024
v_mfma_f32_16x16x32_bf16 v[56:59], a[72:75], v[120:123], v[56:59]
ds_read_b128 v[116:119], v6 offset:16384
v_mfma_f32_16x16x32_bf16 v[60:63], a[76:79], v[120:123], v[60:63]
s_waitcnt lgkmcnt(5)
v_mfma_f32_16x16x32_bf16 v[64:67], a[72:75], v[124:127], v[64:67]
ds_read_b128 v[120:123], v6 offset:17408
s_add_u32 s37, s23, 28672
v_mfma_f32_16x16x32_bf16 v[68:71], a[76:79], v[124:127], v[68:71]
s_waitcnt lgkmcnt(5)
buffer_load_dwordx4 a[112:115], v1, s[8:11], s37 offen offset:0
v_mfma_f32_16x16x32_bf16 v[72:75], a[72:75], v[128:131], v[72:75]
ds_read_b128 v[124:127], v6 offset:18432
v_mfma_f32_16x16x32_bf16 v[76:79], a[76:79], v[128:131], v[76:79]
s_waitcnt lgkmcnt(5)
v_mfma_f32_16x16x32_bf16 v[80:83], a[72:75], v[104:107], v[80:83]
ds_read_b128 v[128:131], v6 offset:19456
s_add_u32 s37, s23, 28672
v_mfma_f32_16x16x32_bf16 v[84:87], a[76:79], v[104:107], v[84:87]
s_waitcnt lgkmcnt(5)
buffer_load_dwordx4 a[116:119], v1, s[8:11], s37 offen offset:1024
v_mfma_f32_16x16x32_bf16 v[88:91], a[72:75], v[108:111], v[88:91]
ds_read_b128 v[104:107], v6 offset:20480
v_mfma_f32_16x16x32_bf16 v[92:95], a[76:79], v[108:111], v[92:95]
s_waitcnt lgkmcnt(5)
v_mfma_f32_16x16x32_bf16 v[96:99], a[72:75], v[112:115], v[96:99]
ds_read_b128 v[108:111], v6 offset:21504
v_mfma_f32_16x16x32_bf16 v[100:103], a[76:79], v[112:115], v[100:103]
s_waitcnt lgkmcnt(5) vmcnt(16)
v_mfma_f32_16x16x32_bf16 v[40:43], a[80:83], v[116:119], v[40:43]
ds_read_b128 v[112:115], v6 offset:22528
s_add_u32 s37, s23, 30720
v_mfma_f32_16x16x32_bf16 v[44:47], a[84:87], v[116:119], v[44:47]
s_waitcnt lgkmcnt(5)
buffer_load_dwordx4 a[120:123], v1, s[8:11], s37 offen offset:0
v_mfma_f32_16x16x32_bf16 v[48:51], a[80:83], v[120:123], v[48:51]
ds_read_b128 v[116:119], v6 offset:23552
v_mfma_f32_16x16x32_bf16 v[52:55], a[84:87], v[120:123], v[52:55]
s_waitcnt lgkmcnt(5)
v_mfma_f32_16x16x32_bf16 v[56:59], a[80:83], v[124:127], v[56:59]
ds_read_b128 v[120:123], v6 offset:24576
s_add_u32 s37, s23, 30720
v_mfma_f32_16x16x32_bf16 v[60:63], a[84:87], v[124:127], v[60:63]
s_waitcnt lgkmcnt(5)
buffer_load_dwordx4 a[124:127], v1, s[8:11], s37 offen offset:1024
v_mfma_f32_16x16x32_bf16 v[64:67], a[80:83], v[128:131], v[64:67]
ds_read_b128 v[124:127], v6 offset:25600
v_mfma_f32_16x16x32_bf16 v[68:71], a[84:87], v[128:131], v[68:71]
s_waitcnt lgkmcnt(5)
v_mfma_f32_16x16x32_bf16 v[72:75], a[80:83], v[104:107], v[72:75]
ds_read_b128 v[128:131], v6 offset:26624
s_add_u32 m0, s34, 0
v_mfma_f32_16x16x32_bf16 v[76:79], a[84:87], v[104:107], v[76:79]
s_waitcnt lgkmcnt(5)
s_add_u32 s36, s35, 131072
v_mfma_f32_16x16x32_bf16 v[80:83], a[80:83], v[108:111], v[80:83]
ds_read_b128 v[104:107], v6 offset:27648
buffer_load_dwordx4 v1, s[8:11], s36 offen offset:0 sc1 lds
v_mfma_f32_16x16x32_bf16 v[84:87], a[84:87], v[108:111], v[84:87]
s_waitcnt lgkmcnt(5)
v_mfma_f32_16x16x32_bf16 v[88:91], a[80:83], v[112:115], v[88:91]
ds_read_b128 v[108:111], v6 offset:28672
buffer_load_dwordx4 v1, s[8:11], s36 offen offset:1024 sc1 lds
v_mfma_f32_16x16x32_bf16 v[92:95], a[84:87], v[112:115], v[92:95]
s_waitcnt lgkmcnt(5)
v_mfma_f32_16x16x32_bf16 v[96:99], a[80:83], v[116:119], v[96:99]
ds_read_b128 v[112:115], v6 offset:29696
v_mfma_f32_16x16x32_bf16 v[100:103], a[84:87], v[116:119], v[100:103]
s_waitcnt lgkmcnt(5) vmcnt(18)
v_mfma_f32_16x16x32_bf16 v[40:43], a[88:91], v[120:123], v[40:43]
ds_read_b128 v[116:119], v6 offset:30720
buffer_load_dwordx4 v1, s[8:11], s36 offen offset:2048 sc1 lds
v_mfma_f32_16x16x32_bf16 v[44:47], a[92:95], v[120:123], v[44:47]
s_waitcnt lgkmcnt(5)
v_mfma_f32_16x16x32_bf16 v[48:51], a[88:91], v[124:127], v[48:51]
ds_read_b128 v[120:123], v6 offset:31744
v_mfma_f32_16x16x32_bf16 v[52:55], a[92:95], v[124:127], v[52:55]
s_waitcnt lgkmcnt(5)
v_mfma_f32_16x16x32_bf16 v[56:59], a[88:91], v[128:131], v[56:59]
s_waitcnt vmcnt(11)
s_barrier
ds_read_b128 v[124:127], v6 offset:32768
buffer_load_dwordx4 v1, s[8:11], s36 offen offset:3072 sc1 lds
v_mfma_f32_16x16x32_bf16 v[60:63], a[92:95], v[128:131], v[60:63]
s_waitcnt lgkmcnt(5)
v_mfma_f32_16x16x32_bf16 v[64:67], a[88:91], v[104:107], v[64:67]
ds_read_b128 v[128:131], v6 offset:33792
v_mfma_f32_16x16x32_bf16 v[68:71], a[92:95], v[104:107], v[68:71]
s_waitcnt lgkmcnt(5)
v_mfma_f32_16x16x32_bf16 v[72:75], a[88:91], v[108:111], v[72:75]
ds_read_b128 v[104:107], v6 offset:34816
s_add_u32 m0, s34, 4096
v_mfma_f32_16x16x32_bf16 v[76:79], a[92:95], v[108:111], v[76:79]
s_waitcnt lgkmcnt(5)
s_add_u32 s36, s35, 135168
v_mfma_f32_16x16x32_bf16 v[80:83], a[88:91], v[112:115], v[80:83]
ds_read_b128 v[108:111], v6 offset:35840
buffer_load_dwordx4 v1, s[8:11], s36 offen offset:0 sc1 lds
v_mfma_f32_16x16x32_bf16 v[84:87], a[92:95], v[112:115], v[84:87]
s_waitcnt lgkmcnt(5)
v_mfma_f32_16x16x32_bf16 v[88:91], a[88:91], v[116:119], v[88:91]
ds_read_b128 v[112:115], v6 offset:36864
buffer_load_dwordx4 v1, s[8:11], s36 offen offset:1024 sc1 lds
v_mfma_f32_16x16x32_bf16 v[92:95], a[92:95], v[116:119], v[92:95]
s_waitcnt lgkmcnt(5)
v_mfma_f32_16x16x32_bf16 v[96:99], a[88:91], v[120:123], v[96:99]
ds_read_b128 v[116:119], v6 offset:37888
v_mfma_f32_16x16x32_bf16 v[100:103], a[92:95], v[120:123], v[100:103]
s_waitcnt lgkmcnt(5) vmcnt(12)
v_mfma_f32_16x16x32_bf16 v[40:43], a[96:99], v[124:127], v[40:43]
ds_read_b128 v[120:123], v6 offset:38912
buffer_load_dwordx4 v1, s[8:11], s36 offen offset:2048 sc1 lds
v_mfma_f32_16x16x32_bf16 v[44:47], a[100:103], v[124:127], v[44:47]
s_waitcnt lgkmcnt(5)
v_mfma_f32_16x16x32_bf16 v[48:51], a[96:99], v[128:131], v[48:51]
ds_read_b128 v[124:127], v6 offset:39936
v_mfma_f32_16x16x32_bf16 v[52:55], a[100:103], v[128:131], v[52:55]
s_waitcnt lgkmcnt(5)
v_mfma_f32_16x16x32_bf16 v[56:59], a[96:99], v[104:107], v[56:59]
ds_read_b128 v[128:131], v6 offset:40960
v_mfma_f32_16x16x32_bf16 v[60:63], a[100:103], v[104:107], v[60:63]
s_waitcnt lgkmcnt(5)
v_mfma_f32_16x16x32_bf16 v[64:67], a[96:99], v[108:111], v[64:67]
ds_read_b128 v[104:107], v6 offset:41984
buffer_load_dwordx4 v1, s[8:11], s36 offen offset:3072 sc1 lds
v_mfma_f32_16x16x32_bf16 v[68:71], a[100:103], v[108:111], v[68:71]
s_waitcnt lgkmcnt(5)
v_mfma_f32_16x16x32_bf16 v[72:75], a[96:99], v[112:115], v[72:75]
ds_read_b128 v[108:111], v6 offset:43008
v_mfma_f32_16x16x32_bf16 v[76:79], a[100:103], v[112:115], v[76:79]
s_waitcnt lgkmcnt(5)
v_mfma_f32_16x16x32_bf16 v[80:83], a[96:99], v[116:119], v[80:83]
ds_read_b128 v[112:115], v6 offset:44032
s_add_u32 s37, s23, 32768
v_mfma_f32_16x16x32_bf16 v[84:87], a[100:103], v[116:119], v[84:87]
s_waitcnt lgkmcnt(5)
buffer_load_dwordx4 a[128:131], v1, s[8:11], s37 offen offset:0
v_mfma_f32_16x16x32_bf16 v[88:91], a[96:99], v[120:123], v[88:91]
ds_read_b128 v[116:119], v6 offset:45056
v_mfma_f32_16x16x32_bf16 v[92:95], a[100:103], v[120:123], v[92:95]
s_waitcnt lgkmcnt(5)
v_mfma_f32_16x16x32_bf16 v[96:99], a[96:99], v[124:127], v[96:99]
ds_read_b128 v[120:123], v6 offset:46080
s_add_u32 s37, s23, 32768
v_mfma_f32_16x16x32_bf16 v[100:103], a[100:103], v[124:127], v[100:103]
s_waitcnt lgkmcnt(5) vmcnt(13)
buffer_load_dwordx4 a[132:135], v1, s[8:11], s37 offen offset:1024
v_mfma_f32_16x16x32_bf16 v[40:43], a[104:107], v[128:131], v[40:43]
ds_read_b128 v[124:127], v6 offset:47104
v_mfma_f32_16x16x32_bf16 v[44:47], a[108:111], v[128:131], v[44:47]
s_waitcnt lgkmcnt(5)
v_mfma_f32_16x16x32_bf16 v[48:51], a[104:107], v[104:107], v[48:51]
ds_read_b128 v[128:131], v6 offset:48128
s_add_u32 s37, s23, 34816
v_mfma_f32_16x16x32_bf16 v[52:55], a[108:111], v[104:107], v[52:55]
s_waitcnt lgkmcnt(5)
buffer_load_dwordx4 a[136:139], v1, s[8:11], s37 offen offset:0
v_mfma_f32_16x16x32_bf16 v[56:59], a[104:107], v[108:111], v[56:59]
ds_read_b128 v[104:107], v6 offset:49152
v_mfma_f32_16x16x32_bf16 v[60:63], a[108:111], v[108:111], v[60:63]
s_waitcnt lgkmcnt(5)
v_mfma_f32_16x16x32_bf16 v[64:67], a[104:107], v[112:115], v[64:67]
ds_read_b128 v[108:111], v6 offset:50176
s_add_u32 s37, s23, 34816
v_mfma_f32_16x16x32_bf16 v[68:71], a[108:111], v[112:115], v[68:71]
s_waitcnt lgkmcnt(5)
buffer_load_dwordx4 a[140:143], v1, s[8:11], s37 offen offset:1024
v_mfma_f32_16x16x32_bf16 v[72:75], a[104:107], v[116:119], v[72:75]
ds_read_b128 v[112:115], v6 offset:51200
v_mfma_f32_16x16x32_bf16 v[76:79], a[108:111], v[116:119], v[76:79]
s_waitcnt lgkmcnt(5)
v_mfma_f32_16x16x32_bf16 v[80:83], a[104:107], v[120:123], v[80:83]
ds_read_b128 v[116:119], v6 offset:52224
s_add_u32 s37, s23, 36864
v_mfma_f32_16x16x32_bf16 v[84:87], a[108:111], v[120:123], v[84:87]
s_waitcnt lgkmcnt(5)
buffer_load_dwordx4 a[144:147], v1, s[8:11], s37 offen offset:0
v_mfma_f32_16x16x32_bf16 v[88:91], a[104:107], v[124:127], v[88:91]
ds_read_b128 v[120:123], v6 offset:53248
v_mfma_f32_16x16x32_bf16 v[92:95], a[108:111], v[124:127], v[92:95]
s_waitcnt lgkmcnt(5)
v_mfma_f32_16x16x32_bf16 v[96:99], a[104:107], v[128:131], v[96:99]
ds_read_b128 v[124:127], v6 offset:54272
s_add_u32 s37, s23, 36864
v_mfma_f32_16x16x32_bf16 v[100:103], a[108:111], v[128:131], v[100:103]
s_waitcnt lgkmcnt(5) vmcnt(15)
buffer_load_dwordx4 a[148:151], v1, s[8:11], s37 offen offset:1024
v_mfma_f32_16x16x32_bf16 v[40:43], a[112:115], v[104:107], v[40:43]
ds_read_b128 v[128:131], v6 offset:55296
v_mfma_f32_16x16x32_bf16 v[44:47], a[116:119], v[104:107], v[44:47]
s_waitcnt lgkmcnt(5)
v_mfma_f32_16x16x32_bf16 v[48:51], a[112:115], v[108:111], v[48:51]
ds_read_b128 v[104:107], v6 offset:56320
s_add_u32 s37, s23, 38912
v_mfma_f32_16x16x32_bf16 v[52:55], a[116:119], v[108:111], v[52:55]
s_waitcnt lgkmcnt(5)
buffer_load_dwordx4 a[152:155], v1, s[8:11], s37 offen offset:0
v_mfma_f32_16x16x32_bf16 v[56:59], a[112:115], v[112:115], v[56:59]
ds_read_b128 v[108:111], v6 offset:57344
v_mfma_f32_16x16x32_bf16 v[60:63], a[116:119], v[112:115], v[60:63]
s_waitcnt lgkmcnt(5)
v_mfma_f32_16x16x32_bf16 v[64:67], a[112:115], v[116:119], v[64:67]
ds_read_b128 v[112:115], v6 offset:58368
s_add_u32 s37, s23, 38912
v_mfma_f32_16x16x32_bf16 v[68:71], a[116:119], v[116:119], v[68:71]
s_waitcnt lgkmcnt(5)
buffer_load_dwordx4 a[156:159], v1, s[8:11], s37 offen offset:1024
v_mfma_f32_16x16x32_bf16 v[72:75], a[112:115], v[120:123], v[72:75]
ds_read_b128 v[116:119], v6 offset:59392
v_mfma_f32_16x16x32_bf16 v[76:79], a[116:119], v[120:123], v[76:79]
s_waitcnt lgkmcnt(5)
v_mfma_f32_16x16x32_bf16 v[80:83], a[112:115], v[124:127], v[80:83]
ds_read_b128 v[120:123], v6 offset:60416
v_mfma_f32_16x16x32_bf16 v[84:87], a[116:119], v[124:127], v[84:87]
s_waitcnt lgkmcnt(5)
v_mfma_f32_16x16x32_bf16 v[88:91], a[112:115], v[128:131], v[88:91]
ds_read_b128 v[124:127], v6 offset:61440
v_mfma_f32_16x16x32_bf16 v[92:95], a[116:119], v[128:131], v[92:95]
s_waitcnt lgkmcnt(5)
v_mfma_f32_16x16x32_bf16 v[96:99], a[112:115], v[104:107], v[96:99]
ds_read_b128 v[128:131], v6 offset:62464
v_mfma_f32_16x16x32_bf16 v[100:103], a[116:119], v[104:107], v[100:103]
s_waitcnt lgkmcnt(5) vmcnt(16)
v_mfma_f32_16x16x32_bf16 v[40:43], a[120:123], v[108:111], v[40:43]
ds_read_b128 v[104:107], v6 offset:63488
s_mul_i32 s46, s16, 5120
s_add_u32 s47, s46, s22
s_add_u32 s46, s46, 143360
v_cmp_ne_u32 vcc, 0, v3
s_and_saveexec_b64 s[38:39], vcc
s_add_u32 m0, s46, 0
s_add_u32 s48, s47, 0
buffer_load_dwordx4 v1, s[8:11], s48 offen sc1 lds
s_mov_b64 exec, s[38:39]
v_mfma_f32_16x16x32_bf16 v[44:47], a[124:127], v[108:111], v[44:47]
s_waitcnt lgkmcnt(5)
v_mfma_f32_16x16x32_bf16 v[48:51], a[120:123], v[112:115], v[48:51]
ds_read_b128 v[108:111], v6 offset:64512
v_mfma_f32_16x16x32_bf16 v[52:55], a[124:127], v[112:115], v[52:55]
s_waitcnt lgkmcnt(5)
v_mfma_f32_16x16x32_bf16 v[56:59], a[120:123], v[116:119], v[56:59]
s_waitcnt vmcnt(9)
s_barrier
ds_read_b128 v[112:115], v5 offset:0
v_mfma_f32_16x16x32_bf16 v[60:63], a[124:127], v[116:119], v[60:63]
s_waitcnt lgkmcnt(5)
v_mfma_f32_16x16x32_bf16 v[64:67], a[120:123], v[120:123], v[64:67]
ds_read_b128 v[116:119], v5 offset:1024
v_cmp_ne_u32 vcc, 0, v3
s_and_saveexec_b64 s[38:39], vcc
s_add_u32 m0, s46, 1024
s_add_u32 s48, s47, 1024
buffer_load_dwordx4 v1, s[8:11], s48 offen sc1 lds
s_mov_b64 exec, s[38:39]
v_mfma_f32_16x16x32_bf16 v[68:71], a[124:127], v[120:123], v[68:71]
s_waitcnt lgkmcnt(5)
v_mfma_f32_16x16x32_bf16 v[72:75], a[120:123], v[124:127], v[72:75]
ds_read_b128 v[120:123], v5 offset:2048
v_mfma_f32_16x16x32_bf16 v[76:79], a[124:127], v[124:127], v[76:79]
s_waitcnt lgkmcnt(5)
v_mfma_f32_16x16x32_bf16 v[80:83], a[120:123], v[128:131], v[80:83]
ds_read_b128 v[124:127], v5 offset:3072
v_mfma_f32_16x16x32_bf16 v[84:87], a[124:127], v[128:131], v[84:87]
s_waitcnt lgkmcnt(5)
v_mfma_f32_16x16x32_bf16 v[88:91], a[120:123], v[104:107], v[88:91]
ds_read_b128 v[128:131], v5 offset:4096
v_cmp_ne_u32 vcc, 0, v3
s_and_saveexec_b64 s[38:39], vcc
s_add_u32 m0, s46, 2048
s_add_u32 s48, s47, 2048
buffer_load_dwordx4 v1, s[8:11], s48 offen sc1 lds
s_mov_b64 exec, s[38:39]
v_mfma_f32_16x16x32_bf16 v[92:95], a[124:127], v[104:107], v[92:95]
s_waitcnt lgkmcnt(5)
v_mfma_f32_16x16x32_bf16 v[96:99], a[120:123], v[108:111], v[96:99]
ds_read_b128 v[104:107], v5 offset:5120
v_mfma_f32_16x16x32_bf16 v[100:103], a[124:127], v[108:111], v[100:103]
s_waitcnt lgkmcnt(5) vmcnt(9)
v_mfma_f32_16x16x32_bf16 v[40:43], a[128:131], v[112:115], v[40:43]
ds_read_b128 v[108:111], v5 offset:6144
v_mfma_f32_16x16x32_bf16 v[44:47], a[132:135], v[112:115], v[44:47]
s_waitcnt lgkmcnt(5)
v_mfma_f32_16x16x32_bf16 v[48:51], a[128:131], v[116:119], v[48:51]
ds_read_b128 v[112:115], v5 offset:7168
v_cmp_ne_u32 vcc, 0, v3
s_and_saveexec_b64 s[38:39], vcc
s_add_u32 m0, s46, 3072
s_add_u32 s48, s47, 3072
buffer_load_dwordx4 v1, s[8:11], s48 offen sc1 lds
s_mov_b64 exec, s[38:39]
v_mfma_f32_16x16x32_bf16 v[52:55], a[132:135], v[116:119], v[52:55]
s_waitcnt lgkmcnt(5)
v_mfma_f32_16x16x32_bf16 v[56:59], a[128:131], v[120:123], v[56:59]
ds_read_b128 v[116:119], v5 offset:8192
v_mfma_f32_16x16x32_bf16 v[60:63], a[132:135], v[120:123], v[60:63]
s_waitcnt lgkmcnt(5)
v_mfma_f32_16x16x32_bf16 v[64:67], a[128:131], v[124:127], v[64:67]
ds_read_b128 v[120:123], v5 offset:9216
v_mfma_f32_16x16x32_bf16 v[68:71], a[132:135], v[124:127], v[68:71]
s_waitcnt lgkmcnt(5)
v_mfma_f32_16x16x32_bf16 v[72:75], a[128:131], v[128:131], v[72:75]
ds_read_b128 v[124:127], v5 offset:10240
v_cmp_ne_u32 vcc, 0, v3
s_and_saveexec_b64 s[38:39], vcc
s_add_u32 m0, s46, 4096
s_add_u32 s48, s47, 4096
buffer_load_dwordx4 v1, s[8:11], s48 offen sc1 lds
s_mov_b64 exec, s[38:39]
v_mfma_f32_16x16x32_bf16 v[76:79], a[132:135], v[128:131], v[76:79]
s_waitcnt lgkmcnt(5)
v_mfma_f32_16x16x32_bf16 v[80:83], a[128:131], v[104:107], v[80:83]
ds_read_b128 v[128:131], v5 offset:11264
v_mfma_f32_16x16x32_bf16 v[84:87], a[132:135], v[104:107], v[84:87]
s_waitcnt lgkmcnt(5)
v_mfma_f32_16x16x32_bf16 v[88:91], a[128:131], v[108:111], v[88:91]
ds_read_b128 v[104:107], v5 offset:12288
v_mfma_f32_16x16x32_bf16 v[92:95], a[132:135], v[108:111], v[92:95]
s_waitcnt lgkmcnt(5)
v_mfma_f32_16x16x32_bf16 v[96:99], a[128:131], v[112:115], v[96:99]
ds_read_b128 v[108:111], v5 offset:13312
v_mfma_f32_16x16x32_bf16 v[100:103], a[132:135], v[112:115], v[100:103]
s_waitcnt lgkmcnt(5) vmcnt(9)
v_mfma_f32_16x16x32_bf16 v[40:43], a[136:139], v[116:119], v[40:43]
ds_read_b128 v[112:115], v5 offset:14336
buffer_load_dwordx4 v[20:23], v1, s[8:11], s24 offen sc1
v_mfma_f32_16x16x32_bf16 v[44:47], a[140:143], v[116:119], v[44:47]
s_waitcnt lgkmcnt(5)
v_mfma_f32_16x16x32_bf16 v[48:51], a[136:139], v[120:123], v[48:51]
ds_read_b128 v[116:119], v5 offset:15360
v_mfma_f32_16x16x32_bf16 v[52:55], a[140:143], v[120:123], v[52:55]
s_waitcnt lgkmcnt(5)
v_mfma_f32_16x16x32_bf16 v[56:59], a[136:139], v[124:127], v[56:59]
ds_read_b128 v[120:123], v5 offset:16384
v_mfma_f32_16x16x32_bf16 v[60:63], a[140:143], v[124:127], v[60:63]
s_waitcnt lgkmcnt(5)
v_mfma_f32_16x16x32_bf16 v[64:67], a[136:139], v[128:131], v[64:67]
ds_read_b128 v[124:127], v5 offset:17408
v_mfma_f32_16x16x32_bf16 v[68:71], a[140:143], v[128:131], v[68:71]
s_waitcnt lgkmcnt(5)
v_mfma_f32_16x16x32_bf16 v[72:75], a[136:139], v[104:107], v[72:75]
ds_read_b128 v[128:131], v5 offset:18432
s_cmp_lg_u32 s16, 0
s_cbranch_scc1 L_bpe_54
v_add_u32 v208, 0, v2
v_min_u32 v208, 405, v208
v_lshlrev_b32 v208, 2, v208
v_add_u32 v208, 23418880, v208
buffer_load_dword v216, v208, s[8:11], 0 offen sc1
v_add_u32 v209, 64, v2
v_min_u32 v209, 405, v209
v_lshlrev_b32 v209, 2, v209
v_add_u32 v209, 23418880, v209
buffer_load_dword v217, v209, s[8:11], 0 offen sc1
v_add_u32 v210, 128, v2
v_min_u32 v210, 405, v210
v_lshlrev_b32_e64 v210, 2, v210
v_add_u32 v210, 23418880, v210
buffer_load_dword v218, v210, s[8:11], 0 offen sc1
v_add_u32 v211, 192, v2
v_min_u32 v211, 405, v211
v_lshlrev_b32_e64 v211, 2, v211
v_add_u32 v211, 23418880, v211
buffer_load_dword v219, v211, s[8:11], 0 offen sc1
v_add_u32 v212, 256, v2
v_min_u32 v212, 405, v212
v_lshlrev_b32_e64 v212, 2, v212
v_add_u32 v212, 23418880, v212
buffer_load_dword v220, v212, s[8:11], 0 offen sc1
v_add_u32 v213, 320, v2
v_min_u32 v213, 405, v213
v_lshlrev_b32_e64 v213, 2, v213
v_add_u32 v213, 23418880, v213
buffer_load_dword v221, v213, s[8:11], 0 offen sc1
v_add_u32 v214, 384, v2
v_min_u32 v214, 405, v214
v_lshlrev_b32 v214, 2, v214
v_add_u32 v214, 23418880, v214
buffer_load_dword v222, v214, s[8:11], 0 offen sc1
L_bpe_54:
v_mfma_f32_16x16x32_bf16 v[76:79], a[140:143], v[104:107], v[76:79]
s_waitcnt lgkmcnt(5)
v_mfma_f32_16x16x32_bf16 v[80:83], a[136:139], v[108:111], v[80:83]
ds_read_b128 v[104:107], v5 offset:19456
v_mfma_f32_16x16x32_bf16 v[84:87], a[140:143], v[108:111], v[84:87]
s_waitcnt lgkmcnt(5)
v_mfma_f32_16x16x32_bf16 v[88:91], a[136:139], v[112:115], v[88:91]
ds_read_b128 v[108:111], v5 offset:20480
v_mfma_f32_16x16x32_bf16 v[92:95], a[140:143], v[112:115], v[92:95]
s_waitcnt lgkmcnt(5)
v_mfma_f32_16x16x32_bf16 v[96:99], a[136:139], v[116:119], v[96:99]
ds_read_b128 v[112:115], v5 offset:21504
v_mfma_f32_16x16x32_bf16 v[100:103], a[140:143], v[116:119], v[100:103]
s_waitcnt lgkmcnt(5) vmcnt(8)
v_mfma_f32_16x16x32_bf16 v[40:43], a[144:147], v[120:123], v[40:43]
ds_read_b128 v[116:119], v5 offset:22528
v_mfma_f32_16x16x32_bf16 v[44:47], a[148:151], v[120:123], v[44:47]
s_waitcnt lgkmcnt(5)
v_mfma_f32_16x16x32_bf16 v[48:51], a[144:147], v[124:127], v[48:51]
ds_read_b128 v[120:123], v5 offset:23552
v_mfma_f32_16x16x32_bf16 v[52:55], a[148:151], v[124:127], v[52:55]
s_waitcnt lgkmcnt(5)
v_mfma_f32_16x16x32_bf16 v[56:59], a[144:147], v[128:131], v[56:59]
ds_read_b128 v[124:127], v5 offset:24576
v_mfma_f32_16x16x32_bf16 v[60:63], a[148:151], v[128:131], v[60:63]
s_waitcnt lgkmcnt(5)
v_mfma_f32_16x16x32_bf16 v[64:67], a[144:147], v[104:107], v[64:67]
ds_read_b128 v[128:131], v5 offset:25600
v_mfma_f32_16x16x32_bf16 v[68:71], a[148:151], v[104:107], v[68:71]
s_waitcnt lgkmcnt(5)
v_mfma_f32_16x16x32_bf16 v[72:75], a[144:147], v[108:111], v[72:75]
ds_read_b128 v[104:107], v5 offset:26624
v_mfma_f32_16x16x32_bf16 v[76:79], a[148:151], v[108:111], v[76:79]
s_waitcnt lgkmcnt(5)
v_mfma_f32_16x16x32_bf16 v[80:83], a[144:147], v[112:115], v[80:83]
ds_read_b128 v[108:111], v5 offset:27648
v_mfma_f32_16x16x32_bf16 v[84:87], a[148:151], v[112:115], v[84:87]
s_waitcnt lgkmcnt(5)
v_mfma_f32_16x16x32_bf16 v[88:91], a[144:147], v[116:119], v[88:91]
ds_read_b128 v[112:115], v5 offset:28672
v_mfma_f32_16x16x32_bf16 v[92:95], a[148:151], v[116:119], v[92:95]
s_waitcnt lgkmcnt(5)
v_mfma_f32_16x16x32_bf16 v[96:99], a[144:147], v[120:123], v[96:99]
ds_read_b128 v[116:119], v5 offset:29696
v_mfma_f32_16x16x32_bf16 v[100:103], a[148:151], v[120:123], v[100:103]
s_waitcnt lgkmcnt(5) vmcnt(6)
v_mfma_f32_16x16x32_bf16 v[40:43], a[152:155], v[124:127], v[40:43]
ds_read_b128 v[120:123], v5 offset:30720
v_mfma_f32_16x16x32_bf16 v[44:47], a[156:159], v[124:127], v[44:47]
s_waitcnt lgkmcnt(5)
v_mfma_f32_16x16x32_bf16 v[48:51], a[152:155], v[128:131], v[48:51]
ds_read_b128 v[124:127], v5 offset:31744
v_mfma_f32_16x16x32_bf16 v[52:55], a[156:159], v[128:131], v[52:55]
s_waitcnt lgkmcnt(5)
v_mfma_f32_16x16x32_bf16 v[56:59], a[152:155], v[104:107], v[56:59]
s_waitcnt vmcnt(0)
s_barrier
ds_read_b128 v[128:131], v7 offset:0
v_mfma_f32_16x16x32_bf16 v[60:63], a[156:159], v[104:107], v[60:63]
s_waitcnt lgkmcnt(5)
v_mfma_f32_16x16x32_bf16 v[64:67], a[152:155], v[108:111], v[64:67]
ds_read_b128 v[104:107], v7 offset:1024
v_mfma_f32_16x16x32_bf16 v[68:71], a[156:159], v[108:111], v[68:71]
s_waitcnt lgkmcnt(5)
v_mfma_f32_16x16x32_bf16 v[72:75], a[152:155], v[112:115], v[72:75]
ds_read_b128 v[108:111], v7 offset:2048
v_mfma_f32_16x16x32_bf16 v[76:79], a[156:159], v[112:115], v[76:79]
s_waitcnt lgkmcnt(5)
v_mfma_f32_16x16x32_bf16 v[80:83], a[152:155], v[116:119], v[80:83]
ds_read_b128 v[112:115], v7 offset:3072
v_mfma_f32_16x16x32_bf16 v[84:87], a[156:159], v[116:119], v[84:87]
s_waitcnt lgkmcnt(5)
v_mfma_f32_16x16x32_bf16 v[88:91], a[152:155], v[120:123], v[88:91]
ds_read_b128 v[116:119], v7 offset:4096
v_mfma_f32_16x16x32_bf16 v[92:95], a[156:159], v[120:123], v[92:95]
s_waitcnt lgkmcnt(5)
v_mfma_f32_16x16x32_bf16 v[96:99], a[152:155], v[124:127], v[96:99]
ds_read_b128 v[120:123], v7 offset:5120
v_mfma_f32_16x16x32_bf16 v[100:103], a[156:159], v[124:127], v[100:103]
s_waitcnt lgkmcnt(5)
v_mfma_f32_16x16x32_bf16 v[32:35], a[0:3], v[128:131], 0
ds_read_b128 v[124:127], v7 offset:6144
v_mfma_f32_16x16x32_bf16 v[36:39], a[4:7], v[128:131], 0
s_waitcnt lgkmcnt(5)
v_mfma_f32_16x16x32_bf16 v[32:35], a[8:11], v[104:107], v[32:35]
ds_read_b128 v[128:131], v7 offset:7168
v_mfma_f32_16x16x32_bf16 v[36:39], a[12:15], v[104:107], v[36:39]
s_waitcnt lgkmcnt(5)
v_mfma_f32_16x16x32_bf16 v[32:35], a[16:19], v[108:111], v[32:35]
ds_read_b128 v[104:107], v7 offset:8192
v_mfma_f32_16x16x32_bf16 v[36:39], a[20:23], v[108:111], v[36:39]
s_waitcnt lgkmcnt(5)
v_mfma_f32_16x16x32_bf16 v[32:35], a[24:27], v[112:115], v[32:35]
ds_read_b128 v[108:111], v7 offset:9216
v_mfma_f32_16x16x32_bf16 v[36:39], a[28:31], v[112:115], v[36:39]
s_waitcnt lgkmcnt(5)
v_mfma_f32_16x16x32_bf16 v[32:35], a[32:35], v[116:119], v[32:35]
ds_read_b128 v[112:115], v7 offset:10240
v_mfma_f32_16x16x32_bf16 v[36:39], a[36:39], v[116:119], v[36:39]
s_waitcnt lgkmcnt(5)
v_mfma_f32_16x16x32_bf16 v[32:35], a[40:43], v[120:123], v[32:35]
ds_read_b128 v[116:119], v7 offset:11264
v_mfma_f32_16x16x32_bf16 v[36:39], a[44:47], v[120:123], v[36:39]
s_waitcnt lgkmcnt(5)
v_mfma_f32_16x16x32_bf16 v[32:35], a[48:51], v[124:127], v[32:35]
ds_read_b128 v[120:123], v7 offset:12288
v_mfma_f32_16x16x32_bf16 v[36:39], a[52:55], v[124:127], v[36:39]
s_waitcnt lgkmcnt(5)
v_mfma_f32_16x16x32_bf16 v[32:35], a[56:59], v[128:131], v[32:35]
ds_read_b128 v[124:127], v7 offset:13312
v_mfma_f32_16x16x32_bf16 v[36:39], a[60:63], v[128:131], v[36:39]
s_waitcnt lgkmcnt(5)
v_mfma_f32_16x16x32_bf16 v[32:35], a[64:67], v[104:107], v[32:35]
ds_read_b128 v[128:131], v7 offset:14336
v_mfma_f32_16x16x32_bf16 v[36:39], a[68:71], v[104:107], v[36:39]
s_waitcnt lgkmcnt(5)
v_mfma_f32_16x16x32_bf16 v[32:35], a[72:75], v[108:111], v[32:35]
ds_read_b128 v[104:107], v7 offset:15360
v_mfma_f32_16x16x32_bf16 v[36:39], a[76:79], v[108:111], v[36:39]
s_waitcnt lgkmcnt(5)
v_mfma_f32_16x16x32_bf16 v[32:35], a[80:83], v[112:115], v[32:35]
ds_read_b128 v[108:111], v7 offset:16384
v_mfma_f32_16x16x32_bf16 v[36:39], a[84:87], v[112:115], v[36:39]
s_waitcnt lgkmcnt(5)
v_mfma_f32_16x16x32_bf16 v[32:35], a[88:91], v[116:119], v[32:35]
ds_read_b128 v[112:115], v7 offset:17408
v_mfma_f32_16x16x32_bf16 v[36:39], a[92:95], v[116:119], v[36:39]
s_waitcnt lgkmcnt(5)
v_mfma_f32_16x16x32_bf16 v[32:35], a[96:99], v[120:123], v[32:35]
ds_read_b128 v[116:119], v7 offset:18432
v_mfma_f32_16x16x32_bf16 v[36:39], a[100:103], v[120:123], v[36:39]
s_waitcnt lgkmcnt(5)
v_mfma_f32_16x16x32_bf16 v[32:35], a[104:107], v[124:127], v[32:35]
ds_read_b128 v[120:123], v7 offset:19456
v_mfma_f32_16x16x32_bf16 v[36:39], a[108:111], v[124:127], v[36:39]
s_waitcnt lgkmcnt(5)
v_mfma_f32_16x16x32_bf16 v[32:35], a[112:115], v[128:131], v[32:35]
v_mfma_f32_16x16x32_bf16 v[36:39], a[116:119], v[128:131], v[36:39]
s_waitcnt lgkmcnt(4)
v_mfma_f32_16x16x32_bf16 v[32:35], a[120:123], v[104:107], v[32:35]
v_mfma_f32_16x16x32_bf16 v[36:39], a[124:127], v[104:107], v[36:39]
s_waitcnt lgkmcnt(3)
v_mfma_f32_16x16x32_bf16 v[32:35], a[128:131], v[108:111], v[32:35]
v_mfma_f32_16x16x32_bf16 v[36:39], a[132:135], v[108:111], v[36:39]
s_waitcnt lgkmcnt(2)
v_mfma_f32_16x16x32_bf16 v[32:35], a[136:139], v[112:115], v[32:35]
v_mfma_f32_16x16x32_bf16 v[36:39], a[140:143], v[112:115], v[36:39]
s_waitcnt lgkmcnt(1)
v_mfma_f32_16x16x32_bf16 v[32:35], a[144:147], v[116:119], v[32:35]
v_mfma_f32_16x16x32_bf16 v[36:39], a[148:151], v[116:119], v[36:39]
s_waitcnt lgkmcnt(0)
v_mfma_f32_16x16x32_bf16 v[32:35], a[152:155], v[120:123], v[32:35]
v_mfma_f32_16x16x32_bf16 v[36:39], a[156:159], v[120:123], v[36:39]
v_add_f32 v24, v20, v22
v_add_f32 v25, v21, v23
v_mov_b32 v28, v24
v_mov_b32 v29, v25
s_nop 1
v_permlane16_swap_b32 v24, v28
v_permlane16_swap_b32 v25, v29
s_nop 1
v_add_f32 v24, v24, v28
v_add_f32 v25, v25, v29
v_mov_b32 v28, v24
v_mov_b32 v29, v25
s_nop 1
v_permlane32_swap_b32 v24, v28
v_permlane32_swap_b32 v25, v29
s_nop 1
v_add_f32 v24, v24, v28
v_add_f32 v25, v25, v29
v_mul_f32 v24, 0.0015625, v24
v_mul_f32 v25, 0.0015625, v25
v_fma_f32 v25, -v24, v24, v25
v_max_f32 v25, 0, v25
v_add_f32 v25, 0x3727c5ac, v25
v_rsq_f32 v25, v25
s_nop 0
v_lshlrev_b32 v16, 3, v3
v_add_u32 v16, 131072, v16
s_mov_b64 s[38:39], exec
s_mov_b64 exec, 0xffff
ds_write_b64 v16, v[24:25]
s_mov_b64 exec, s[38:39]
s_cmp_lg_u32 s16, 0
s_cbranch_scc1 L_bpok_55
s_waitcnt vmcnt(0)
v_xor_b32 v216, s59, v216
v_xor_b32 v217, s59, v217
v_or_b32 v216, v216, v217
v_xor_b32 v218, s59, v218
v_or_b32 v216, v216, v218
v_xor_b32 v219, s59, v219
v_or_b32 v216, v216, v219
v_xor_b32 v220, s59, v220
v_or_b32 v216, v216, v220
v_xor_b32 v221, s59, v221
v_or_b32 v216, v216, v221
v_xor_b32 v222, s59, v222
v_or_b32 v216, v216, v222
v_cmp_ne_u32 vcc, 0, v216
s_cbranch_vccz L_bpok_55
s_cmp_lg_u32 s16, 0
s_cbranch_scc1 L_pp_56
s_mov_b64 s[38:39], exec
v_add_u32 v12, 0, v2
v_min_u32 v12, 405, v12
v_lshlrev_b32 v12, 2, v12
v_add_u32 v12, 23418880, v12
v_add_u32 v13, 64, v2
v_min_u32 v13, 405, v13
v_lshlrev_b32 v13, 2, v13
v_add_u32 v13, 23418880, v13
v_add_u32 v14, 128, v2
v_min_u32 v14, 405, v14
v_lshlrev_b32 v14, 2, v14
v_add_u32 v14, 23418880, v14
v_add_u32 v15, 192, v2
v_min_u32 v15, 405, v15
v_lshlrev_b32 v15, 2, v15
v_add_u32 v15, 23418880, v15
v_add_u32 v16, 256, v2
v_min_u32 v16, 405, v16
v_lshlrev_b32 v16, 2, v16
v_add_u32 v16, 23418880, v16
v_add_u32 v17, 320, v2
v_min_u32 v17, 405, v17
v_lshlrev_b32 v17, 2, v17
v_add_u32 v17, 23418880, v17
v_add_u32 v18, 384, v2
v_min_u32 v18, 405, v18
v_lshlrev_b32 v18, 2, v18
v_add_u32 v18, 23418880, v18
s_mov_b32 s41, 0
s_nop 0
L_ppoll_57:
buffer_load_dword v20, v12, s[8:11], 0 offen sc1
buffer_load_dword v21, v13, s[8:11], 0 offen sc1
buffer_load_dword v22, v14, s[8:11], 0 offen sc1
buffer_load_dword v23, v15, s[8:11], 0 offen sc1
buffer_load_dword v24, v16, s[8:11], 0 offen sc1
buffer_load_dword v25, v17, s[8:11], 0 offen sc1
buffer_load_dword v26, v18, s[8:11], 0 offen sc1
s_waitcnt vmcnt(0)
v_xor_b32 v20, s59, v20
v_xor_b32 v21, s59, v21
v_or_b32 v20, v20, v21
v_xor_b32 v22, s59, v22
v_or_b32 v20, v20, v22
v_xor_b32 v23, s59, v23
v_or_b32 v20, v20, v23
v_xor_b32 v24, s59, v24
v_or_b32 v20, v20, v24
v_xor_b32 v25, s59, v25
v_or_b32 v20, v20, v25
v_xor_b32 v26, s59, v26
v_or_b32 v20, v20, v26
v_cmp_ne_u32 vcc, 0, v20
s_add_u32 s41, s41, 1
s_cmp_gt_u32 s41, 40000
s_cbranch_scc1 L_ppolld_58
s_cbranch_vccnz L_ppoll_57
L_ppolld_58:
s_mov_b64 exec, s[38:39]
L_pp_56:
L_bpok_55:
s_waitcnt lgkmcnt(0)
s_barrier
s_nop 0
s_mul_i32 s43, s18, 896
s_add_u32 s43, s43, 10240000
v_min_u32 v16, 880, v1
buffer_load_dwordx4 v[224:227], v16, s[8:11], s43 offen sc1
s_add_u32 s43, s43, 14336
buffer_load_dwordx4 v[228:231], v16, s[8:11], s43 offen sc1
s_lshl_b32 s40, s17, 4
s_add_u32 s40, s40, s18
s_lshl_b32 s40, s40, 2
s_add_u32 s40, s40, s16
s_lshl_b32 s41, s40, 13
s_add_u32 s41, s41, 2621440
s_cmp_ge_u32 s40, 933
s_cselect_b32 s41, 1073741824, s41
buffer_load_dword v250, v249, s[8:11], s41 offen
s_mul_i32 s46, s98, 102400
s_mul_i32 s47, s16, 25600
s_add_u32 s46, s46, s47
s_add_u32 s46, s46, 2621440
s_add_u32 s47, s47, 57344
v_lshlrev_b32 v7, 3, v3
v_add_u32 v7, 131072, v7
ds_read_b64 v[104:105], v7 offset:0
ds_read_b64 v[106:107], v7 offset:128
ds_read_b64 v[108:109], v7 offset:256
ds_read_b64 v[110:111], v7 offset:384
ds_read_b64 v[112:113], v7 offset:512
ds_read_b64 v[114:115], v7 offset:640
ds_read_b64 v[116:117], v7 offset:768
ds_read_b64 v[118:119], v7 offset:896
ds_read_b64 v[120:121], v7 offset:1024
v_mov_b32_dpp v124, v32 row_newbcast:0 row_mask:0xf bank_mask:0xf
v_mov_b32_dpp v125, v33 row_newbcast:0 row_mask:0xf bank_mask:0xf
v_mov_b32_dpp v126, v34 row_newbcast:0 row_mask:0xf bank_mask:0xf
v_mov_b32_dpp v127, v35 row_newbcast:0 row_mask:0xf bank_mask:0xf
v_mov_b32_dpp v128, v36 row_newbcast:0 row_mask:0xf bank_mask:0xf
v_mov_b32_dpp v129, v37 row_newbcast:0 row_mask:0xf bank_mask:0xf
v_mov_b32_dpp v130, v38 row_newbcast:0 row_mask:0xf bank_mask:0xf
v_mov_b32_dpp v131, v39 row_newbcast:0 row_mask:0xf bank_mask:0xf
v_accvgpr_write_b32 a236, v124
v_accvgpr_write_b32 a237, v125
v_accvgpr_write_b32 a238, v126
v_accvgpr_write_b32 a239, v127
v_accvgpr_write_b32 a240, v128
v_accvgpr_write_b32 a241, v129
v_accvgpr_write_b32 a242, v130
v_accvgpr_write_b32 a243, v131
s_waitcnt lgkmcnt(0)
s_nop 0
v_pk_fma_f32 v[32:33], v[124:125], v[104:105], v[32:33] op_sel_hi:[1,0,1] neg_lo:[0,1,0] neg_hi:[0,1,0]
v_pk_fma_f32 v[34:35], v[126:127], v[104:105], v[34:35] op_sel_hi:[1,0,1] neg_lo:[0,1,0] neg_hi:[0,1,0]
v_pk_mul_f32 v[32:33], v[32:33], v[104:105] op_sel:[0,1] op_sel_hi:[1,1]
v_pk_mul_f32 v[34:35], v[34:35], v[104:105] op_sel:[0,1] op_sel_hi:[1,1]
v_cvt_pk_bf16_f32 v32, v32, v33
v_cvt_pk_bf16_f32 v33, v34, v35
ds_write_b64 v252, v[32:33] offset:0
v_pk_fma_f32 v[36:37], v[128:129], v[104:105], v[36:37] op_sel_hi:[1,0,1] neg_lo:[0,1,0] neg_hi:[0,1,0]
v_pk_fma_f32 v[38:39], v[130:131], v[104:105], v[38:39] op_sel_hi:[1,0,1] neg_lo:[0,1,0] neg_hi:[0,1,0]
v_pk_mul_f32 v[36:37], v[36:37], v[104:105] op_sel:[0,1] op_sel_hi:[1,1]
v_pk_mul_f32 v[38:39], v[38:39], v[104:105] op_sel:[0,1] op_sel_hi:[1,1]
v_cvt_pk_bf16_f32 v36, v36, v37
v_cvt_pk_bf16_f32 v37, v38, v39
ds_write_b64 v253, v[36:37] offset:0
v_pk_fma_f32 v[40:41], v[124:125], v[106:107], v[40:41] op_sel_hi:[1,0,1] neg_lo:[0,1,0] neg_hi:[0,1,0]
v_pk_fma_f32 v[42:43], v[126:127], v[106:107], v[42:43] op_sel_hi:[1,0,1] neg_lo:[0,1,0] neg_hi:[0,1,0]
v_pk_mul_f32 v[40:41], v[40:41], v[106:107] op_sel:[0,1] op_sel_hi:[1,1]
v_pk_mul_f32 v[42:43], v[42:43], v[106:107] op_sel:[0,1] op_sel_hi:[1,1]
v_cvt_pk_bf16_f32 v40, v40, v41
v_cvt_pk_bf16_f32 v41, v42, v43
ds_write_b64 v252, v[40:41] offset:4864
v_pk_fma_f32 v[44:45], v[128:129], v[106:107], v[44:45] op_sel_hi:[1,0,1] neg_lo:[0,1,0] neg_hi:[0,1,0]
v_pk_fma_f32 v[46:47], v[130:131], v[106:107], v[46:47] op_sel_hi:[1,0,1] neg_lo:[0,1,0] neg_hi:[0,1,0]
v_pk_mul_f32 v[44:45], v[44:45], v[106:107] op_sel:[0,1] op_sel_hi:[1,1]
v_pk_mul_f32 v[46:47], v[46:47], v[106:107] op_sel:[0,1] op_sel_hi:[1,1]
v_cvt_pk_bf16_f32 v44, v44, v45
v_cvt_pk_bf16_f32 v45, v46, v47
ds_write_b64 v253, v[44:45] offset:4864
v_pk_fma_f32 v[48:49], v[124:125], v[108:109], v[48:49] op_sel_hi:[1,0,1] neg_lo:[0,1,0] neg_hi:[0,1,0]
v_pk_fma_f32 v[50:51], v[126:127], v[108:109], v[50:51] op_sel_hi:[1,0,1] neg_lo:[0,1,0] neg_hi:[0,1,0]
v_pk_mul_f32 v[48:49], v[48:49], v[108:109] op_sel:[0,1] op_sel_hi:[1,1]
v_pk_mul_f32 v[50:51], v[50:51], v[108:109] op_sel:[0,1] op_sel_hi:[1,1]
v_cvt_pk_bf16_f32 v48, v48, v49
v_cvt_pk_bf16_f32 v49, v50, v51
ds_write_b64 v252, v[48:49] offset:9728
v_pk_fma_f32 v[52:53], v[128:129], v[108:109], v[52:53] op_sel_hi:[1,0,1] neg_lo:[0,1,0] neg_hi:[0,1,0]
v_pk_fma_f32 v[54:55], v[130:131], v[108:109], v[54:55] op_sel_hi:[1,0,1] neg_lo:[0,1,0] neg_hi:[0,1,0]
v_pk_mul_f32 v[52:53], v[52:53], v[108:109] op_sel:[0,1] op_sel_hi:[1,1]
v_pk_mul_f32 v[54:55], v[54:55], v[108:109] op_sel:[0,1] op_sel_hi:[1,1]
v_cvt_pk_bf16_f32 v52, v52, v53
v_cvt_pk_bf16_f32 v53, v54, v55
ds_write_b64 v253, v[52:53] offset:9728
v_pk_fma_f32 v[56:57], v[124:125], v[110:111], v[56:57] op_sel_hi:[1,0,1] neg_lo:[0,1,0] neg_hi:[0,1,0]
v_pk_fma_f32 v[58:59], v[126:127], v[110:111], v[58:59] op_sel_hi:[1,0,1] neg_lo:[0,1,0] neg_hi:[0,1,0]
v_pk_mul_f32 v[56:57], v[56:57], v[110:111] op_sel:[0,1] op_sel_hi:[1,1]
v_pk_mul_f32 v[58:59], v[58:59], v[110:111] op_sel:[0,1] op_sel_hi:[1,1]
v_cvt_pk_bf16_f32 v56, v56, v57
v_cvt_pk_bf16_f32 v57, v58, v59
ds_write_b64 v252, v[56:57] offset:14592
v_pk_fma_f32 v[60:61], v[128:129], v[110:111], v[60:61] op_sel_hi:[1,0,1] neg_lo:[0,1,0] neg_hi:[0,1,0]
v_pk_fma_f32 v[62:63], v[130:131], v[110:111], v[62:63] op_sel_hi:[1,0,1] neg_lo:[0,1,0] neg_hi:[0,1,0]
v_pk_mul_f32 v[60:61], v[60:61], v[110:111] op_sel:[0,1] op_sel_hi:[1,1]
v_pk_mul_f32 v[62:63], v[62:63], v[110:111] op_sel:[0,1] op_sel_hi:[1,1]
v_cvt_pk_bf16_f32 v60, v60, v61
v_cvt_pk_bf16_f32 v61, v62, v63
ds_write_b64 v253, v[60:61] offset:14592
v_pk_fma_f32 v[64:65], v[124:125], v[112:113], v[64:65] op_sel_hi:[1,0,1] neg_lo:[0,1,0] neg_hi:[0,1,0]
v_pk_fma_f32 v[66:67], v[126:127], v[112:113], v[66:67] op_sel_hi:[1,0,1] neg_lo:[0,1,0] neg_hi:[0,1,0]
v_pk_mul_f32 v[64:65], v[64:65], v[112:113] op_sel:[0,1] op_sel_hi:[1,1]
v_pk_mul_f32 v[66:67], v[66:67], v[112:113] op_sel:[0,1] op_sel_hi:[1,1]
v_cvt_pk_bf16_f32 v64, v64, v65
v_cvt_pk_bf16_f32 v65, v66, v67
ds_write_b64 v252, v[64:65] offset:19456
v_pk_fma_f32 v[68:69], v[128:129], v[112:113], v[68:69] op_sel_hi:[1,0,1] neg_lo:[0,1,0] neg_hi:[0,1,0]
v_pk_fma_f32 v[70:71], v[130:131], v[112:113], v[70:71] op_sel_hi:[1,0,1] neg_lo:[0,1,0] neg_hi:[0,1,0]
v_pk_mul_f32 v[68:69], v[68:69], v[112:113] op_sel:[0,1] op_sel_hi:[1,1]
v_pk_mul_f32 v[70:71], v[70:71], v[112:113] op_sel:[0,1] op_sel_hi:[1,1]
v_cvt_pk_bf16_f32 v68, v68, v69
v_cvt_pk_bf16_f32 v69, v70, v71
ds_write_b64 v253, v[68:69] offset:19456
v_pk_fma_f32 v[72:73], v[124:125], v[114:115], v[72:73] op_sel_hi:[1,0,1] neg_lo:[0,1,0] neg_hi:[0,1,0]
v_pk_fma_f32 v[74:75], v[126:127], v[114:115], v[74:75] op_sel_hi:[1,0,1] neg_lo:[0,1,0] neg_hi:[0,1,0]
v_pk_mul_f32 v[72:73], v[72:73], v[114:115] op_sel:[0,1] op_sel_hi:[1,1]
v_pk_mul_f32 v[74:75], v[74:75], v[114:115] op_sel:[0,1] op_sel_hi:[1,1]
v_cvt_pk_bf16_f32 v72, v72, v73
v_cvt_pk_bf16_f32 v73, v74, v75
ds_write_b64 v252, v[72:73] offset:24320
v_pk_fma_f32 v[76:77], v[128:129], v[114:115], v[76:77] op_sel_hi:[1,0,1] neg_lo:[0,1,0] neg_hi:[0,1,0]
v_pk_fma_f32 v[78:79], v[130:131], v[114:115], v[78:79] op_sel_hi:[1,0,1] neg_lo:[0,1,0] neg_hi:[0,1,0]
v_pk_mul_f32 v[76:77], v[76:77], v[114:115] op_sel:[0,1] op_sel_hi:[1,1]
v_pk_mul_f32 v[78:79], v[78:79], v[114:115] op_sel:[0,1] op_sel_hi:[1,1]
v_cvt_pk_bf16_f32 v76, v76, v77
v_cvt_pk_bf16_f32 v77, v78, v79
ds_write_b64 v253, v[76:77] offset:24320
v_pk_fma_f32 v[80:81], v[124:125], v[116:117], v[80:81] op_sel_hi:[1,0,1] neg_lo:[0,1,0] neg_hi:[0,1,0]
v_pk_fma_f32 v[82:83], v[126:127], v[116:117], v[82:83] op_sel_hi:[1,0,1] neg_lo:[0,1,0] neg_hi:[0,1,0]
v_pk_mul_f32 v[80:81], v[80:81], v[116:117] op_sel:[0,1] op_sel_hi:[1,1]
v_pk_mul_f32 v[82:83], v[82:83], v[116:117] op_sel:[0,1] op_sel_hi:[1,1]
v_cvt_pk_bf16_f32 v80, v80, v81
v_cvt_pk_bf16_f32 v81, v82, v83
ds_write_b64 v252, v[80:81] offset:29184
v_pk_fma_f32 v[84:85], v[128:129], v[116:117], v[84:85] op_sel_hi:[1,0,1] neg_lo:[0,1,0] neg_hi:[0,1,0]
v_pk_fma_f32 v[86:87], v[130:131], v[116:117], v[86:87] op_sel_hi:[1,0,1] neg_lo:[0,1,0] neg_hi:[0,1,0]
v_pk_mul_f32 v[84:85], v[84:85], v[116:117] op_sel:[0,1] op_sel_hi:[1,1]
v_pk_mul_f32 v[86:87], v[86:87], v[116:117] op_sel:[0,1] op_sel_hi:[1,1]
v_cvt_pk_bf16_f32 v84, v84, v85
v_cvt_pk_bf16_f32 v85, v86, v87
ds_write_b64 v253, v[84:85] offset:29184
v_pk_fma_f32 v[88:89], v[124:125], v[118:119], v[88:89] op_sel_hi:[1,0,1] neg_lo:[0,1,0] neg_hi:[0,1,0]
v_pk_fma_f32 v[90:91], v[126:127], v[118:119], v[90:91] op_sel_hi:[1,0,1] neg_lo:[0,1,0] neg_hi:[0,1,0]
v_pk_mul_f32 v[88:89], v[88:89], v[118:119] op_sel:[0,1] op_sel_hi:[1,1]
v_pk_mul_f32 v[90:91], v[90:91], v[118:119] op_sel:[0,1] op_sel_hi:[1,1]
v_cvt_pk_bf16_f32 v88, v88, v89
v_cvt_pk_bf16_f32 v89, v90, v91
ds_write_b64 v252, v[88:89] offset:34048
v_pk_fma_f32 v[92:93], v[128:129], v[118:119], v[92:93] op_sel_hi:[1,0,1] neg_lo:[0,1,0] neg_hi:[0,1,0]
v_pk_fma_f32 v[94:95], v[130:131], v[118:119], v[94:95] op_sel_hi:[1,0,1] neg_lo:[0,1,0] neg_hi:[0,1,0]
v_pk_mul_f32 v[92:93], v[92:93], v[118:119] op_sel:[0,1] op_sel_hi:[1,1]
v_pk_mul_f32 v[94:95], v[94:95], v[118:119] op_sel:[0,1] op_sel_hi:[1,1]
v_cvt_pk_bf16_f32 v92, v92, v93
v_cvt_pk_bf16_f32 v93, v94, v95
ds_write_b64 v253, v[92:93] offset:34048
v_pk_fma_f32 v[96:97], v[124:125], v[120:121], v[96:97] op_sel_hi:[1,0,1] neg_lo:[0,1,0] neg_hi:[0,1,0]
v_pk_fma_f32 v[98:99], v[126:127], v[120:121], v[98:99] op_sel_hi:[1,0,1] neg_lo:[0,1,0] neg_hi:[0,1,0]
v_pk_mul_f32 v[96:97], v[96:97], v[120:121] op_sel:[0,1] op_sel_hi:[1,1]
v_pk_mul_f32 v[98:99], v[98:99], v[120:121] op_sel:[0,1] op_sel_hi:[1,1]
v_cvt_pk_bf16_f32 v96, v96, v97
v_cvt_pk_bf16_f32 v97, v98, v99
ds_write_b64 v252, v[96:97] offset:38912
v_pk_fma_f32 v[100:101], v[128:129], v[120:121], v[100:101] op_sel_hi:[1,0,1] neg_lo:[0,1,0] neg_hi:[0,1,0]
v_pk_fma_f32 v[102:103], v[130:131], v[120:121], v[102:103] op_sel_hi:[1,0,1] neg_lo:[0,1,0] neg_hi:[0,1,0]
v_pk_mul_f32 v[100:101], v[100:101], v[120:121] op_sel:[0,1] op_sel_hi:[1,1]
v_pk_mul_f32 v[102:103], v[102:103], v[120:121] op_sel:[0,1] op_sel_hi:[1,1]
v_cvt_pk_bf16_f32 v100, v100, v101
v_cvt_pk_bf16_f32 v101, v102, v103
ds_write_b64 v253, v[100:101] offset:38912
s_waitcnt lgkmcnt(0)
s_barrier
s_and_b32 s36, s16, 1
s_lshr_b32 s37, s16, 1
s_lshl_b32 s40, s36, 6
v_add_u32 v8, s40, v2
v_add_u32 v9, 2, v8
v_mul_u32_u24 v9, 304, v9
s_mul_i32 s41, s37, 144
v_add_u32 v9, s41, v9
s_lshl_b32 s41, s17, 7
v_add_u32 v10, s41, v8
ds_read_b128 v[192:195], v9 offset:4256
ds_read_b128 v[196:199], v9 offset:4272
ds_read_b64 v[200:201], v9 offset:4288
ds_read_b128 v[32:35], v9 offset:4304
ds_read_b128 v[36:39], v9 offset:4320
ds_read_b64 v[40:41], v9 offset:4336
ds_read_b128 v[42:45], v9 offset:3696
ds_read_b128 v[46:49], v9 offset:3712
ds_read_b64 v[50:51], v9 offset:3728
ds_read_b128 v[52:55], v9 offset:3088
s_add_u32 m0, s47, 0
s_add_u32 s48, s46, 0
buffer_load_dwordx4 v1, s[8:11], s48 offen offset:0 lds
ds_read_b128 v[56:59], v9 offset:3104
ds_read_b64 v[60:61], v9 offset:3120
ds_read_b128 v[62:65], v9 offset:2480
ds_read_b128 v[66:69], v9 offset:2496
ds_read_b64 v[70:71], v9 offset:2512
v_mov_b32 v11, 0xf149f2ca
v_mov_b32 v13, 0.3225964182229561
s_mov_b32 s42, 0x05040100
s_mov_b32 s43, 0x07060302
s_waitcnt lgkmcnt(9)
s_nop 0
buffer_load_dwordx4 v1, s[8:11], s48 offen offset:1024 lds
ds_read_b128 v[72:75], v9 offset:1872
ds_read_b128 v[76:79], v9 offset:1888
ds_read_b64 v[80:81], v9 offset:1904
v_dot2_f32_bf16 v204, v192, v32, 0
v_dot2_f32_bf16 v204, v193, v33, v204
v_dot2_f32_bf16 v204, v194, v34, v204
v_dot2_f32_bf16 v204, v195, v35, v204
v_dot2_f32_bf16 v204, v196, v36, v204
v_dot2_f32_bf16 v204, v197, v37, v204
v_dot2_f32_bf16 v204, v198, v38, v204
v_dot2_f32_bf16 v204, v199, v39, v204
buffer_load_dwordx4 v1, s[8:11], s48 offen offset:2048 lds
v_dot2_f32_bf16 v204, v200, v40, v204
v_dot2_f32_bf16 v204, v201, v41, v204
s_waitcnt lgkmcnt(9)
s_nop 0
ds_read_b128 v[82:85], v9 offset:1264
ds_read_b128 v[86:89], v9 offset:1280
ds_read_b64 v[90:91], v9 offset:1296
v_dot2_f32_bf16 v205, v192, v42, 0
v_dot2_f32_bf16 v205, v193, v43, v205
v_dot2_f32_bf16 v205, v194, v44, v205
v_dot2_f32_bf16 v205, v195, v45, v205
v_dot2_f32_bf16 v205, v196, v46, v205
buffer_load_dwordx4 v1, s[8:11], s48 offen offset:3072 lds
v_dot2_f32_bf16 v205, v197, v47, v205
v_dot2_f32_bf16 v205, v198, v48, v205
v_dot2_f32_bf16 v205, v199, v49, v205
v_dot2_f32_bf16 v205, v200, v50, v205
v_dot2_f32_bf16 v205, v201, v51, v205
s_waitcnt lgkmcnt(9)
s_nop 0
ds_read_b128 v[92:95], v9 offset:656
ds_read_b128 v[96:99], v9 offset:672
ds_read_b64 v[100:101], v9 offset:688
v_dot2_f32_bf16 v206, v192, v52, 0
v_dot2_f32_bf16 v206, v193, v53, v206
s_add_u32 m0, s47, 4096
s_add_u32 s48, s46, 4096
buffer_load_dwordx4 v1, s[8:11], s48 offen offset:0 lds
v_dot2_f32_bf16 v206, v194, v54, v206
v_dot2_f32_bf16 v206, v195, v55, v206
v_dot2_f32_bf16 v206, v196, v56, v206
v_dot2_f32_bf16 v206, v197, v57, v206
v_dot2_f32_bf16 v206, v198, v58, v206
v_dot2_f32_bf16 v206, v199, v59, v206
v_dot2_f32_bf16 v206, v200, v60, v206
v_dot2_f32_bf16 v206, v201, v61, v206
s_waitcnt lgkmcnt(9)
s_nop 0
ds_read_b128 v[102:105], v9 offset:48
ds_read_b128 v[106:109], v9 offset:64
buffer_load_dwordx4 v1, s[8:11], s48 offen offset:1024 lds
ds_read_b64 v[110:111], v9 offset:80
v_dot2_f32_bf16 v207, v192, v62, 0
v_dot2_f32_bf16 v207, v193, v63, v207
v_dot2_f32_bf16 v207, v194, v64, v207
v_dot2_f32_bf16 v207, v195, v65, v207
v_dot2_f32_bf16 v207, v196, v66, v207
v_dot2_f32_bf16 v207, v197, v67, v207
v_dot2_f32_bf16 v207, v198, v68, v207
v_dot2_f32_bf16 v207, v199, v69, v207
v_dot2_f32_bf16 v207, v200, v70, v207
v_dot2_f32_bf16 v207, v201, v71, v207
buffer_load_dwordx4 v1, s[8:11], s48 offen offset:2048 lds
s_waitcnt lgkmcnt(9)
s_nop 0
ds_read_b128 v[112:115], v9 offset:4352
ds_read_b128 v[116:119], v9 offset:4368
ds_read_b64 v[120:121], v9 offset:4384
v_dot2_f32_bf16 v208, v192, v72, 0
v_dot2_f32_bf16 v208, v193, v73, v208
v_dot2_f32_bf16 v208, v194, v74, v208
v_dot2_f32_bf16 v208, v195, v75, v208
v_dot2_f32_bf16 v208, v196, v76, v208
v_dot2_f32_bf16 v208, v197, v77, v208
v_dot2_f32_bf16 v208, v198, v78, v208
buffer_load_dwordx4 v1, s[8:11], s48 offen offset:3072 lds
v_dot2_f32_bf16 v208, v199, v79, v208
v_dot2_f32_bf16 v208, v200, v80, v208
v_dot2_f32_bf16 v208, v201, v81, v208
s_waitcnt lgkmcnt(9)
s_nop 0
ds_read_b128 v[122:125], v9 offset:3744
ds_read_b128 v[126:129], v9 offset:3760
ds_read_b64 v[130:131], v9 offset:3776
v_dot2_f32_bf16 v209, v192, v82, 0
v_dot2_f32_bf16 v209, v193, v83, v209
v_dot2_f32_bf16 v209, v194, v84, v209
v_dot2_f32_bf16 v209, v195, v85, v209
s_add_u32 m0, s47, 8192
s_add_u32 s48, s46, 8192
buffer_load_dwordx4 v1, s[8:11], s48 offen offset:0 lds
v_dot2_f32_bf16 v209, v196, v86, v209
v_dot2_f32_bf16 v209, v197, v87, v209
v_dot2_f32_bf16 v209, v198, v88, v209
v_dot2_f32_bf16 v209, v199, v89, v209
v_dot2_f32_bf16 v209, v200, v90, v209
v_dot2_f32_bf16 v209, v201, v91, v209
s_waitcnt lgkmcnt(9)
s_nop 0
ds_read_b128 v[132:135], v9 offset:3136
ds_read_b128 v[136:139], v9 offset:3152
ds_read_b64 v[140:141], v9 offset:3168
buffer_load_dwordx4 v1, s[8:11], s48 offen offset:1024 lds
v_dot2_f32_bf16 v210, v192, v92, 0
v_dot2_f32_bf16 v210, v193, v93, v210
v_dot2_f32_bf16 v210, v194, v94, v210
v_dot2_f32_bf16 v210, v195, v95, v210
v_dot2_f32_bf16 v210, v196, v96, v210
v_dot2_f32_bf16 v210, v197, v97, v210
v_dot2_f32_bf16 v210, v198, v98, v210
v_dot2_f32_bf16 v210, v199, v99, v210
v_dot2_f32_bf16 v210, v200, v100, v210
v_dot2_f32_bf16 v210, v201, v101, v210
s_waitcnt lgkmcnt(9)
s_nop 0
buffer_load_dwordx4 v1, s[8:11], s48 offen offset:2048 lds
ds_read_b128 v[142:145], v9 offset:2528
ds_read_b128 v[146:149], v9 offset:2544
ds_read_b64 v[150:151], v9 offset:2560
v_dot2_f32_bf16 v211, v192, v102, 0
v_dot2_f32_bf16 v211, v193, v103, v211
v_dot2_f32_bf16 v211, v194, v104, v211
v_dot2_f32_bf16 v211, v195, v105, v211
v_dot2_f32_bf16 v211, v196, v106, v211
v_dot2_f32_bf16 v211, v197, v107, v211
v_dot2_f32_bf16 v211, v198, v108, v211
v_dot2_f32_bf16 v211, v199, v109, v211
buffer_load_dwordx4 v1, s[8:11], s48 offen offset:3072 lds
v_dot2_f32_bf16 v211, v200, v110, v211
v_dot2_f32_bf16 v211, v201, v111, v211
ds_read_b128 v[152:155], v9 offset:1920
ds_read_b128 v[156:159], v9 offset:1936
ds_read_b64 v[160:161], v9 offset:1952
ds_read_b128 v[162:165], v9 offset:1312
ds_read_b128 v[166:169], v9 offset:1328
ds_read_b64 v[170:171], v9 offset:1344
ds_read_b128 v[172:175], v9 offset:704
ds_read_b128 v[176:179], v9 offset:720
ds_read_b64 v[180:181], v9 offset:736
s_add_u32 m0, s47, 12288
s_add_u32 s48, s46, 12288
buffer_load_dwordx4 v1, s[8:11], s48 offen offset:0 lds
ds_read_b128 v[182:185], v9 offset:96
ds_read_b128 v[186:189], v9 offset:112
ds_read_b64 v[190:191], v9 offset:128
s_cmp_lg_u32 s17, 0
s_cbranch_scc1 L_nomask_59
v_cmp_le_u32 s[34:35], 2, v10
s_nop 0
s_nop 0
v_cmp_le_u32 s[32:33], 4, v10
v_cndmask_b32 v205, v11, v205, s[34:35]
v_cmp_le_u32 s[34:35], 6, v10
v_cndmask_b32 v206, v11, v206, s[32:33]
v_cmp_le_u32 s[32:33], 8, v10
v_cndmask_b32 v207, v11, v207, s[34:35]
v_cmp_le_u32 s[34:35], 10, v10
v_cndmask_b32 v208, v11, v208, s[32:33]
v_cmp_le_u32 s[32:33], 12, v10
v_cndmask_b32 v209, v11, v209, s[34:35]
v_cmp_le_u32 s[34:35], 14, v10
v_cndmask_b32 v210, v11, v210, s[32:33]
s_nop 0
s_nop 0
v_cndmask_b32 v211, v11, v211, s[34:35]
L_nomask_59:
buffer_load_dwordx4 v1, s[8:11], s48 offen offset:1024 lds
buffer_load_dwordx4 v1, s[8:11], s48 offen offset:2048 lds
v_max3_f32 v12, v204, v205, v206
v_max3_f32 v12, v12, v207, v208
v_max3_f32 v12, v12, v209, v210
v_max_f32 v12, v12, v211
v_mul_f32 v12, v12, v13
v_fma_f32 v204, v204, v13, -v12
v_fma_f32 v205, v205, v13, -v12
v_fma_f32 v206, v206, v13, -v12
v_fma_f32 v207, v207, v13, -v12
v_fma_f32 v208, v208, v13, -v12
v_fma_f32 v209, v209, v13, -v12
buffer_load_dwordx4 v1, s[8:11], s48 offen offset:3072 lds
v_fma_f32 v210, v210, v13, -v12
v_fma_f32 v211, v211, v13, -v12
v_exp_f32 v204, v204
v_exp_f32 v205, v205
v_exp_f32 v206, v206
v_exp_f32 v207, v207
v_exp_f32 v208, v208
v_exp_f32 v209, v209
v_exp_f32 v210, v210
v_exp_f32 v211, v211
s_nop 0
s_add_u32 m0, s47, 16384
s_add_u32 s48, s46, 16384
buffer_load_dwordx4 v1, s[8:11], s48 offen offset:0 lds
v_add_f32 v12, v204, v205
v_add_f32 v14, v206, v207
v_add_f32 v15, v208, v209
v_add_f32 v11, v210, v211
v_add_f32 v12, v12, v14
v_add_f32 v15, v15, v11
v_add_f32 v12, v12, v15
v_rcp_f32 v12, v12
s_nop 0
v_mul_f32 v204, v204, v12
buffer_load_dwordx4 v1, s[8:11], s48 offen offset:1024 lds
v_mul_f32 v205, v205, v12
v_mul_f32 v206, v206, v12
v_mul_f32 v207, v207, v12
v_mul_f32 v208, v208, v12
v_mul_f32 v209, v209, v12
v_mul_f32 v210, v210, v12
v_mul_f32 v211, v211, v12
v_cvt_pk_bf16_f32 v212, v204, v205
v_cvt_pk_bf16_f32 v213, v206, v207
v_cvt_pk_bf16_f32 v214, v208, v209
v_cvt_pk_bf16_f32 v215, v210, v211
buffer_load_dwordx4 v1, s[8:11], s48 offen offset:2048 lds
s_waitcnt lgkmcnt(15)
s_nop 0
v_perm_b32 v216, v122, v112, s42
v_perm_b32 v217, v122, v112, s43
v_dot2_f32_bf16 v32, v212, v216, 0
v_dot2_f32_bf16 v33, v212, v217, 0
v_perm_b32 v218, v123, v113, s42
v_perm_b32 v219, v123, v113, s43
v_dot2_f32_bf16 v34, v212, v218, 0
v_dot2_f32_bf16 v35, v212, v219, 0
v_perm_b32 v220, v124, v114, s42
v_perm_b32 v221, v124, v114, s43
buffer_load_dwordx4 v1, s[8:11], s48 offen offset:3072 lds
v_dot2_f32_bf16 v36, v212, v220, 0
v_dot2_f32_bf16 v37, v212, v221, 0
v_perm_b32 v222, v125, v115, s42
v_perm_b32 v223, v125, v115, s43
v_dot2_f32_bf16 v38, v212, v222, 0
v_dot2_f32_bf16 v39, v212, v223, 0
v_perm_b32 v216, v126, v116, s42
v_perm_b32 v217, v126, v116, s43
v_dot2_f32_bf16 v40, v212, v216, 0
v_dot2_f32_bf16 v41, v212, v217, 0
v_perm_b32 v218, v127, v117, s42
s_add_u32 m0, s47, 20480
s_add_u32 s48, s46, 20480
buffer_load_dwordx4 v1, s[8:11], s48 offen offset:0 lds
v_perm_b32 v219, v127, v117, s43
v_dot2_f32_bf16 v42, v212, v218, 0
v_dot2_f32_bf16 v43, v212, v219, 0
v_perm_b32 v220, v128, v118, s42
v_perm_b32 v221, v128, v118, s43
v_dot2_f32_bf16 v44, v212, v220, 0
v_dot2_f32_bf16 v45, v212, v221, 0
v_perm_b32 v222, v129, v119, s42
v_perm_b32 v223, v129, v119, s43
v_dot2_f32_bf16 v46, v212, v222, 0
v_dot2_f32_bf16 v47, v212, v223, 0
buffer_load_dwordx4 v1, s[8:11], s48 offen offset:1024 lds
v_perm_b32 v216, v130, v120, s42
v_perm_b32 v217, v130, v120, s43
v_dot2_f32_bf16 v48, v212, v216, 0
v_dot2_f32_bf16 v49, v212, v217, 0
v_perm_b32 v218, v131, v121, s42
v_perm_b32 v219, v131, v121, s43
v_dot2_f32_bf16 v50, v212, v218, 0
v_dot2_f32_bf16 v51, v212, v219, 0
s_waitcnt lgkmcnt(12)
s_nop 0
v_perm_b32 v216, v142, v132, s42
v_perm_b32 v217, v142, v132, s43
buffer_load_dwordx4 v1, s[8:11], s48 offen offset:2048 lds
v_dot2_f32_bf16 v32, v213, v216, v32
v_dot2_f32_bf16 v33, v213, v217, v33
v_perm_b32 v218, v143, v133, s42
v_perm_b32 v219, v143, v133, s43
v_dot2_f32_bf16 v34, v213, v218, v34
v_dot2_f32_bf16 v35, v213, v219, v35
v_perm_b32 v220, v144, v134, s42
v_perm_b32 v221, v144, v134, s43
v_dot2_f32_bf16 v36, v213, v220, v36
v_dot2_f32_bf16 v37, v213, v221, v37
v_perm_b32 v222, v145, v135, s42
buffer_load_dwordx4 v1, s[8:11], s48 offen offset:3072 lds
v_perm_b32 v223, v145, v135, s43
v_dot2_f32_bf16 v38, v213, v222, v38
v_dot2_f32_bf16 v39, v213, v223, v39
v_perm_b32 v216, v146, v136, s42
v_perm_b32 v217, v146, v136, s43
v_dot2_f32_bf16 v40, v213, v216, v40
v_dot2_f32_bf16 v41, v213, v217, v41
v_perm_b32 v218, v147, v137, s42
v_perm_b32 v219, v147, v137, s43
v_dot2_f32_bf16 v42, v213, v218, v42
v_dot2_f32_bf16 v43, v213, v219, v43
s_add_u32 m0, s47, 24576
s_add_u32 s48, s46, 24576
buffer_load_dwordx4 v1, s[8:11], s48 offen offset:0 lds
v_perm_b32 v220, v148, v138, s42
v_perm_b32 v221, v148, v138, s43
v_dot2_f32_bf16 v44, v213, v220, v44
v_dot2_f32_bf16 v45, v213, v221, v45
v_perm_b32 v222, v149, v139, s42
v_perm_b32 v223, v149, v139, s43
v_dot2_f32_bf16 v46, v213, v222, v46
v_dot2_f32_bf16 v47, v213, v223, v47
v_perm_b32 v216, v150, v140, s42
v_perm_b32 v217, v150, v140, s43
v_dot2_f32_bf16 v48, v213, v216, v48
v_dot2_f32_bf16 v49, v213, v217, v49
v_perm_b32 v218, v151, v141, s42
v_perm_b32 v219, v151, v141, s43
v_dot2_f32_bf16 v50, v213, v218, v50
v_dot2_f32_bf16 v51, v213, v219, v51
s_waitcnt lgkmcnt(6)
s_nop 0
v_perm_b32 v216, v162, v152, s42
v_perm_b32 v217, v162, v152, s43
v_dot2_f32_bf16 v32, v214, v216, v32
v_dot2_f32_bf16 v33, v214, v217, v33
v_perm_b32 v218, v163, v153, s42
v_perm_b32 v219, v163, v153, s43
v_dot2_f32_bf16 v34, v214, v218, v34
v_dot2_f32_bf16 v35, v214, v219, v35
v_perm_b32 v220, v164, v154, s42
v_perm_b32 v221, v164, v154, s43
v_dot2_f32_bf16 v36, v214, v220, v36
v_dot2_f32_bf16 v37, v214, v221, v37
v_perm_b32 v222, v165, v155, s42
v_perm_b32 v223, v165, v155, s43
v_dot2_f32_bf16 v38, v214, v222, v38
v_dot2_f32_bf16 v39, v214, v223, v39
v_perm_b32 v216, v166, v156, s42
v_perm_b32 v217, v166, v156, s43
v_dot2_f32_bf16 v40, v214, v216, v40
v_dot2_f32_bf16 v41, v214, v217, v41
v_perm_b32 v218, v167, v157, s42
v_perm_b32 v219, v167, v157, s43
v_dot2_f32_bf16 v42, v214, v218, v42
v_dot2_f32_bf16 v43, v214, v219, v43
v_perm_b32 v220, v168, v158, s42
v_perm_b32 v221, v168, v158, s43
v_dot2_f32_bf16 v44, v214, v220, v44
v_dot2_f32_bf16 v45, v214, v221, v45
v_perm_b32 v222, v169, v159, s42
v_perm_b32 v223, v169, v159, s43
v_dot2_f32_bf16 v46, v214, v222, v46
v_dot2_f32_bf16 v47, v214, v223, v47
v_perm_b32 v216, v170, v160, s42
v_perm_b32 v217, v170, v160, s43
v_dot2_f32_bf16 v48, v214, v216, v48
v_dot2_f32_bf16 v49, v214, v217, v49
v_perm_b32 v218, v171, v161, s42
v_perm_b32 v219, v171, v161, s43
v_dot2_f32_bf16 v50, v214, v218, v50
v_dot2_f32_bf16 v51, v214, v219, v51
s_waitcnt lgkmcnt(0)
s_nop 0
v_perm_b32 v216, v182, v172, s42
v_perm_b32 v217, v182, v172, s43
v_dot2_f32_bf16 v32, v215, v216, v32
v_dot2_f32_bf16 v33, v215, v217, v33
v_perm_b32 v218, v183, v173, s42
v_perm_b32 v219, v183, v173, s43
v_dot2_f32_bf16 v34, v215, v218, v34
v_dot2_f32_bf16 v35, v215, v219, v35
v_perm_b32 v220, v184, v174, s42
v_perm_b32 v221, v184, v174, s43
v_dot2_f32_bf16 v36, v215, v220, v36
v_dot2_f32_bf16 v37, v215, v221, v37
v_perm_b32 v222, v185, v175, s42
v_perm_b32 v223, v185, v175, s43
v_dot2_f32_bf16 v38, v215, v222, v38
v_dot2_f32_bf16 v39, v215, v223, v39
v_perm_b32 v216, v186, v176, s42
v_perm_b32 v217, v186, v176, s43
v_dot2_f32_bf16 v40, v215, v216, v40
v_dot2_f32_bf16 v41, v215, v217, v41
v_perm_b32 v218, v187, v177, s42
v_perm_b32 v219, v187, v177, s43
v_dot2_f32_bf16 v42, v215, v218, v42
v_dot2_f32_bf16 v43, v215, v219, v43
v_perm_b32 v220, v188, v178, s42
v_perm_b32 v221, v188, v178, s43
v_dot2_f32_bf16 v44, v215, v220, v44
v_dot2_f32_bf16 v45, v215, v221, v45
v_perm_b32 v222, v189, v179, s42
v_perm_b32 v223, v189, v179, s43
v_dot2_f32_bf16 v46, v215, v222, v46
v_dot2_f32_bf16 v47, v215, v223, v47
v_perm_b32 v216, v190, v180, s42
v_perm_b32 v217, v190, v180, s43
v_dot2_f32_bf16 v48, v215, v216, v48
v_dot2_f32_bf16 v49, v215, v217, v49
v_perm_b32 v218, v191, v181, s42
v_perm_b32 v219, v191, v181, s43
v_dot2_f32_bf16 v50, v215, v218, v50
v_dot2_f32_bf16 v51, v215, v219, v51
s_nop 2
s_nop 0
v_cvt_pk_bf16_f32 v56, v32, v33
v_cvt_pk_bf16_f32 v57, v34, v35
v_cvt_pk_bf16_f32 v58, v36, v37
v_cvt_pk_bf16_f32 v59, v38, v39
v_cvt_pk_bf16_f32 v60, v40, v41
v_cvt_pk_bf16_f32 v61, v42, v43
v_cvt_pk_bf16_f32 v62, v44, v45
v_cvt_pk_bf16_f32 v63, v46, v47
v_cvt_pk_bf16_f32 v64, v48, v49
v_cvt_pk_bf16_f32 v65, v50, v51
buffer_store_dwordx2 v[56:57], v232, s[8:11], s25 offen
buffer_store_dwordx2 v[58:59], v233, s[8:11], s25 offen
buffer_store_dwordx2 v[60:61], v234, s[8:11], s25 offen
buffer_store_dwordx2 v[62:63], v235, s[8:11], s25 offen
buffer_store_dwordx2 v[64:65], v236, s[8:11], s25 offen
v_pk_add_f32 v[224:225], v[224:225], v[228:229]
v_pk_add_f32 v[226:227], v[226:227], v[230:231]
v_accvgpr_write_b32 a232, v224
v_accvgpr_write_b32 a233, v225
v_accvgpr_write_b32 a234, v226
v_accvgpr_write_b32 a235, v227
L_mid:
s_add_u32 s56, s56, 1
v_mov_b32 v8, s56
v_mov_b32 v9, s57
s_mov_b64 s[38:39], exec
s_waitcnt vmcnt(0)
s_mov_b64 exec, 1
buffer_store_dword v8, v9, s[8:11], 0 offen
s_mov_b64 exec, s[38:39]
s_cmp_lg_u32 s16, 0
s_cbranch_scc1 L_tb_60
v_lshlrev_b32 v10, 2, v2
v_add_u32 v10, s58, v10
s_mov_b32 s40, 0
L_poll_61:
buffer_load_dword v11, v10, s[8:11], 0 offen sc1
s_add_u32 s40, s40, 1
s_cmp_gt_u32 s40, 40000
s_cbranch_scc1 L_polld_62
s_waitcnt vmcnt(0)
v_subrev_u32 v11, s56, v11
v_cmp_lt_u32 vcc, 1, v11
s_cbranch_vccnz L_poll_61
L_polld_62:
L_tb_60:
s_barrier
s_lshl_b32 s44, s100, 10
s_add_u32 s44, s44, s25
s_add_u32 s45, s44, 0
buffer_load_dwordx4 a[0:3], v1, s[8:11], s45 offen sc1
s_add_u32 s45, s44, 8192
buffer_load_dwordx4 a[4:7], v1, s[8:11], s45 offen sc1
s_add_u32 s45, s44, 16384
buffer_load_dwordx4 a[8:11], v1, s[8:11], s45 offen sc1
s_add_u32 s45, s44, 24576
buffer_load_dwordx4 a[12:15], v1, s[8:11], s45 offen sc1
s_add_u32 s45, s44, 32768
buffer_load_dwordx4 a[16:19], v1, s[8:11], s45 offen sc1
s_add_u32 s45, s44, 40960
buffer_load_dwordx4 a[20:23], v1, s[8:11], s45 offen sc1
s_add_u32 s45, s44, 49152
buffer_load_dwordx4 a[24:27], v1, s[8:11], s45 offen sc1
s_add_u32 s45, s44, 57344
buffer_load_dwordx4 a[28:31], v1, s[8:11], s45 offen sc1
v_add_u32 v5, 57344, v1
v_add_u32 v6, 108544, v1
ds_read_b128 v[56:59], v5 offset:0
ds_read_b128 v[60:63], v5 offset:1024
ds_read_b128 v[64:67], v5 offset:2048
ds_read_b128 v[68:71], v5 offset:3072
ds_read_b128 v[72:75], v5 offset:4096
ds_read_b128 v[76:79], v5 offset:5120
ds_read_b128 v[80:83], v5 offset:6144
ds_read_b128 v[84:87], v5 offset:7168
ds_read_b128 v[88:91], v5 offset:8192
ds_read_b128 v[92:95], v5 offset:9216
s_waitcnt lgkmcnt(8) vmcnt(7)
v_mfma_f32_16x16x32_bf16 v[32:35], v[56:59], a[0:3], 0
ds_read_b128 v[96:99], v5 offset:10240
s_add_u32 s45, s44, 65536
v_mfma_f32_16x16x32_bf16 v[36:39], v[60:63], a[0:3], 0
ds_read_b128 v[100:103], v5 offset:11264
s_waitcnt lgkmcnt(8)
v_mfma_f32_16x16x32_bf16 v[40:43], v[64:67], a[0:3], 0
ds_read_b128 v[56:59], v5 offset:12288
buffer_load_dwordx4 a[32:35], v1, s[8:11], s45 offen sc1
v_mfma_f32_16x16x32_bf16 v[44:47], v[68:71], a[0:3], 0
ds_read_b128 v[60:63], v5 offset:13312
s_waitcnt lgkmcnt(8) vmcnt(7)
v_mfma_f32_16x16x32_bf16 v[48:51], v[72:75], a[0:3], 0
ds_read_b128 v[64:67], v5 offset:14336
s_add_u32 s45, s44, 73728
v_mfma_f32_16x16x32_bf16 v[32:35], v[76:79], a[4:7], v[32:35]
ds_read_b128 v[68:71], v5 offset:15360
s_waitcnt lgkmcnt(8)
v_mfma_f32_16x16x32_bf16 v[36:39], v[80:83], a[4:7], v[36:39]
ds_read_b128 v[72:75], v5 offset:16384
buffer_load_dwordx4 a[36:39], v1, s[8:11], s45 offen sc1
v_mfma_f32_16x16x32_bf16 v[40:43], v[84:87], a[4:7], v[40:43]
ds_read_b128 v[76:79], v5 offset:17408
s_waitcnt lgkmcnt(8)
v_mfma_f32_16x16x32_bf16 v[44:47], v[88:91], a[4:7], v[44:47]
ds_read_b128 v[80:83], v5 offset:18432
s_add_u32 s45, s44, 81920
v_mfma_f32_16x16x32_bf16 v[48:51], v[92:95], a[4:7], v[48:51]
ds_read_b128 v[84:87], v5 offset:19456
s_waitcnt lgkmcnt(8) vmcnt(7)
v_mfma_f32_16x16x32_bf16 v[32:35], v[96:99], a[8:11], v[32:35]
ds_read_b128 v[88:91], v5 offset:20480
buffer_load_dwordx4 a[40:43], v1, s[8:11], s45 offen sc1
v_mfma_f32_16x16x32_bf16 v[36:39], v[100:103], a[8:11], v[36:39]
ds_read_b128 v[92:95], v5 offset:21504
s_waitcnt lgkmcnt(8)
v_mfma_f32_16x16x32_bf16 v[40:43], v[56:59], a[8:11], v[40:43]
ds_read_b128 v[96:99], v5 offset:22528
s_add_u32 s45, s44, 90112
v_mfma_f32_16x16x32_bf16 v[44:47], v[60:63], a[8:11], v[44:47]
ds_read_b128 v[100:103], v5 offset:23552
s_waitcnt lgkmcnt(8) vmcnt(7)
v_mfma_f32_16x16x32_bf16 v[48:51], v[64:67], a[8:11], v[48:51]
ds_read_b128 v[56:59], v5 offset:24576
buffer_load_dwordx4 a[44:47], v1, s[8:11], s45 offen sc1
v_mfma_f32_16x16x32_bf16 v[32:35], v[68:71], a[12:15], v[32:35]
ds_read_b128 v[60:63], v5 offset:25600
s_waitcnt lgkmcnt(8)
v_mfma_f32_16x16x32_bf16 v[36:39], v[72:75], a[12:15], v[36:39]
ds_read_b128 v[64:67], v5 offset:26624
s_add_u32 s45, s44, 98304
v_mfma_f32_16x16x32_bf16 v[40:43], v[76:79], a[12:15], v[40:43]
ds_read_b128 v[68:71], v5 offset:27648
s_waitcnt lgkmcnt(8)
v_mfma_f32_16x16x32_bf16 v[44:47], v[80:83], a[12:15], v[44:47]
ds_read_b128 v[72:75], v5 offset:28672
buffer_load_dwordx4 a[48:51], v1, s[8:11], s45 offen sc1
v_mfma_f32_16x16x32_bf16 v[48:51], v[84:87], a[12:15], v[48:51]
ds_read_b128 v[76:79], v5 offset:29696
s_waitcnt lgkmcnt(8) vmcnt(8)
v_mfma_f32_16x16x32_bf16 v[32:35], v[88:91], a[16:19], v[32:35]
ds_read_b128 v[80:83], v5 offset:30720
s_add_u32 s45, s44, 106496
v_mfma_f32_16x16x32_bf16 v[36:39], v[92:95], a[16:19], v[36:39]
ds_read_b128 v[84:87], v5 offset:31744
s_waitcnt lgkmcnt(8)
v_mfma_f32_16x16x32_bf16 v[40:43], v[96:99], a[16:19], v[40:43]
ds_read_b128 v[88:91], v5 offset:32768
buffer_load_dwordx4 a[52:55], v1, s[8:11], s45 offen sc1
v_mfma_f32_16x16x32_bf16 v[44:47], v[100:103], a[16:19], v[44:47]
ds_read_b128 v[92:95], v5 offset:33792
s_waitcnt lgkmcnt(8) vmcnt(8)
v_mfma_f32_16x16x32_bf16 v[48:51], v[56:59], a[16:19], v[48:51]
ds_read_b128 v[96:99], v5 offset:34816
s_add_u32 s45, s44, 114688
v_mfma_f32_16x16x32_bf16 v[32:35], v[60:63], a[20:23], v[32:35]
ds_read_b128 v[100:103], v5 offset:35840
s_waitcnt lgkmcnt(8)
v_mfma_f32_16x16x32_bf16 v[36:39], v[64:67], a[20:23], v[36:39]
ds_read_b128 v[56:59], v5 offset:36864
buffer_load_dwordx4 a[56:59], v1, s[8:11], s45 offen sc1
v_mfma_f32_16x16x32_bf16 v[40:43], v[68:71], a[20:23], v[40:43]
ds_read_b128 v[60:63], v5 offset:37888
s_waitcnt lgkmcnt(8)
v_mfma_f32_16x16x32_bf16 v[44:47], v[72:75], a[20:23], v[44:47]
ds_read_b128 v[64:67], v5 offset:38912
s_add_u32 s45, s44, 122880
v_mfma_f32_16x16x32_bf16 v[48:51], v[76:79], a[20:23], v[48:51]
ds_read_b128 v[68:71], v5 offset:39936
s_waitcnt lgkmcnt(8) vmcnt(8)
v_mfma_f32_16x16x32_bf16 v[32:35], v[80:83], a[24:27], v[32:35]
ds_read_b128 v[72:75], v5 offset:40960
buffer_load_dwordx4 a[60:63], v1, s[8:11], s45 offen sc1
v_mfma_f32_16x16x32_bf16 v[36:39], v[84:87], a[24:27], v[36:39]
ds_read_b128 v[76:79], v5 offset:41984
s_waitcnt lgkmcnt(8)
v_mfma_f32_16x16x32_bf16 v[40:43], v[88:91], a[24:27], v[40:43]
ds_read_b128 v[80:83], v5 offset:43008
s_add_u32 s45, s44, 131072
v_mfma_f32_16x16x32_bf16 v[44:47], v[92:95], a[24:27], v[44:47]
ds_read_b128 v[84:87], v5 offset:44032
s_waitcnt lgkmcnt(8) vmcnt(8)
v_mfma_f32_16x16x32_bf16 v[48:51], v[96:99], a[24:27], v[48:51]
ds_read_b128 v[88:91], v5 offset:45056
buffer_load_dwordx4 a[64:67], v1, s[8:11], s45 offen sc1
v_mfma_f32_16x16x32_bf16 v[32:35], v[100:103], a[28:31], v[32:35]
ds_read_b128 v[92:95], v5 offset:46080
s_waitcnt lgkmcnt(8)
v_mfma_f32_16x16x32_bf16 v[36:39], v[56:59], a[28:31], v[36:39]
ds_read_b128 v[96:99], v5 offset:47104
s_add_u32 s45, s44, 139264
v_mfma_f32_16x16x32_bf16 v[40:43], v[60:63], a[28:31], v[40:43]
ds_read_b128 v[100:103], v5 offset:48128
s_waitcnt lgkmcnt(8)
v_mfma_f32_16x16x32_bf16 v[44:47], v[64:67], a[28:31], v[44:47]
ds_read_b128 v[56:59], v5 offset:49152
buffer_load_dwordx4 a[68:71], v1, s[8:11], s45 offen sc1
v_mfma_f32_16x16x32_bf16 v[48:51], v[68:71], a[28:31], v[48:51]
ds_read_b128 v[60:63], v5 offset:50176
s_waitcnt lgkmcnt(8) vmcnt(9)
v_mfma_f32_16x16x32_bf16 v[32:35], v[72:75], a[32:35], v[32:35]
ds_read_b128 v[64:67], v6 offset:0
s_add_u32 s45, s44, 147456
v_mfma_f32_16x16x32_bf16 v[36:39], v[76:79], a[32:35], v[36:39]
ds_read_b128 v[68:71], v6 offset:1024
s_waitcnt lgkmcnt(8)
v_mfma_f32_16x16x32_bf16 v[40:43], v[80:83], a[32:35], v[40:43]
ds_read_b128 v[72:75], v6 offset:2048
buffer_load_dwordx4 a[72:75], v1, s[8:11], s45 offen sc1
v_mfma_f32_16x16x32_bf16 v[44:47], v[84:87], a[32:35], v[44:47]
ds_read_b128 v[76:79], v6 offset:3072
s_waitcnt lgkmcnt(8) vmcnt(9)
v_mfma_f32_16x16x32_bf16 v[48:51], v[88:91], a[32:35], v[48:51]
ds_read_b128 v[80:83], v6 offset:4096
s_add_u32 s45, s44, 155648
v_mfma_f32_16x16x32_bf16 v[32:35], v[92:95], a[36:39], v[32:35]
ds_read_b128 v[84:87], v6 offset:5120
s_waitcnt lgkmcnt(8)
v_mfma_f32_16x16x32_bf16 v[36:39], v[96:99], a[36:39], v[36:39]
ds_read_b128 v[88:91], v6 offset:6144
buffer_load_dwordx4 a[76:79], v1, s[8:11], s45 offen sc1
v_mfma_f32_16x16x32_bf16 v[40:43], v[100:103], a[36:39], v[40:43]
ds_read_b128 v[92:95], v6 offset:7168
s_waitcnt lgkmcnt(8)
v_mfma_f32_16x16x32_bf16 v[44:47], v[56:59], a[36:39], v[44:47]
ds_read_b128 v[96:99], v6 offset:8192
s_add_u32 m0, s30, 0
v_mfma_f32_16x16x32_bf16 v[48:51], v[60:63], a[36:39], v[48:51]
ds_read_b128 v[100:103], v6 offset:9216
s_waitcnt lgkmcnt(8) vmcnt(9)
v_mfma_f32_16x16x32_bf16 v[32:35], v[64:67], a[40:43], v[32:35]
ds_read_b128 v[56:59], v6 offset:10240
s_add_u32 s43, s27, 0
v_mfma_f32_16x16x32_bf16 v[36:39], v[68:71], a[40:43], v[36:39]
ds_read_b128 v[60:63], v6 offset:11264
s_waitcnt lgkmcnt(8)
v_mfma_f32_16x16x32_bf16 v[40:43], v[72:75], a[40:43], v[40:43]
ds_read_b128 v[64:67], v6 offset:12288
buffer_load_dwordx4 v1, s[8:11], s43 offen offset:0 lds
v_mfma_f32_16x16x32_bf16 v[44:47], v[76:79], a[40:43], v[44:47]
ds_read_b128 v[68:71], v6 offset:13312
s_waitcnt lgkmcnt(8) vmcnt(9)
v_mfma_f32_16x16x32_bf16 v[48:51], v[80:83], a[40:43], v[48:51]
ds_read_b128 v[72:75], v6 offset:14336
buffer_load_dwordx4 v1, s[8:11], s43 offen offset:1024 lds
v_mfma_f32_16x16x32_bf16 v[32:35], v[84:87], a[44:47], v[32:35]
ds_read_b128 v[76:79], v6 offset:15360
s_waitcnt lgkmcnt(8)
v_mfma_f32_16x16x32_bf16 v[36:39], v[88:91], a[44:47], v[36:39]
ds_read_b128 v[80:83], v6 offset:16384
buffer_load_dwordx4 v1, s[8:11], s43 offen offset:2048 lds
v_mfma_f32_16x16x32_bf16 v[40:43], v[92:95], a[44:47], v[40:43]
ds_read_b128 v[84:87], v6 offset:17408
s_waitcnt lgkmcnt(8)
v_mfma_f32_16x16x32_bf16 v[44:47], v[96:99], a[44:47], v[44:47]
ds_read_b128 v[88:91], v6 offset:18432
buffer_load_dwordx4 v1, s[8:11], s43 offen offset:3072 lds
v_mfma_f32_16x16x32_bf16 v[48:51], v[100:103], a[44:47], v[48:51]
ds_read_b128 v[92:95], v6 offset:19456
s_waitcnt lgkmcnt(8) vmcnt(11)
v_mfma_f32_16x16x32_bf16 v[32:35], v[56:59], a[48:51], v[32:35]
ds_read_b128 v[96:99], v6 offset:20480
s_add_u32 m0, s30, 4096
v_mfma_f32_16x16x32_bf16 v[36:39], v[60:63], a[48:51], v[36:39]
ds_read_b128 v[100:103], v6 offset:21504
s_waitcnt lgkmcnt(8)
v_mfma_f32_16x16x32_bf16 v[40:43], v[64:67], a[48:51], v[40:43]
ds_read_b128 v[56:59], v6 offset:22528
s_add_u32 s43, s27, 4096
v_mfma_f32_16x16x32_bf16 v[44:47], v[68:71], a[48:51], v[44:47]
ds_read_b128 v[60:63], v6 offset:23552
s_waitcnt lgkmcnt(8) vmcnt(10)
v_mfma_f32_16x16x32_bf16 v[48:51], v[72:75], a[48:51], v[48:51]
ds_read_b128 v[64:67], v6 offset:24576
buffer_load_dwordx4 v1, s[8:11], s43 offen offset:0 lds
v_mfma_f32_16x16x32_bf16 v[32:35], v[76:79], a[52:55], v[32:35]
ds_read_b128 v[68:71], v6 offset:25600
s_waitcnt lgkmcnt(8)
v_mfma_f32_16x16x32_bf16 v[36:39], v[80:83], a[52:55], v[36:39]
ds_read_b128 v[72:75], v6 offset:26624
buffer_load_dwordx4 v1, s[8:11], s43 offen offset:1024 lds
v_mfma_f32_16x16x32_bf16 v[40:43], v[84:87], a[52:55], v[40:43]
ds_read_b128 v[76:79], v6 offset:27648
s_waitcnt lgkmcnt(8)
v_mfma_f32_16x16x32_bf16 v[44:47], v[88:91], a[52:55], v[44:47]
ds_read_b128 v[80:83], v6 offset:28672
buffer_load_dwordx4 v1, s[8:11], s43 offen offset:2048 lds
v_mfma_f32_16x16x32_bf16 v[48:51], v[92:95], a[52:55], v[48:51]
ds_read_b128 v[84:87], v6 offset:29696
s_waitcnt lgkmcnt(8) vmcnt(12)
v_mfma_f32_16x16x32_bf16 v[32:35], v[96:99], a[56:59], v[32:35]
ds_read_b128 v[88:91], v6 offset:30720
s_add_u32 m0, s30, 28672
v_mfma_f32_16x16x32_bf16 v[36:39], v[100:103], a[56:59], v[36:39]
ds_read_b128 v[92:95], v6 offset:31744
s_waitcnt lgkmcnt(8)
v_mfma_f32_16x16x32_bf16 v[40:43], v[56:59], a[56:59], v[40:43]
ds_read_b128 v[96:99], v6 offset:32768
s_add_u32 s43, s27, 28672
v_mfma_f32_16x16x32_bf16 v[44:47], v[60:63], a[56:59], v[44:47]
ds_read_b128 v[100:103], v6 offset:33792
s_waitcnt lgkmcnt(8) vmcnt(11)
v_mfma_f32_16x16x32_bf16 v[48:51], v[64:67], a[56:59], v[48:51]
ds_read_b128 v[56:59], v6 offset:34816
buffer_load_dwordx4 v1, s[8:11], s43 offen offset:0 lds
v_mfma_f32_16x16x32_bf16 v[32:35], v[68:71], a[60:63], v[32:35]
ds_read_b128 v[60:63], v6 offset:35840
s_waitcnt lgkmcnt(8)
v_mfma_f32_16x16x32_bf16 v[36:39], v[72:75], a[60:63], v[36:39]
ds_read_b128 v[64:67], v6 offset:36864
buffer_load_dwordx4 v1, s[8:11], s43 offen offset:1024 lds
v_mfma_f32_16x16x32_bf16 v[40:43], v[76:79], a[60:63], v[40:43]
ds_read_b128 v[68:71], v6 offset:37888
s_waitcnt lgkmcnt(8)
v_mfma_f32_16x16x32_bf16 v[44:47], v[80:83], a[60:63], v[44:47]
ds_read_b128 v[72:75], v6 offset:38912
buffer_load_dwordx4 v1, s[8:11], s43 offen offset:2048 lds
v_mfma_f32_16x16x32_bf16 v[48:51], v[84:87], a[60:63], v[48:51]
ds_read_b128 v[76:79], v6 offset:39936
s_waitcnt lgkmcnt(8) vmcnt(13)
v_mfma_f32_16x16x32_bf16 v[32:35], v[88:91], a[64:67], v[32:35]
ds_read_b128 v[80:83], v6 offset:40960
v_mfma_f32_16x16x32_bf16 v[36:39], v[92:95], a[64:67], v[36:39]
ds_read_b128 v[84:87], v6 offset:41984
s_waitcnt lgkmcnt(8)
v_mfma_f32_16x16x32_bf16 v[40:43], v[96:99], a[64:67], v[40:43]
ds_read_b128 v[88:91], v6 offset:43008
buffer_load_dwordx4 v1, s[8:11], s43 offen offset:3072 lds
v_mfma_f32_16x16x32_bf16 v[44:47], v[100:103], a[64:67], v[44:47]
ds_read_b128 v[92:95], v6 offset:44032
s_waitcnt lgkmcnt(8) vmcnt(13)
v_mfma_f32_16x16x32_bf16 v[48:51], v[56:59], a[64:67], v[48:51]
ds_read_b128 v[96:99], v6 offset:45056
v_mfma_f32_16x16x32_bf16 v[32:35], v[60:63], a[68:71], v[32:35]
ds_read_b128 v[100:103], v6 offset:46080
s_waitcnt lgkmcnt(8)
v_mfma_f32_16x16x32_bf16 v[36:39], v[64:67], a[68:71], v[36:39]
ds_read_b128 v[56:59], v6 offset:47104
s_add_u32 m0, s30, 32768
v_mfma_f32_16x16x32_bf16 v[40:43], v[68:71], a[68:71], v[40:43]
ds_read_b128 v[60:63], v6 offset:48128
s_waitcnt lgkmcnt(8)
v_mfma_f32_16x16x32_bf16 v[44:47], v[72:75], a[68:71], v[44:47]
ds_read_b128 v[64:67], v6 offset:49152
s_add_u32 s43, s27, 32768
v_mfma_f32_16x16x32_bf16 v[48:51], v[76:79], a[68:71], v[48:51]
ds_read_b128 v[68:71], v6 offset:50176
s_waitcnt lgkmcnt(8) vmcnt(12)
v_mfma_f32_16x16x32_bf16 v[32:35], v[80:83], a[72:75], v[32:35]
buffer_load_dwordx4 v1, s[8:11], s43 offen offset:0 lds
buffer_load_dwordx4 v1, s[8:11], s43 offen offset:1024 lds
v_mfma_f32_16x16x32_bf16 v[36:39], v[84:87], a[72:75], v[36:39]
s_waitcnt lgkmcnt(6)
v_mfma_f32_16x16x32_bf16 v[40:43], v[88:91], a[72:75], v[40:43]
v_mfma_f32_16x16x32_bf16 v[44:47], v[92:95], a[72:75], v[44:47]
s_waitcnt lgkmcnt(4) vmcnt(13)
v_mfma_f32_16x16x32_bf16 v[48:51], v[96:99], a[72:75], v[48:51]
buffer_load_dwordx4 v1, s[8:11], s43 offen offset:2048 lds
v_mfma_f32_16x16x32_bf16 v[32:35], v[100:103], a[76:79], v[32:35]
s_waitcnt lgkmcnt(2)
v_mfma_f32_16x16x32_bf16 v[36:39], v[56:59], a[76:79], v[36:39]
v_mfma_f32_16x16x32_bf16 v[40:43], v[60:63], a[76:79], v[40:43]
s_waitcnt lgkmcnt(0)
v_mfma_f32_16x16x32_bf16 v[44:47], v[64:67], a[76:79], v[44:47]
v_mfma_f32_16x16x32_bf16 v[48:51], v[68:71], a[76:79], v[48:51]
v_accvgpr_read_b32 v100, a246
v_accvgpr_read_b32 v101, a247
v_accvgpr_read_b32 v102, a248
v_accvgpr_read_b32 v103, a249
v_accvgpr_read_b32 v104, a250
v_accvgpr_read_b32 v105, a251
v_accvgpr_read_b32 v106, a252
v_accvgpr_read_b32 v107, a253
v_accvgpr_read_b32 v108, a254
v_accvgpr_read_b32 v109, a255
s_mov_b32 s53, 0x00003f80
s_mov_b32 s54, 0x3f800000
s_nop 0
v_dot2_f32_bf16 v32, v100, s53, v32
v_dot2_f32_bf16 v33, v100, s54, v33
v_dot2_f32_bf16 v34, v101, s53, v34
v_dot2_f32_bf16 v35, v101, s54, v35
v_dot2_f32_bf16 v36, v102, s53, v36
v_dot2_f32_bf16 v37, v102, s54, v37
v_dot2_f32_bf16 v38, v103, s53, v38
v_dot2_f32_bf16 v39, v103, s54, v39
v_dot2_f32_bf16 v40, v104, s53, v40
v_dot2_f32_bf16 v41, v104, s54, v41
v_dot2_f32_bf16 v42, v105, s53, v42
v_dot2_f32_bf16 v43, v105, s54, v43
v_dot2_f32_bf16 v44, v106, s53, v44
v_dot2_f32_bf16 v45, v106, s54, v45
v_dot2_f32_bf16 v46, v107, s53, v46
v_dot2_f32_bf16 v47, v107, s54, v47
v_dot2_f32_bf16 v48, v108, s53, v48
v_dot2_f32_bf16 v49, v108, s54, v49
v_dot2_f32_bf16 v50, v109, s53, v50
v_dot2_f32_bf16 v51, v109, s54, v51
s_nop 2
s_nop 0
v_cvt_pk_bf16_f32 v132, v32, v33
v_cvt_pk_bf16_f32 v133, v34, v35
v_cvt_pk_bf16_f32 v134, v36, v37
v_cvt_pk_bf16_f32 v135, v38, v39
v_cvt_pk_bf16_f32 v136, v40, v41
v_cvt_pk_bf16_f32 v137, v42, v43
v_cvt_pk_bf16_f32 v138, v44, v45
v_cvt_pk_bf16_f32 v139, v46, v47
v_cvt_pk_bf16_f32 v140, v48, v49
v_cvt_pk_bf16_f32 v141, v50, v51
buffer_store_dwordx2 v[132:133], v237, s[8:11], s26 offen
buffer_store_dwordx2 v[134:135], v238, s[8:11], s26 offen
buffer_store_dwordx2 v[136:137], v239, s[8:11], s26 offen
buffer_store_dwordx2 v[138:139], v240, s[8:11], s26 offen
buffer_store_dwordx2 v[140:141], v241, s[8:11], s26 offen
v_mov_b32 v8, 0x3f803f80
v_dot2_f32_bf16 v10, v132, v8, 0
v_dot2_f32_bf16 v11, v132, v132, 0
v_dot2_f32_bf16 v10, v133, v8, v10
v_dot2_f32_bf16 v11, v133, v133, v11
v_dot2_f32_bf16 v10, v134, v8, v10
v_dot2_f32_bf16 v11, v134, v134, v11
v_dot2_f32_bf16 v10, v135, v8, v10
v_dot2_f32_bf16 v11, v135, v135, v11
v_dot2_f32_bf16 v10, v136, v8, v10
v_dot2_f32_bf16 v11, v136, v136, v11
v_dot2_f32_bf16 v10, v137, v8, v10
v_dot2_f32_bf16 v11, v137, v137, v11
v_dot2_f32_bf16 v10, v138, v8, v10
v_dot2_f32_bf16 v11, v138, v138, v11
v_dot2_f32_bf16 v10, v139, v8, v10
v_dot2_f32_bf16 v11, v139, v139, v11
v_dot2_f32_bf16 v10, v140, v8, v10
v_dot2_f32_bf16 v11, v140, v140, v11
v_dot2_f32_bf16 v10, v141, v8, v10
v_dot2_f32_bf16 v11, v141, v141, v11
s_nop 2
v_mov_b32 v12, v10
v_mov_b32 v13, v11
s_nop 1
v_permlane16_swap_b32 v10, v12
v_permlane16_swap_b32 v11, v13
s_nop 1
v_add_f32 v10, v10, v12
v_add_f32 v11, v11, v13
v_mov_b32 v12, v10
v_mov_b32 v13, v11
s_nop 1
v_permlane32_swap_b32 v10, v12
v_permlane32_swap_b32 v11, v13
s_nop 1
v_add_f32 v10, v10, v12
v_add_f32 v11, v11, v13
s_mov_b64 s[38:39], exec
s_mov_b64 exec, 0xffff
buffer_store_dwordx2 v[10:11], v251, s[8:11], s21 offen
s_mov_b64 exec, s[38:39]
s_nop 0
v_accvgpr_write_b32 a246, v132
v_accvgpr_write_b32 a247, v133
v_accvgpr_write_b32 a248, v134
v_accvgpr_write_b32 a249, v135
v_accvgpr_write_b32 a250, v136
v_accvgpr_write_b32 a251, v137
v_accvgpr_write_b32 a252, v138
v_accvgpr_write_b32 a253, v139
v_accvgpr_write_b32 a254, v140
v_accvgpr_write_b32 a255, v141
s_add_u32 s56, s56, 1
v_mov_b32 v8, s56
v_mov_b32 v9, s57
s_mov_b64 s[38:39], exec
s_waitcnt vmcnt(0)
s_mov_b64 exec, 1
buffer_store_dword v8, v9, s[8:11], 0 offen
s_mov_b64 exec, s[38:39]
s_cmp_lg_u32 s16, 0
s_cbranch_scc1 L_tb_63
v_lshlrev_b32 v10, 2, v2
v_add_u32 v10, s58, v10
s_mov_b32 s40, 0
L_poll_64:
buffer_load_dword v11, v10, s[8:11], 0 offen sc1
s_add_u32 s40, s40, 1
s_cmp_gt_u32 s40, 40000
s_cbranch_scc1 L_polld_65
s_waitcnt vmcnt(0)
v_subrev_u32 v11, s56, v11
v_cmp_lt_u32 vcc, 1, v11
s_cbranch_vccnz L_poll_64
L_polld_65:
L_tb_63:
s_barrier
s_lshl_b32 s44, s16, 11
s_add_u32 s45, s44, s21
s_mov_b32 s46, s45
s_add_u32 s44, s44, s26
s_add_u32 s45, s44, 0
buffer_load_dwordx4 a[0:3], v1, s[8:11], s45 offen offset:0 sc1
buffer_load_dwordx4 a[4:7], v1, s[8:11], s45 offen offset:1024 sc1
s_add_u32 s45, s44, 8192
buffer_load_dwordx4 a[8:11], v1, s[8:11], s45 offen offset:0 sc1
buffer_load_dwordx4 a[12:15], v1, s[8:11], s45 offen offset:1024 sc1
s_add_u32 s45, s44, 16384
buffer_load_dwordx4 a[16:19], v1, s[8:11], s45 offen offset:0 sc1
buffer_load_dwordx4 a[20:23], v1, s[8:11], s45 offen offset:1024 sc1
buffer_load_dwordx4 v[8:11], v1, s[8:11], s46 offen sc1
buffer_load_dwordx4 v[12:15], v1, s[8:11], s46 offen offset:1024 sc1
v_accvgpr_read_b32 v16, a232
v_accvgpr_read_b32 v17, a233
v_accvgpr_read_b32 v18, a234
v_accvgpr_read_b32 v19, a235
v_add_u32 v20, 153600, v1
ds_write_b128 v20, v[16:19]
v_add_u32 v5, 0, v1
v_add_u32 v6, 57344, v1
v_add_u32 v7, 114688, v1
s_barrier
ds_read_b128 v[144:147], v5 offset:0
ds_read_b128 v[148:151], v5 offset:1024
ds_read_b128 v[152:155], v5 offset:2048
ds_read_b128 v[156:159], v5 offset:3072
ds_read_b128 v[160:163], v5 offset:4096
ds_read_b128 v[164:167], v5 offset:5120
s_waitcnt lgkmcnt(5) vmcnt(6)
v_mfma_f32_16x16x32_bf16 v[32:35], v[144:147], a[0:3], 0
ds_read_b128 v[168:171], v5 offset:6144
s_add_u32 m0, s30, 57344
v_mfma_f32_16x16x32_bf16 v[36:39], v[144:147], a[4:7], 0
s_waitcnt lgkmcnt(5)
s_add_u32 s43, s27, 57344
v_mfma_f32_16x16x32_bf16 v[40:43], v[148:151], a[0:3], 0
ds_read_b128 v[144:147], v5 offset:7168
buffer_load_dwordx4 v1, s[8:11], s43 offen offset:0 lds
v_mfma_f32_16x16x32_bf16 v[44:47], v[148:151], a[4:7], 0
s_waitcnt lgkmcnt(5)
buffer_load_dwordx4 v1, s[8:11], s43 offen offset:1024 lds
v_mfma_f32_16x16x32_bf16 v[48:51], v[152:155], a[0:3], 0
ds_read_b128 v[148:151], v5 offset:8192
v_mfma_f32_16x16x32_bf16 v[52:55], v[152:155], a[4:7], 0
s_waitcnt lgkmcnt(5)
v_mfma_f32_16x16x32_bf16 v[56:59], v[156:159], a[0:3], 0
ds_read_b128 v[152:155], v5 offset:9216
s_add_u32 s45, s44, 24576
v_mfma_f32_16x16x32_bf16 v[60:63], v[156:159], a[4:7], 0
s_waitcnt lgkmcnt(5)
buffer_load_dwordx4 a[24:27], v1, s[8:11], s45 offen offset:0 sc1
v_mfma_f32_16x16x32_bf16 v[64:67], v[160:163], a[0:3], 0
ds_read_b128 v[156:159], v5 offset:10240
v_mfma_f32_16x16x32_bf16 v[68:71], v[160:163], a[4:7], 0
s_waitcnt lgkmcnt(5)
v_mfma_f32_16x16x32_bf16 v[72:75], v[164:167], a[0:3], 0
ds_read_b128 v[160:163], v5 offset:11264
buffer_load_dwordx4 v1, s[8:11], s43 offen offset:2048 lds
v_mfma_f32_16x16x32_bf16 v[76:79], v[164:167], a[4:7], 0
s_waitcnt lgkmcnt(5)
v_mfma_f32_16x16x32_bf16 v[80:83], v[168:171], a[0:3], 0
ds_read_b128 v[164:167], v5 offset:12288
v_mfma_f32_16x16x32_bf16 v[84:87], v[168:171], a[4:7], 0
s_waitcnt lgkmcnt(5)
v_mfma_f32_16x16x32_bf16 v[88:91], v[144:147], a[0:3], 0
ds_read_b128 v[168:171], v5 offset:13312
buffer_load_dwordx4 v1, s[8:11], s43 offen offset:3072 lds
v_mfma_f32_16x16x32_bf16 v[92:95], v[144:147], a[4:7], 0
s_waitcnt lgkmcnt(5)
v_mfma_f32_16x16x32_bf16 v[96:99], v[148:151], a[0:3], 0
ds_read_b128 v[144:147], v5 offset:14336
v_mfma_f32_16x16x32_bf16 v[100:103], v[148:151], a[4:7], 0
s_waitcnt lgkmcnt(5)
v_mfma_f32_16x16x32_bf16 v[104:107], v[152:155], a[0:3], 0
ds_read_b128 v[148:151], v5 offset:15360
buffer_load_dwordx4 a[28:31], v1, s[8:11], s45 offen offset:1024 sc1
v_mfma_f32_16x16x32_bf16 v[108:111], v[152:155], a[4:7], 0
s_waitcnt lgkmcnt(5)
v_mfma_f32_16x16x32_bf16 v[112:115], v[156:159], a[0:3], 0
ds_read_b128 v[152:155], v5 offset:16384
v_mfma_f32_16x16x32_bf16 v[116:119], v[156:159], a[4:7], 0
s_waitcnt lgkmcnt(5)
v_mfma_f32_16x16x32_bf16 v[120:123], v[160:163], a[0:3], 0
ds_read_b128 v[156:159], v5 offset:17408
s_add_u32 m0, s30, 61440
v_mfma_f32_16x16x32_bf16 v[124:127], v[160:163], a[4:7], 0
s_waitcnt lgkmcnt(5)
s_add_u32 s43, s27, 61440
v_mfma_f32_16x16x32_bf16 v[128:131], v[164:167], a[0:3], 0
ds_read_b128 v[160:163], v5 offset:18432
buffer_load_dwordx4 v1, s[8:11], s43 offen offset:0 lds
v_mfma_f32_16x16x32_bf16 v[132:135], v[164:167], a[4:7], 0
s_waitcnt lgkmcnt(5)
v_mfma_f32_16x16x32_bf16 v[136:139], v[168:171], a[0:3], 0
ds_read_b128 v[164:167], v5 offset:19456
buffer_load_dwordx4 v1, s[8:11], s43 offen offset:1024 lds
v_mfma_f32_16x16x32_bf16 v[140:143], v[168:171], a[4:7], 0
s_waitcnt lgkmcnt(5) vmcnt(12)
v_mfma_f32_16x16x32_bf16 v[32:35], v[144:147], a[8:11], v[32:35]
ds_read_b128 v[168:171], v5 offset:20480
v_mfma_f32_16x16x32_bf16 v[36:39], v[144:147], a[12:15], v[36:39]
s_waitcnt lgkmcnt(5)
v_mfma_f32_16x16x32_bf16 v[40:43], v[148:151], a[8:11], v[40:43]
ds_read_b128 v[144:147], v5 offset:21504
s_add_u32 s45, s44, 32768
v_mfma_f32_16x16x32_bf16 v[44:47], v[148:151], a[12:15], v[44:47]
s_waitcnt lgkmcnt(5)
buffer_load_dwordx4 a[32:35], v1, s[8:11], s45 offen offset:0 sc1
v_mfma_f32_16x16x32_bf16 v[48:51], v[152:155], a[8:11], v[48:51]
ds_read_b128 v[148:151], v5 offset:22528
v_mfma_f32_16x16x32_bf16 v[52:55], v[152:155], a[12:15], v[52:55]
s_waitcnt lgkmcnt(5)
v_mfma_f32_16x16x32_bf16 v[56:59], v[156:159], a[8:11], v[56:59]
ds_read_b128 v[152:155], v5 offset:23552
buffer_load_dwordx4 v1, s[8:11], s43 offen offset:2048 lds
v_mfma_f32_16x16x32_bf16 v[60:63], v[156:159], a[12:15], v[60:63]
s_waitcnt lgkmcnt(5)
v_mfma_f32_16x16x32_bf16 v[64:67], v[160:163], a[8:11], v[64:67]
ds_read_b128 v[156:159], v5 offset:24576
v_mfma_f32_16x16x32_bf16 v[68:71], v[160:163], a[12:15], v[68:71]
s_waitcnt lgkmcnt(5)
v_mfma_f32_16x16x32_bf16 v[72:75], v[164:167], a[8:11], v[72:75]
ds_read_b128 v[160:163], v5 offset:25600
buffer_load_dwordx4 a[36:39], v1, s[8:11], s45 offen offset:1024 sc1
v_mfma_f32_16x16x32_bf16 v[76:79], v[164:167], a[12:15], v[76:79]
s_waitcnt lgkmcnt(5)
v_mfma_f32_16x16x32_bf16 v[80:83], v[168:171], a[8:11], v[80:83]
ds_read_b128 v[164:167], v5 offset:26624
v_mfma_f32_16x16x32_bf16 v[84:87], v[168:171], a[12:15], v[84:87]
s_waitcnt lgkmcnt(5)
v_mfma_f32_16x16x32_bf16 v[88:91], v[144:147], a[8:11], v[88:91]
ds_read_b128 v[168:171], v5 offset:27648
v_mfma_f32_16x16x32_bf16 v[92:95], v[144:147], a[12:15], v[92:95]
s_waitcnt lgkmcnt(5)
v_mfma_f32_16x16x32_bf16 v[96:99], v[148:151], a[8:11], v[96:99]
s_barrier
ds_read_b128 v[144:147], v5 offset:28672
s_add_u32 m0, s30, 86016
v_mfma_f32_16x16x32_bf16 v[100:103], v[148:151], a[12:15], v[100:103]
s_waitcnt lgkmcnt(5)
s_add_u32 s43, s27, 86016
v_mfma_f32_16x16x32_bf16 v[104:107], v[152:155], a[8:11], v[104:107]
ds_read_b128 v[148:151], v5 offset:29696
buffer_load_dwordx4 v1, s[8:11], s43 offen offset:0 lds
v_mfma_f32_16x16x32_bf16 v[108:111], v[152:155], a[12:15], v[108:111]
s_waitcnt lgkmcnt(5)
v_mfma_f32_16x16x32_bf16 v[112:115], v[156:159], a[8:11], v[112:115]
ds_read_b128 v[152:155], v5 offset:30720
buffer_load_dwordx4 v1, s[8:11], s43 offen offset:1024 lds
v_mfma_f32_16x16x32_bf16 v[116:119], v[156:159], a[12:15], v[116:119]
s_waitcnt lgkmcnt(5)
v_mfma_f32_16x16x32_bf16 v[120:123], v[160:163], a[8:11], v[120:123]
ds_read_b128 v[156:159], v5 offset:31744
v_mfma_f32_16x16x32_bf16 v[124:127], v[160:163], a[12:15], v[124:127]
s_waitcnt lgkmcnt(5)
v_mfma_f32_16x16x32_bf16 v[128:131], v[164:167], a[8:11], v[128:131]
ds_read_b128 v[160:163], v5 offset:32768
s_add_u32 s45, s44, 40960
v_mfma_f32_16x16x32_bf16 v[132:135], v[164:167], a[12:15], v[132:135]
s_waitcnt lgkmcnt(5)
buffer_load_dwordx4 a[40:43], v1, s[8:11], s45 offen offset:0 sc1
v_mfma_f32_16x16x32_bf16 v[136:139], v[168:171], a[8:11], v[136:139]
ds_read_b128 v[164:167], v5 offset:33792
v_mfma_f32_16x16x32_bf16 v[140:143], v[168:171], a[12:15], v[140:143]
s_waitcnt lgkmcnt(5) vmcnt(16)
v_mfma_f32_16x16x32_bf16 v[32:35], v[144:147], a[16:19], v[32:35]
ds_read_b128 v[168:171], v5 offset:34816
v_mfma_f32_16x16x32_bf16 v[36:39], v[144:147], a[20:23], v[36:39]
s_waitcnt lgkmcnt(5)
v_mfma_f32_16x16x32_bf16 v[40:43], v[148:151], a[16:19], v[40:43]
ds_read_b128 v[144:147], v5 offset:35840
buffer_load_dwordx4 v1, s[8:11], s43 offen offset:2048 lds
v_mfma_f32_16x16x32_bf16 v[44:47], v[148:151], a[20:23], v[44:47]
s_waitcnt lgkmcnt(5)
v_mfma_f32_16x16x32_bf16 v[48:51], v[152:155], a[16:19], v[48:51]
ds_read_b128 v[148:151], v5 offset:36864
s_waitcnt vmcnt(15)
v_mfma_f32_16x16x32_bf16 v[52:55], v[152:155], a[20:23], v[52:55]
s_waitcnt lgkmcnt(5)
v_mfma_f32_16x16x32_bf16 v[56:59], v[156:159], a[16:19], v[56:59]
ds_read_b128 v[152:155], v5 offset:37888
buffer_load_dwordx4 v1, s[8:11], s43 offen offset:3072 lds
v_mfma_f32_16x16x32_bf16 v[60:63], v[156:159], a[20:23], v[60:63]
s_waitcnt lgkmcnt(5)
v_mfma_f32_16x16x32_bf16 v[64:67], v[160:163], a[16:19], v[64:67]
ds_read_b128 v[156:159], v5 offset:38912
v_add_f32 v24, v8, v10
v_mfma_f32_16x16x32_bf16 v[68:71], v[160:163], a[20:23], v[68:71]
s_waitcnt lgkmcnt(5)
v_add_f32 v25, v9, v11
v_mfma_f32_16x16x32_bf16 v[72:75], v[164:167], a[16:19], v[72:75]
ds_read_b128 v[160:163], v5 offset:39936
v_add_f32 v26, v12, v14
v_mfma_f32_16x16x32_bf16 v[76:79], v[164:167], a[20:23], v[76:79]
s_waitcnt lgkmcnt(5)
v_add_f32 v27, v13, v15
v_mfma_f32_16x16x32_bf16 v[80:83], v[168:171], a[16:19], v[80:83]
ds_read_b128 v[164:167], v5 offset:40960
v_mov_b32 v28, v24
v_mfma_f32_16x16x32_bf16 v[84:87], v[168:171], a[20:23], v[84:87]
s_waitcnt lgkmcnt(5)
v_mov_b32 v29, v25
v_mfma_f32_16x16x32_bf16 v[88:91], v[144:147], a[16:19], v[88:91]
ds_read_b128 v[168:171], v5 offset:41984
v_mov_b32 v30, v26
v_mfma_f32_16x16x32_bf16 v[92:95], v[144:147], a[20:23], v[92:95]
s_waitcnt lgkmcnt(5)
v_mov_b32 v31, v27
v_mfma_f32_16x16x32_bf16 v[96:99], v[148:151], a[16:19], v[96:99]
ds_read_b128 v[144:147], v5 offset:43008
buffer_load_dwordx4 a[44:47], v1, s[8:11], s45 offen offset:1024 sc1
v_mfma_f32_16x16x32_bf16 v[100:103], v[148:151], a[20:23], v[100:103]
s_waitcnt lgkmcnt(5)
s_nop 1
v_mfma_f32_16x16x32_bf16 v[104:107], v[152:155], a[16:19], v[104:107]
ds_read_b128 v[148:151], v5 offset:44032
v_permlane16_swap_b32 v24, v28
v_mfma_f32_16x16x32_bf16 v[108:111], v[152:155], a[20:23], v[108:111]
s_waitcnt lgkmcnt(5)
v_permlane16_swap_b32 v25, v29
v_mfma_f32_16x16x32_bf16 v[112:115], v[156:159], a[16:19], v[112:115]
ds_read_b128 v[152:155], v5 offset:45056
v_permlane16_swap_b32 v26, v30
v_mfma_f32_16x16x32_bf16 v[116:119], v[156:159], a[20:23], v[116:119]
s_waitcnt lgkmcnt(5)
v_permlane16_swap_b32 v27, v31
v_mfma_f32_16x16x32_bf16 v[120:123], v[160:163], a[16:19], v[120:123]
ds_read_b128 v[156:159], v5 offset:46080
s_add_u32 m0, s30, 90112
v_mfma_f32_16x16x32_bf16 v[124:127], v[160:163], a[20:23], v[124:127]
s_waitcnt lgkmcnt(5)
s_add_u32 s43, s27, 90112
v_mfma_f32_16x16x32_bf16 v[128:131], v[164:167], a[16:19], v[128:131]
ds_read_b128 v[160:163], v5 offset:47104
buffer_load_dwordx4 v1, s[8:11], s43 offen offset:0 lds
v_mfma_f32_16x16x32_bf16 v[132:135], v[164:167], a[20:23], v[132:135]
s_waitcnt lgkmcnt(5)
s_nop 1
v_mfma_f32_16x16x32_bf16 v[136:139], v[168:171], a[16:19], v[136:139]
ds_read_b128 v[164:167], v5 offset:48128
v_add_f32 v24, v24, v28
v_mfma_f32_16x16x32_bf16 v[140:143], v[168:171], a[20:23], v[140:143]
s_waitcnt lgkmcnt(5) vmcnt(12)
v_add_f32 v25, v25, v29
v_mfma_f32_16x16x32_bf16 v[32:35], v[144:147], a[24:27], v[32:35]
ds_read_b128 v[168:171], v5 offset:49152
v_add_f32 v26, v26, v30
v_mfma_f32_16x16x32_bf16 v[36:39], v[144:147], a[28:31], v[36:39]
s_waitcnt lgkmcnt(5)
v_add_f32 v27, v27, v31
v_mfma_f32_16x16x32_bf16 v[40:43], v[148:151], a[24:27], v[40:43]
ds_read_b128 v[144:147], v5 offset:50176
v_mov_b32 v28, v24
v_mfma_f32_16x16x32_bf16 v[44:47], v[148:151], a[28:31], v[44:47]
s_waitcnt lgkmcnt(5)
v_mov_b32 v29, v25
v_mfma_f32_16x16x32_bf16 v[48:51], v[152:155], a[24:27], v[48:51]
ds_read_b128 v[148:151], v5 offset:51200
v_mov_b32 v30, v26
v_mfma_f32_16x16x32_bf16 v[52:55], v[152:155], a[28:31], v[52:55]
s_waitcnt lgkmcnt(5)
v_mov_b32 v31, v27
v_mfma_f32_16x16x32_bf16 v[56:59], v[156:159], a[24:27], v[56:59]
ds_read_b128 v[152:155], v5 offset:52224
s_nop 1
v_mfma_f32_16x16x32_bf16 v[60:63], v[156:159], a[28:31], v[60:63]
s_waitcnt lgkmcnt(5)
v_permlane32_swap_b32 v24, v28
v_mfma_f32_16x16x32_bf16 v[64:67], v[160:163], a[24:27], v[64:67]
ds_read_b128 v[156:159], v5 offset:53248
v_permlane32_swap_b32 v25, v29
v_mfma_f32_16x16x32_bf16 v[68:71], v[160:163], a[28:31], v[68:71]
s_waitcnt lgkmcnt(5)
v_permlane32_swap_b32 v26, v30
v_mfma_f32_16x16x32_bf16 v[72:75], v[164:167], a[24:27], v[72:75]
ds_read_b128 v[160:163], v5 offset:54272
v_permlane32_swap_b32 v27, v31
v_mfma_f32_16x16x32_bf16 v[76:79], v[164:167], a[28:31], v[76:79]
s_waitcnt lgkmcnt(5)
buffer_load_dwordx4 v1, s[8:11], s43 offen offset:1024 lds
v_mfma_f32_16x16x32_bf16 v[80:83], v[168:171], a[24:27], v[80:83]
ds_read_b128 v[164:167], v5 offset:55296
s_nop 1
v_mfma_f32_16x16x32_bf16 v[84:87], v[168:171], a[28:31], v[84:87]
s_waitcnt lgkmcnt(5)
v_add_f32 v24, v24, v28
v_mfma_f32_16x16x32_bf16 v[88:91], v[144:147], a[24:27], v[88:91]
ds_read_b128 v[168:171], v5 offset:56320
v_add_f32 v25, v25, v29
v_mfma_f32_16x16x32_bf16 v[92:95], v[144:147], a[28:31], v[92:95]
s_waitcnt lgkmcnt(5)
v_add_f32 v26, v26, v30
v_mfma_f32_16x16x32_bf16 v[96:99], v[148:151], a[24:27], v[96:99]
s_waitcnt vmcnt(9)
s_barrier
ds_read_b128 v[144:147], v6 offset:0
v_add_f32 v27, v27, v31
v_mfma_f32_16x16x32_bf16 v[100:103], v[148:151], a[28:31], v[100:103]
s_waitcnt lgkmcnt(5)
v_mul_f32 v24, 0.0015625, v24
v_mfma_f32_16x16x32_bf16 v[104:107], v[152:155], a[24:27], v[104:107]
ds_read_b128 v[148:151], v6 offset:1024
v_mul_f32 v25, 0.0015625, v25
v_mfma_f32_16x16x32_bf16 v[108:111], v[152:155], a[28:31], v[108:111]
s_waitcnt lgkmcnt(5)
v_mul_f32 v26, 0.0015625, v26
v_mfma_f32_16x16x32_bf16 v[112:115], v[156:159], a[24:27], v[112:115]
ds_read_b128 v[152:155], v6 offset:2048
v_mul_f32 v27, 0.0015625, v27
v_mfma_f32_16x16x32_bf16 v[116:119], v[156:159], a[28:31], v[116:119]
s_waitcnt lgkmcnt(5)
s_add_u32 s45, s44, 49152
v_mfma_f32_16x16x32_bf16 v[120:123], v[160:163], a[24:27], v[120:123]
ds_read_b128 v[156:159], v6 offset:3072
buffer_load_dwordx4 a[48:51], v1, s[8:11], s45 offen offset:0 sc1
v_mfma_f32_16x16x32_bf16 v[124:127], v[160:163], a[28:31], v[124:127]
s_waitcnt lgkmcnt(5)
v_fma_f32 v25, -v24, v24, v25
v_mfma_f32_16x16x32_bf16 v[128:131], v[164:167], a[24:27], v[128:131]
ds_read_b128 v[160:163], v6 offset:4096
v_max_f32 v25, 0, v25
v_mfma_f32_16x16x32_bf16 v[132:135], v[164:167], a[28:31], v[132:135]
s_waitcnt lgkmcnt(5)
v_add_f32 v25, 0x3727c5ac, v25
v_mfma_f32_16x16x32_bf16 v[136:139], v[168:171], a[24:27], v[136:139]
ds_read_b128 v[164:167], v6 offset:5120
v_rsq_f32 v25, v25
v_mfma_f32_16x16x32_bf16 v[140:143], v[168:171], a[28:31], v[140:143]
s_waitcnt lgkmcnt(5) vmcnt(9)
v_fma_f32 v27, -v26, v26, v27
v_mfma_f32_16x16x32_bf16 v[32:35], v[144:147], a[32:35], v[32:35]
ds_read_b128 v[168:171], v6 offset:6144
v_max_f32 v27, 0, v27
v_mfma_f32_16x16x32_bf16 v[36:39], v[144:147], a[36:39], v[36:39]
s_waitcnt lgkmcnt(5)
v_add_f32 v27, 0x3727c5ac, v27
v_mfma_f32_16x16x32_bf16 v[40:43], v[148:151], a[32:35], v[40:43]
ds_read_b128 v[144:147], v6 offset:7168
v_rsq_f32 v27, v27
v_mfma_f32_16x16x32_bf16 v[44:47], v[148:151], a[36:39], v[44:47]
s_waitcnt lgkmcnt(5)
s_nop 0
v_mfma_f32_16x16x32_bf16 v[48:51], v[152:155], a[32:35], v[48:51]
ds_read_b128 v[148:151], v6 offset:8192
buffer_load_dwordx4 v1, s[8:11], s43 offen offset:2048 lds
v_mfma_f32_16x16x32_bf16 v[52:55], v[152:155], a[36:39], v[52:55]
s_waitcnt lgkmcnt(5)
buffer_load_dwordx4 a[52:55], v1, s[8:11], s45 offen offset:1024 sc1
v_mfma_f32_16x16x32_bf16 v[56:59], v[156:159], a[32:35], v[56:59]
ds_read_b128 v[152:155], v6 offset:9216
s_add_u32 m0, s30, 114688
v_mfma_f32_16x16x32_bf16 v[60:63], v[156:159], a[36:39], v[60:63]
s_waitcnt lgkmcnt(5)
s_add_u32 s43, s27, 114688
v_mfma_f32_16x16x32_bf16 v[64:67], v[160:163], a[32:35], v[64:67]
ds_read_b128 v[156:159], v6 offset:10240
buffer_load_dwordx4 v1, s[8:11], s43 offen offset:0 lds
v_mfma_f32_16x16x32_bf16 v[68:71], v[160:163], a[36:39], v[68:71]
s_waitcnt lgkmcnt(5)
buffer_load_dwordx4 v1, s[8:11], s43 offen offset:1024 lds
v_mfma_f32_16x16x32_bf16 v[72:75], v[164:167], a[32:35], v[72:75]
ds_read_b128 v[160:163], v6 offset:11264
s_add_u32 s45, s44, 57344
v_mfma_f32_16x16x32_bf16 v[76:79], v[164:167], a[36:39], v[76:79]
s_waitcnt lgkmcnt(5)
buffer_load_dwordx4 a[56:59], v1, s[8:11], s45 offen offset:0 sc1
v_mfma_f32_16x16x32_bf16 v[80:83], v[168:171], a[32:35], v[80:83]
ds_read_b128 v[164:167], v6 offset:12288
buffer_load_dwordx4 v1, s[8:11], s43 offen offset:2048 lds
v_mfma_f32_16x16x32_bf16 v[84:87], v[168:171], a[36:39], v[84:87]
s_waitcnt lgkmcnt(5)
buffer_load_dwordx4 v1, s[8:11], s43 offen offset:3072 lds
v_mfma_f32_16x16x32_bf16 v[88:91], v[144:147], a[32:35], v[88:91]
ds_read_b128 v[168:171], v6 offset:13312
buffer_load_dwordx4 a[60:63], v1, s[8:11], s45 offen offset:1024 sc1
v_mfma_f32_16x16x32_bf16 v[92:95], v[144:147], a[36:39], v[92:95]
s_waitcnt lgkmcnt(5)
v_mfma_f32_16x16x32_bf16 v[96:99], v[148:151], a[32:35], v[96:99]
ds_read_b128 v[144:147], v6 offset:14336
s_add_u32 m0, s30, 118784
v_mfma_f32_16x16x32_bf16 v[100:103], v[148:151], a[36:39], v[100:103]
s_waitcnt lgkmcnt(5)
s_add_u32 s43, s27, 118784
v_mfma_f32_16x16x32_bf16 v[104:107], v[152:155], a[32:35], v[104:107]
ds_read_b128 v[148:151], v6 offset:15360
buffer_load_dwordx4 v1, s[8:11], s43 offen offset:0 lds
v_mfma_f32_16x16x32_bf16 v[108:111], v[152:155], a[36:39], v[108:111]
s_waitcnt lgkmcnt(5)
v_mfma_f32_16x16x32_bf16 v[112:115], v[156:159], a[32:35], v[112:115]
ds_read_b128 v[152:155], v6 offset:16384
v_mfma_f32_16x16x32_bf16 v[116:119], v[156:159], a[36:39], v[116:119]
s_waitcnt lgkmcnt(5)
v_mfma_f32_16x16x32_bf16 v[120:123], v[160:163], a[32:35], v[120:123]
ds_read_b128 v[156:159], v6 offset:17408
buffer_load_dwordx4 v1, s[8:11], s43 offen offset:1024 lds
v_mfma_f32_16x16x32_bf16 v[124:127], v[160:163], a[36:39], v[124:127]
s_waitcnt lgkmcnt(5)
v_mfma_f32_16x16x32_bf16 v[128:131], v[164:167], a[32:35], v[128:131]
ds_read_b128 v[160:163], v6 offset:18432
v_mfma_f32_16x16x32_bf16 v[132:135], v[164:167], a[36:39], v[132:135]
s_waitcnt lgkmcnt(5)
v_mfma_f32_16x16x32_bf16 v[136:139], v[168:171], a[32:35], v[136:139]
ds_read_b128 v[164:167], v6 offset:19456
s_add_u32 s45, s44, 65536
v_mfma_f32_16x16x32_bf16 v[140:143], v[168:171], a[36:39], v[140:143]
s_waitcnt lgkmcnt(5) vmcnt(13)
buffer_load_dwordx4 a[64:67], v1, s[8:11], s45 offen offset:0 sc1
v_mfma_f32_16x16x32_bf16 v[32:35], v[144:147], a[40:43], v[32:35]
ds_read_b128 v[168:171], v6 offset:20480
v_mfma_f32_16x16x32_bf16 v[36:39], v[144:147], a[44:47], v[36:39]
s_waitcnt lgkmcnt(5)
v_mfma_f32_16x16x32_bf16 v[40:43], v[148:151], a[40:43], v[40:43]
ds_read_b128 v[144:147], v6 offset:21504
v_mfma_f32_16x16x32_bf16 v[44:47], v[148:151], a[44:47], v[44:47]
s_waitcnt lgkmcnt(5)
v_mfma_f32_16x16x32_bf16 v[48:51], v[152:155], a[40:43], v[48:51]
ds_read_b128 v[148:151], v6 offset:22528
buffer_load_dwordx4 v1, s[8:11], s43 offen offset:2048 lds
v_mfma_f32_16x16x32_bf16 v[52:55], v[152:155], a[44:47], v[52:55]
s_waitcnt lgkmcnt(5)
v_mfma_f32_16x16x32_bf16 v[56:59], v[156:159], a[40:43], v[56:59]
ds_read_b128 v[152:155], v6 offset:23552
v_mfma_f32_16x16x32_bf16 v[60:63], v[156:159], a[44:47], v[60:63]
s_waitcnt lgkmcnt(5)
v_mfma_f32_16x16x32_bf16 v[64:67], v[160:163], a[40:43], v[64:67]
ds_read_b128 v[156:159], v6 offset:24576
buffer_load_dwordx4 a[68:71], v1, s[8:11], s45 offen offset:1024 sc1
v_mfma_f32_16x16x32_bf16 v[68:71], v[160:163], a[44:47], v[68:71]
s_waitcnt lgkmcnt(5)
v_mfma_f32_16x16x32_bf16 v[72:75], v[164:167], a[40:43], v[72:75]
ds_read_b128 v[160:163], v6 offset:25600
v_mfma_f32_16x16x32_bf16 v[76:79], v[164:167], a[44:47], v[76:79]
s_waitcnt lgkmcnt(5)
v_mfma_f32_16x16x32_bf16 v[80:83], v[168:171], a[40:43], v[80:83]
ds_read_b128 v[164:167], v6 offset:26624
v_mfma_f32_16x16x32_bf16 v[84:87], v[168:171], a[44:47], v[84:87]
s_waitcnt lgkmcnt(5)
v_mfma_f32_16x16x32_bf16 v[88:91], v[144:147], a[40:43], v[88:91]
ds_read_b128 v[168:171], v6 offset:27648
v_mfma_f32_16x16x32_bf16 v[92:95], v[144:147], a[44:47], v[92:95]
s_waitcnt lgkmcnt(5)
v_mfma_f32_16x16x32_bf16 v[96:99], v[148:151], a[40:43], v[96:99]
s_waitcnt vmcnt(12)
s_barrier
ds_read_b128 v[144:147], v6 offset:28672
s_add_u32 m0, s30, 0
v_mfma_f32_16x16x32_bf16 v[100:103], v[148:151], a[44:47], v[100:103]
s_waitcnt lgkmcnt(5)
s_add_u32 s43, s27, 143360
v_mfma_f32_16x16x32_bf16 v[104:107], v[152:155], a[40:43], v[104:107]
ds_read_b128 v[148:151], v6 offset:29696
buffer_load_dwordx4 v1, s[8:11], s43 offen offset:0 lds
v_mfma_f32_16x16x32_bf16 v[108:111], v[152:155], a[44:47], v[108:111]
s_waitcnt lgkmcnt(5)
v_mfma_f32_16x16x32_bf16 v[112:115], v[156:159], a[40:43], v[112:115]
ds_read_b128 v[152:155], v6 offset:30720
buffer_load_dwordx4 v1, s[8:11], s43 offen offset:1024 lds
v_mfma_f32_16x16x32_bf16 v[116:119], v[156:159], a[44:47], v[116:119]
s_waitcnt lgkmcnt(5)
v_mfma_f32_16x16x32_bf16 v[120:123], v[160:163], a[40:43], v[120:123]
ds_read_b128 v[156:159], v6 offset:31744
v_mfma_f32_16x16x32_bf16 v[124:127], v[160:163], a[44:47], v[124:127]
s_waitcnt lgkmcnt(5)
v_mfma_f32_16x16x32_bf16 v[128:131], v[164:167], a[40:43], v[128:131]
ds_read_b128 v[160:163], v6 offset:32768
s_add_u32 s45, s44, 73728
v_mfma_f32_16x16x32_bf16 v[132:135], v[164:167], a[44:47], v[132:135]
s_waitcnt lgkmcnt(5)
buffer_load_dwordx4 a[72:75], v1, s[8:11], s45 offen offset:0 sc1
v_mfma_f32_16x16x32_bf16 v[136:139], v[168:171], a[40:43], v[136:139]
ds_read_b128 v[164:167], v6 offset:33792
v_mfma_f32_16x16x32_bf16 v[140:143], v[168:171], a[44:47], v[140:143]
s_waitcnt lgkmcnt(5) vmcnt(14)
v_mfma_f32_16x16x32_bf16 v[32:35], v[144:147], a[48:51], v[32:35]
ds_read_b128 v[168:171], v6 offset:34816
v_mfma_f32_16x16x32_bf16 v[36:39], v[144:147], a[52:55], v[36:39]
s_waitcnt lgkmcnt(5)
v_mfma_f32_16x16x32_bf16 v[40:43], v[148:151], a[48:51], v[40:43]
ds_read_b128 v[144:147], v6 offset:35840
buffer_load_dwordx4 v1, s[8:11], s43 offen offset:2048 lds
v_mfma_f32_16x16x32_bf16 v[44:47], v[148:151], a[52:55], v[44:47]
s_waitcnt lgkmcnt(5)
v_mfma_f32_16x16x32_bf16 v[48:51], v[152:155], a[48:51], v[48:51]
ds_read_b128 v[148:151], v6 offset:36864
v_mfma_f32_16x16x32_bf16 v[52:55], v[152:155], a[52:55], v[52:55]
s_waitcnt lgkmcnt(5)
v_mfma_f32_16x16x32_bf16 v[56:59], v[156:159], a[48:51], v[56:59]
ds_read_b128 v[152:155], v6 offset:37888
buffer_load_dwordx4 v1, s[8:11], s43 offen offset:3072 lds
v_mfma_f32_16x16x32_bf16 v[60:63], v[156:159], a[52:55], v[60:63]
s_waitcnt lgkmcnt(5)
v_mfma_f32_16x16x32_bf16 v[64:67], v[160:163], a[48:51], v[64:67]
ds_read_b128 v[156:159], v6 offset:38912
v_mfma_f32_16x16x32_bf16 v[68:71], v[160:163], a[52:55], v[68:71]
s_waitcnt lgkmcnt(5)
v_mfma_f32_16x16x32_bf16 v[72:75], v[164:167], a[48:51], v[72:75]
ds_read_b128 v[160:163], v6 offset:39936
v_mfma_f32_16x16x32_bf16 v[76:79], v[164:167], a[52:55], v[76:79]
s_waitcnt lgkmcnt(5)
v_mfma_f32_16x16x32_bf16 v[80:83], v[168:171], a[48:51], v[80:83]
ds_read_b128 v[164:167], v6 offset:40960
buffer_load_dwordx4 a[76:79], v1, s[8:11], s45 offen offset:1024 sc1
v_mfma_f32_16x16x32_bf16 v[84:87], v[168:171], a[52:55], v[84:87]
s_waitcnt lgkmcnt(5)
v_mfma_f32_16x16x32_bf16 v[88:91], v[144:147], a[48:51], v[88:91]
ds_read_b128 v[168:171], v6 offset:41984
v_mfma_f32_16x16x32_bf16 v[92:95], v[144:147], a[52:55], v[92:95]
s_waitcnt lgkmcnt(5)
v_mfma_f32_16x16x32_bf16 v[96:99], v[148:151], a[48:51], v[96:99]
ds_read_b128 v[144:147], v6 offset:43008
s_add_u32 m0, s30, 4096
v_mfma_f32_16x16x32_bf16 v[100:103], v[148:151], a[52:55], v[100:103]
s_waitcnt lgkmcnt(5)
s_add_u32 s43, s27, 147456
v_mfma_f32_16x16x32_bf16 v[104:107], v[152:155], a[48:51], v[104:107]
ds_read_b128 v[148:151], v6 offset:44032
buffer_load_dwordx4 v1, s[8:11], s43 offen offset:0 lds
v_mfma_f32_16x16x32_bf16 v[108:111], v[152:155], a[52:55], v[108:111]
s_waitcnt lgkmcnt(5)
v_mfma_f32_16x16x32_bf16 v[112:115], v[156:159], a[48:51], v[112:115]
ds_read_b128 v[152:155], v6 offset:45056
v_mfma_f32_16x16x32_bf16 v[116:119], v[156:159], a[52:55], v[116:119]
s_waitcnt lgkmcnt(5)
v_mfma_f32_16x16x32_bf16 v[120:123], v[160:163], a[48:51], v[120:123]
ds_read_b128 v[156:159], v6 offset:46080
buffer_load_dwordx4 v1, s[8:11], s43 offen offset:1024 lds
v_mfma_f32_16x16x32_bf16 v[124:127], v[160:163], a[52:55], v[124:127]
s_waitcnt lgkmcnt(5)
v_mfma_f32_16x16x32_bf16 v[128:131], v[164:167], a[48:51], v[128:131]
ds_read_b128 v[160:163], v6 offset:47104
v_mfma_f32_16x16x32_bf16 v[132:135], v[164:167], a[52:55], v[132:135]
s_waitcnt lgkmcnt(5)
v_mfma_f32_16x16x32_bf16 v[136:139], v[168:171], a[48:51], v[136:139]
ds_read_b128 v[164:167], v6 offset:48128
s_add_u32 s45, s44, 81920
v_mfma_f32_16x16x32_bf16 v[140:143], v[168:171], a[52:55], v[140:143]
s_waitcnt lgkmcnt(5) vmcnt(13)
buffer_load_dwordx4 a[80:83], v1, s[8:11], s45 offen offset:0 sc1
v_mfma_f32_16x16x32_bf16 v[32:35], v[144:147], a[56:59], v[32:35]
ds_read_b128 v[168:171], v6 offset:49152
v_mfma_f32_16x16x32_bf16 v[36:39], v[144:147], a[60:63], v[36:39]
s_waitcnt lgkmcnt(5)
v_mfma_f32_16x16x32_bf16 v[40:43], v[148:151], a[56:59], v[40:43]
ds_read_b128 v[144:147], v6 offset:50176
v_mfma_f32_16x16x32_bf16 v[44:47], v[148:151], a[60:63], v[44:47]
s_waitcnt lgkmcnt(5)
v_mfma_f32_16x16x32_bf16 v[48:51], v[152:155], a[56:59], v[48:51]
ds_read_b128 v[148:151], v6 offset:51200
buffer_load_dwordx4 v1, s[8:11], s43 offen offset:2048 lds
v_mfma_f32_16x16x32_bf16 v[52:55], v[152:155], a[60:63], v[52:55]
s_waitcnt lgkmcnt(5)
v_mfma_f32_16x16x32_bf16 v[56:59], v[156:159], a[56:59], v[56:59]
ds_read_b128 v[152:155], v6 offset:52224
v_mfma_f32_16x16x32_bf16 v[60:63], v[156:159], a[60:63], v[60:63]
s_waitcnt lgkmcnt(5)
v_mfma_f32_16x16x32_bf16 v[64:67], v[160:163], a[56:59], v[64:67]
ds_read_b128 v[156:159], v6 offset:53248
buffer_load_dwordx4 a[84:87], v1, s[8:11], s45 offen offset:1024 sc1
v_mfma_f32_16x16x32_bf16 v[68:71], v[160:163], a[60:63], v[68:71]
s_waitcnt lgkmcnt(5)
v_mfma_f32_16x16x32_bf16 v[72:75], v[164:167], a[56:59], v[72:75]
ds_read_b128 v[160:163], v6 offset:54272
v_mfma_f32_16x16x32_bf16 v[76:79], v[164:167], a[60:63], v[76:79]
s_waitcnt lgkmcnt(5)
v_mfma_f32_16x16x32_bf16 v[80:83], v[168:171], a[56:59], v[80:83]
ds_read_b128 v[164:167], v6 offset:55296
v_mfma_f32_16x16x32_bf16 v[84:87], v[168:171], a[60:63], v[84:87]
s_waitcnt lgkmcnt(5)
v_mfma_f32_16x16x32_bf16 v[88:91], v[144:147], a[56:59], v[88:91]
ds_read_b128 v[168:171], v6 offset:56320
v_mfma_f32_16x16x32_bf16 v[92:95], v[144:147], a[60:63], v[92:95]
s_waitcnt lgkmcnt(5)
v_mfma_f32_16x16x32_bf16 v[96:99], v[148:151], a[56:59], v[96:99]
s_waitcnt vmcnt(12)
s_barrier
ds_read_b128 v[144:147], v7 offset:0
s_add_u32 m0, s30, 28672
v_mfma_f32_16x16x32_bf16 v[100:103], v[148:151], a[60:63], v[100:103]
s_waitcnt lgkmcnt(5)
s_add_u32 s43, s27, 172032
v_mfma_f32_16x16x32_bf16 v[104:107], v[152:155], a[56:59], v[104:107]
ds_read_b128 v[148:151], v7 offset:1024
buffer_load_dwordx4 v1, s[8:11], s43 offen offset:0 lds
v_mfma_f32_16x16x32_bf16 v[108:111], v[152:155], a[60:63], v[108:111]
s_waitcnt lgkmcnt(5)
v_mfma_f32_16x16x32_bf16 v[112:115], v[156:159], a[56:59], v[112:115]
ds_read_b128 v[152:155], v7 offset:2048
buffer_load_dwordx4 v1, s[8:11], s43 offen offset:1024 lds
v_mfma_f32_16x16x32_bf16 v[116:119], v[156:159], a[60:63], v[116:119]
s_waitcnt lgkmcnt(5)
v_mfma_f32_16x16x32_bf16 v[120:123], v[160:163], a[56:59], v[120:123]
ds_read_b128 v[156:159], v7 offset:3072
v_mfma_f32_16x16x32_bf16 v[124:127], v[160:163], a[60:63], v[124:127]
s_waitcnt lgkmcnt(5)
v_mfma_f32_16x16x32_bf16 v[128:131], v[164:167], a[56:59], v[128:131]
ds_read_b128 v[160:163], v7 offset:4096
s_add_u32 s45, s44, 90112
v_mfma_f32_16x16x32_bf16 v[132:135], v[164:167], a[60:63], v[132:135]
s_waitcnt lgkmcnt(5)
buffer_load_dwordx4 a[88:91], v1, s[8:11], s45 offen offset:0 sc1
v_mfma_f32_16x16x32_bf16 v[136:139], v[168:171], a[56:59], v[136:139]
ds_read_b128 v[164:167], v7 offset:5120
v_mfma_f32_16x16x32_bf16 v[140:143], v[168:171], a[60:63], v[140:143]
s_waitcnt lgkmcnt(5) vmcnt(14)
v_mfma_f32_16x16x32_bf16 v[32:35], v[144:147], a[64:67], v[32:35]
ds_read_b128 v[168:171], v7 offset:6144
v_mfma_f32_16x16x32_bf16 v[36:39], v[144:147], a[68:71], v[36:39]
s_waitcnt lgkmcnt(5)
v_mfma_f32_16x16x32_bf16 v[40:43], v[148:151], a[64:67], v[40:43]
ds_read_b128 v[144:147], v7 offset:7168
buffer_load_dwordx4 v1, s[8:11], s43 offen offset:2048 lds
v_mfma_f32_16x16x32_bf16 v[44:47], v[148:151], a[68:71], v[44:47]
s_waitcnt lgkmcnt(5)
v_mfma_f32_16x16x32_bf16 v[48:51], v[152:155], a[64:67], v[48:51]
ds_read_b128 v[148:151], v7 offset:8192
v_mfma_f32_16x16x32_bf16 v[52:55], v[152:155], a[68:71], v[52:55]
s_waitcnt lgkmcnt(5)
v_mfma_f32_16x16x32_bf16 v[56:59], v[156:159], a[64:67], v[56:59]
ds_read_b128 v[152:155], v7 offset:9216
buffer_load_dwordx4 v1, s[8:11], s43 offen offset:3072 lds
v_mfma_f32_16x16x32_bf16 v[60:63], v[156:159], a[68:71], v[60:63]
s_waitcnt lgkmcnt(5)
v_mfma_f32_16x16x32_bf16 v[64:67], v[160:163], a[64:67], v[64:67]
ds_read_b128 v[156:159], v7 offset:10240
v_mfma_f32_16x16x32_bf16 v[68:71], v[160:163], a[68:71], v[68:71]
s_waitcnt lgkmcnt(5)
v_mfma_f32_16x16x32_bf16 v[72:75], v[164:167], a[64:67], v[72:75]
ds_read_b128 v[160:163], v7 offset:11264
v_mfma_f32_16x16x32_bf16 v[76:79], v[164:167], a[68:71], v[76:79]
s_waitcnt lgkmcnt(5)
v_mfma_f32_16x16x32_bf16 v[80:83], v[168:171], a[64:67], v[80:83]
ds_read_b128 v[164:167], v7 offset:12288
buffer_load_dwordx4 a[92:95], v1, s[8:11], s45 offen offset:1024 sc1
v_mfma_f32_16x16x32_bf16 v[84:87], v[168:171], a[68:71], v[84:87]
s_waitcnt lgkmcnt(5)
v_mfma_f32_16x16x32_bf16 v[88:91], v[144:147], a[64:67], v[88:91]
ds_read_b128 v[168:171], v7 offset:13312
v_mfma_f32_16x16x32_bf16 v[92:95], v[144:147], a[68:71], v[92:95]
s_waitcnt lgkmcnt(5)
v_mfma_f32_16x16x32_bf16 v[96:99], v[148:151], a[64:67], v[96:99]
ds_read_b128 v[144:147], v7 offset:14336
s_add_u32 m0, s30, 32768
v_mfma_f32_16x16x32_bf16 v[100:103], v[148:151], a[68:71], v[100:103]
s_waitcnt lgkmcnt(5)
s_add_u32 s43, s27, 176128
v_mfma_f32_16x16x32_bf16 v[104:107], v[152:155], a[64:67], v[104:107]
ds_read_b128 v[148:151], v7 offset:15360
buffer_load_dwordx4 v1, s[8:11], s43 offen offset:0 lds
v_mfma_f32_16x16x32_bf16 v[108:111], v[152:155], a[68:71], v[108:111]
s_waitcnt lgkmcnt(5)
v_mfma_f32_16x16x32_bf16 v[112:115], v[156:159], a[64:67], v[112:115]
ds_read_b128 v[152:155], v7 offset:16384
v_mfma_f32_16x16x32_bf16 v[116:119], v[156:159], a[68:71], v[116:119]
s_waitcnt lgkmcnt(5)
v_mfma_f32_16x16x32_bf16 v[120:123], v[160:163], a[64:67], v[120:123]
ds_read_b128 v[156:159], v7 offset:17408
buffer_load_dwordx4 v1, s[8:11], s43 offen offset:1024 lds
v_mfma_f32_16x16x32_bf16 v[124:127], v[160:163], a[68:71], v[124:127]
s_waitcnt lgkmcnt(5)
v_mfma_f32_16x16x32_bf16 v[128:131], v[164:167], a[64:67], v[128:131]
ds_read_b128 v[160:163], v7 offset:18432
v_mfma_f32_16x16x32_bf16 v[132:135], v[164:167], a[68:71], v[132:135]
s_waitcnt lgkmcnt(5)
v_mfma_f32_16x16x32_bf16 v[136:139], v[168:171], a[64:67], v[136:139]
ds_read_b128 v[164:167], v7 offset:19456
s_add_u32 s45, s44, 98304
v_mfma_f32_16x16x32_bf16 v[140:143], v[168:171], a[68:71], v[140:143]
s_waitcnt lgkmcnt(5) vmcnt(13)
buffer_load_dwordx4 a[96:99], v1, s[8:11], s45 offen offset:0 sc1
v_mfma_f32_16x16x32_bf16 v[32:35], v[144:147], a[72:75], v[32:35]
ds_read_b128 v[168:171], v7 offset:20480
v_mfma_f32_16x16x32_bf16 v[36:39], v[144:147], a[76:79], v[36:39]
s_waitcnt lgkmcnt(5)
v_mfma_f32_16x16x32_bf16 v[40:43], v[148:151], a[72:75], v[40:43]
ds_read_b128 v[144:147], v7 offset:21504
v_mfma_f32_16x16x32_bf16 v[44:47], v[148:151], a[76:79], v[44:47]
s_waitcnt lgkmcnt(5)
v_mfma_f32_16x16x32_bf16 v[48:51], v[152:155], a[72:75], v[48:51]
ds_read_b128 v[148:151], v7 offset:22528
buffer_load_dwordx4 v1, s[8:11], s43 offen offset:2048 lds
v_mfma_f32_16x16x32_bf16 v[52:55], v[152:155], a[76:79], v[52:55]
s_waitcnt lgkmcnt(5)
v_mfma_f32_16x16x32_bf16 v[56:59], v[156:159], a[72:75], v[56:59]
ds_read_b128 v[152:155], v7 offset:23552
v_mfma_f32_16x16x32_bf16 v[60:63], v[156:159], a[76:79], v[60:63]
s_waitcnt lgkmcnt(5)
v_mfma_f32_16x16x32_bf16 v[64:67], v[160:163], a[72:75], v[64:67]
ds_read_b128 v[156:159], v7 offset:24576
buffer_load_dwordx4 a[100:103], v1, s[8:11], s45 offen offset:1024 sc1
v_mfma_f32_16x16x32_bf16 v[68:71], v[160:163], a[76:79], v[68:71]
s_waitcnt lgkmcnt(5)
v_mfma_f32_16x16x32_bf16 v[72:75], v[164:167], a[72:75], v[72:75]
ds_read_b128 v[160:163], v7 offset:25600
v_mfma_f32_16x16x32_bf16 v[76:79], v[164:167], a[76:79], v[76:79]
s_waitcnt lgkmcnt(5)
v_mfma_f32_16x16x32_bf16 v[80:83], v[168:171], a[72:75], v[80:83]
ds_read_b128 v[164:167], v7 offset:26624
v_mfma_f32_16x16x32_bf16 v[84:87], v[168:171], a[76:79], v[84:87]
s_waitcnt lgkmcnt(5)
v_mfma_f32_16x16x32_bf16 v[88:91], v[144:147], a[72:75], v[88:91]
ds_read_b128 v[168:171], v7 offset:27648
v_mfma_f32_16x16x32_bf16 v[92:95], v[144:147], a[76:79], v[92:95]
s_waitcnt lgkmcnt(5)
v_mfma_f32_16x16x32_bf16 v[96:99], v[148:151], a[72:75], v[96:99]
s_waitcnt vmcnt(12)
s_barrier
ds_read_b128 v[144:147], v5 offset:0
s_add_u32 m0, s30, 57344
v_mfma_f32_16x16x32_bf16 v[100:103], v[148:151], a[76:79], v[100:103]
s_waitcnt lgkmcnt(5)
s_add_u32 s43, s27, 200704
v_mfma_f32_16x16x32_bf16 v[104:107], v[152:155], a[72:75], v[104:107]
ds_read_b128 v[148:151], v5 offset:1024
buffer_load_dwordx4 v1, s[8:11], s43 offen offset:0 lds
v_mfma_f32_16x16x32_bf16 v[108:111], v[152:155], a[76:79], v[108:111]
s_waitcnt lgkmcnt(5)
v_mfma_f32_16x16x32_bf16 v[112:115], v[156:159], a[72:75], v[112:115]
ds_read_b128 v[152:155], v5 offset:2048
buffer_load_dwordx4 v1, s[8:11], s43 offen offset:1024 lds
v_mfma_f32_16x16x32_bf16 v[116:119], v[156:159], a[76:79], v[116:119]
s_waitcnt lgkmcnt(5)
v_mfma_f32_16x16x32_bf16 v[120:123], v[160:163], a[72:75], v[120:123]
ds_read_b128 v[156:159], v5 offset:3072
v_mfma_f32_16x16x32_bf16 v[124:127], v[160:163], a[76:79], v[124:127]
s_waitcnt lgkmcnt(5)
v_mfma_f32_16x16x32_bf16 v[128:131], v[164:167], a[72:75], v[128:131]
ds_read_b128 v[160:163], v5 offset:4096
s_add_u32 s45, s44, 106496
v_mfma_f32_16x16x32_bf16 v[132:135], v[164:167], a[76:79], v[132:135]
s_waitcnt lgkmcnt(5)
buffer_load_dwordx4 a[104:107], v1, s[8:11], s45 offen offset:0 sc1
v_mfma_f32_16x16x32_bf16 v[136:139], v[168:171], a[72:75], v[136:139]
ds_read_b128 v[164:167], v5 offset:5120
v_mfma_f32_16x16x32_bf16 v[140:143], v[168:171], a[76:79], v[140:143]
s_waitcnt lgkmcnt(5) vmcnt(14)
v_mfma_f32_16x16x32_bf16 v[32:35], v[144:147], a[80:83], v[32:35]
ds_read_b128 v[168:171], v5 offset:6144
v_mfma_f32_16x16x32_bf16 v[36:39], v[144:147], a[84:87], v[36:39]
s_waitcnt lgkmcnt(5)
v_mfma_f32_16x16x32_bf16 v[40:43], v[148:151], a[80:83], v[40:43]
ds_read_b128 v[144:147], v5 offset:7168
buffer_load_dwordx4 v1, s[8:11], s43 offen offset:2048 lds
v_mfma_f32_16x16x32_bf16 v[44:47], v[148:151], a[84:87], v[44:47]
s_waitcnt lgkmcnt(5)
v_mfma_f32_16x16x32_bf16 v[48:51], v[152:155], a[80:83], v[48:51]
ds_read_b128 v[148:151], v5 offset:8192
v_mfma_f32_16x16x32_bf16 v[52:55], v[152:155], a[84:87], v[52:55]
s_waitcnt lgkmcnt(5)
v_mfma_f32_16x16x32_bf16 v[56:59], v[156:159], a[80:83], v[56:59]
ds_read_b128 v[152:155], v5 offset:9216
buffer_load_dwordx4 v1, s[8:11], s43 offen offset:3072 lds
v_mfma_f32_16x16x32_bf16 v[60:63], v[156:159], a[84:87], v[60:63]
s_waitcnt lgkmcnt(5)
v_mfma_f32_16x16x32_bf16 v[64:67], v[160:163], a[80:83], v[64:67]
ds_read_b128 v[156:159], v5 offset:10240
v_mfma_f32_16x16x32_bf16 v[68:71], v[160:163], a[84:87], v[68:71]
s_waitcnt lgkmcnt(5)
v_mfma_f32_16x16x32_bf16 v[72:75], v[164:167], a[80:83], v[72:75]
ds_read_b128 v[160:163], v5 offset:11264
v_mfma_f32_16x16x32_bf16 v[76:79], v[164:167], a[84:87], v[76:79]
s_waitcnt lgkmcnt(5)
v_mfma_f32_16x16x32_bf16 v[80:83], v[168:171], a[80:83], v[80:83]
ds_read_b128 v[164:167], v5 offset:12288
buffer_load_dwordx4 a[108:111], v1, s[8:11], s45 offen offset:1024 sc1
v_mfma_f32_16x16x32_bf16 v[84:87], v[168:171], a[84:87], v[84:87]
s_waitcnt lgkmcnt(5)
v_mfma_f32_16x16x32_bf16 v[88:91], v[144:147], a[80:83], v[88:91]
ds_read_b128 v[168:171], v5 offset:13312
v_mfma_f32_16x16x32_bf16 v[92:95], v[144:147], a[84:87], v[92:95]
s_waitcnt lgkmcnt(5)
v_mfma_f32_16x16x32_bf16 v[96:99], v[148:151], a[80:83], v[96:99]
ds_read_b128 v[144:147], v5 offset:14336
s_add_u32 m0, s30, 61440
v_mfma_f32_16x16x32_bf16 v[100:103], v[148:151], a[84:87], v[100:103]
s_waitcnt lgkmcnt(5)
s_add_u32 s43, s27, 204800
v_mfma_f32_16x16x32_bf16 v[104:107], v[152:155], a[80:83], v[104:107]
ds_read_b128 v[148:151], v5 offset:15360
buffer_load_dwordx4 v1, s[8:11], s43 offen offset:0 lds
v_mfma_f32_16x16x32_bf16 v[108:111], v[152:155], a[84:87], v[108:111]
s_waitcnt lgkmcnt(5)
v_mfma_f32_16x16x32_bf16 v[112:115], v[156:159], a[80:83], v[112:115]
ds_read_b128 v[152:155], v5 offset:16384
v_mfma_f32_16x16x32_bf16 v[116:119], v[156:159], a[84:87], v[116:119]
s_waitcnt lgkmcnt(5)
v_mfma_f32_16x16x32_bf16 v[120:123], v[160:163], a[80:83], v[120:123]
ds_read_b128 v[156:159], v5 offset:17408
buffer_load_dwordx4 v1, s[8:11], s43 offen offset:1024 lds
v_mfma_f32_16x16x32_bf16 v[124:127], v[160:163], a[84:87], v[124:127]
s_waitcnt lgkmcnt(5)
v_mfma_f32_16x16x32_bf16 v[128:131], v[164:167], a[80:83], v[128:131]
ds_read_b128 v[160:163], v5 offset:18432
v_mfma_f32_16x16x32_bf16 v[132:135], v[164:167], a[84:87], v[132:135]
s_waitcnt lgkmcnt(5)
v_mfma_f32_16x16x32_bf16 v[136:139], v[168:171], a[80:83], v[136:139]
ds_read_b128 v[164:167], v5 offset:19456
s_add_u32 s45, s44, 114688
v_mfma_f32_16x16x32_bf16 v[140:143], v[168:171], a[84:87], v[140:143]
s_waitcnt lgkmcnt(5) vmcnt(13)
buffer_load_dwordx4 a[112:115], v1, s[8:11], s45 offen offset:0 sc1
v_mfma_f32_16x16x32_bf16 v[32:35], v[144:147], a[88:91], v[32:35]
ds_read_b128 v[168:171], v5 offset:20480
v_mfma_f32_16x16x32_bf16 v[36:39], v[144:147], a[92:95], v[36:39]
s_waitcnt lgkmcnt(5)
v_mfma_f32_16x16x32_bf16 v[40:43], v[148:151], a[88:91], v[40:43]
ds_read_b128 v[144:147], v5 offset:21504
v_mfma_f32_16x16x32_bf16 v[44:47], v[148:151], a[92:95], v[44:47]
s_waitcnt lgkmcnt(5)
v_mfma_f32_16x16x32_bf16 v[48:51], v[152:155], a[88:91], v[48:51]
ds_read_b128 v[148:151], v5 offset:22528
buffer_load_dwordx4 v1, s[8:11], s43 offen offset:2048 lds
v_mfma_f32_16x16x32_bf16 v[52:55], v[152:155], a[92:95], v[52:55]
s_waitcnt lgkmcnt(5)
v_mfma_f32_16x16x32_bf16 v[56:59], v[156:159], a[88:91], v[56:59]
ds_read_b128 v[152:155], v5 offset:23552
v_mfma_f32_16x16x32_bf16 v[60:63], v[156:159], a[92:95], v[60:63]
s_waitcnt lgkmcnt(5)
v_mfma_f32_16x16x32_bf16 v[64:67], v[160:163], a[88:91], v[64:67]
ds_read_b128 v[156:159], v5 offset:24576
buffer_load_dwordx4 a[116:119], v1, s[8:11], s45 offen offset:1024 sc1
v_mfma_f32_16x16x32_bf16 v[68:71], v[160:163], a[92:95], v[68:71]
s_waitcnt lgkmcnt(5)
v_mfma_f32_16x16x32_bf16 v[72:75], v[164:167], a[88:91], v[72:75]
ds_read_b128 v[160:163], v5 offset:25600
v_mfma_f32_16x16x32_bf16 v[76:79], v[164:167], a[92:95], v[76:79]
s_waitcnt lgkmcnt(5)
v_mfma_f32_16x16x32_bf16 v[80:83], v[168:171], a[88:91], v[80:83]
ds_read_b128 v[164:167], v5 offset:26624
v_mfma_f32_16x16x32_bf16 v[84:87], v[168:171], a[92:95], v[84:87]
s_waitcnt lgkmcnt(5)
v_mfma_f32_16x16x32_bf16 v[88:91], v[144:147], a[88:91], v[88:91]
ds_read_b128 v[168:171], v5 offset:27648
v_mfma_f32_16x16x32_bf16 v[92:95], v[144:147], a[92:95], v[92:95]
s_waitcnt lgkmcnt(5)
v_mfma_f32_16x16x32_bf16 v[96:99], v[148:151], a[88:91], v[96:99]
s_waitcnt vmcnt(12)
s_barrier
ds_read_b128 v[144:147], v5 offset:28672
s_add_u32 m0, s30, 86016
v_mfma_f32_16x16x32_bf16 v[100:103], v[148:151], a[92:95], v[100:103]
s_waitcnt lgkmcnt(5)
s_add_u32 s43, s27, 229376
v_mfma_f32_16x16x32_bf16 v[104:107], v[152:155], a[88:91], v[104:107]
ds_read_b128 v[148:151], v5 offset:29696
buffer_load_dwordx4 v1, s[8:11], s43 offen offset:0 lds
v_mfma_f32_16x16x32_bf16 v[108:111], v[152:155], a[92:95], v[108:111]
s_waitcnt lgkmcnt(5)
v_mfma_f32_16x16x32_bf16 v[112:115], v[156:159], a[88:91], v[112:115]
ds_read_b128 v[152:155], v5 offset:30720
buffer_load_dwordx4 v1, s[8:11], s43 offen offset:1024 lds
v_mfma_f32_16x16x32_bf16 v[116:119], v[156:159], a[92:95], v[116:119]
s_waitcnt lgkmcnt(5)
v_mfma_f32_16x16x32_bf16 v[120:123], v[160:163], a[88:91], v[120:123]
ds_read_b128 v[156:159], v5 offset:31744
v_mfma_f32_16x16x32_bf16 v[124:127], v[160:163], a[92:95], v[124:127]
s_waitcnt lgkmcnt(5)
v_mfma_f32_16x16x32_bf16 v[128:131], v[164:167], a[88:91], v[128:131]
ds_read_b128 v[160:163], v5 offset:32768
s_add_u32 s45, s44, 122880
v_mfma_f32_16x16x32_bf16 v[132:135], v[164:167], a[92:95], v[132:135]
s_waitcnt lgkmcnt(5)
buffer_load_dwordx4 a[120:123], v1, s[8:11], s45 offen offset:0 sc1
v_mfma_f32_16x16x32_bf16 v[136:139], v[168:171], a[88:91], v[136:139]
ds_read_b128 v[164:167], v5 offset:33792
v_mfma_f32_16x16x32_bf16 v[140:143], v[168:171], a[92:95], v[140:143]
s_waitcnt lgkmcnt(5) vmcnt(14)
v_mfma_f32_16x16x32_bf16 v[32:35], v[144:147], a[96:99], v[32:35]
ds_read_b128 v[168:171], v5 offset:34816
v_mfma_f32_16x16x32_bf16 v[36:39], v[144:147], a[100:103], v[36:39]
s_waitcnt lgkmcnt(5)
v_mfma_f32_16x16x32_bf16 v[40:43], v[148:151], a[96:99], v[40:43]
ds_read_b128 v[144:147], v5 offset:35840
buffer_load_dwordx4 v1, s[8:11], s43 offen offset:2048 lds
v_mfma_f32_16x16x32_bf16 v[44:47], v[148:151], a[100:103], v[44:47]
s_waitcnt lgkmcnt(5)
v_mfma_f32_16x16x32_bf16 v[48:51], v[152:155], a[96:99], v[48:51]
ds_read_b128 v[148:151], v5 offset:36864
v_mfma_f32_16x16x32_bf16 v[52:55], v[152:155], a[100:103], v[52:55]
s_waitcnt lgkmcnt(5)
v_mfma_f32_16x16x32_bf16 v[56:59], v[156:159], a[96:99], v[56:59]
ds_read_b128 v[152:155], v5 offset:37888
buffer_load_dwordx4 v1, s[8:11], s43 offen offset:3072 lds
v_mfma_f32_16x16x32_bf16 v[60:63], v[156:159], a[100:103], v[60:63]
s_waitcnt lgkmcnt(5)
v_mfma_f32_16x16x32_bf16 v[64:67], v[160:163], a[96:99], v[64:67]
ds_read_b128 v[156:159], v5 offset:38912
v_mfma_f32_16x16x32_bf16 v[68:71], v[160:163], a[100:103], v[68:71]
s_waitcnt lgkmcnt(5)
v_mfma_f32_16x16x32_bf16 v[72:75], v[164:167], a[96:99], v[72:75]
ds_read_b128 v[160:163], v5 offset:39936
v_mfma_f32_16x16x32_bf16 v[76:79], v[164:167], a[100:103], v[76:79]
s_waitcnt lgkmcnt(5)
v_mfma_f32_16x16x32_bf16 v[80:83], v[168:171], a[96:99], v[80:83]
ds_read_b128 v[164:167], v5 offset:40960
buffer_load_dwordx4 a[124:127], v1, s[8:11], s45 offen offset:1024 sc1
v_mfma_f32_16x16x32_bf16 v[84:87], v[168:171], a[100:103], v[84:87]
s_waitcnt lgkmcnt(5)
v_mfma_f32_16x16x32_bf16 v[88:91], v[144:147], a[96:99], v[88:91]
ds_read_b128 v[168:171], v5 offset:41984
v_mfma_f32_16x16x32_bf16 v[92:95], v[144:147], a[100:103], v[92:95]
s_waitcnt lgkmcnt(5)
v_mfma_f32_16x16x32_bf16 v[96:99], v[148:151], a[96:99], v[96:99]
ds_read_b128 v[144:147], v5 offset:43008
s_add_u32 m0, s30, 90112
v_mfma_f32_16x16x32_bf16 v[100:103], v[148:151], a[100:103], v[100:103]
s_waitcnt lgkmcnt(5)
s_add_u32 s43, s27, 233472
v_mfma_f32_16x16x32_bf16 v[104:107], v[152:155], a[96:99], v[104:107]
ds_read_b128 v[148:151], v5 offset:44032
buffer_load_dwordx4 v1, s[8:11], s43 offen offset:0 lds
v_mfma_f32_16x16x32_bf16 v[108:111], v[152:155], a[100:103], v[108:111]
s_waitcnt lgkmcnt(5)
v_mfma_f32_16x16x32_bf16 v[112:115], v[156:159], a[96:99], v[112:115]
ds_read_b128 v[152:155], v5 offset:45056
v_mfma_f32_16x16x32_bf16 v[116:119], v[156:159], a[100:103], v[116:119]
s_waitcnt lgkmcnt(5)
v_mfma_f32_16x16x32_bf16 v[120:123], v[160:163], a[96:99], v[120:123]
ds_read_b128 v[156:159], v5 offset:46080
buffer_load_dwordx4 v1, s[8:11], s43 offen offset:1024 lds
v_mfma_f32_16x16x32_bf16 v[124:127], v[160:163], a[100:103], v[124:127]
s_waitcnt lgkmcnt(5)
v_mfma_f32_16x16x32_bf16 v[128:131], v[164:167], a[96:99], v[128:131]
ds_read_b128 v[160:163], v5 offset:47104
v_mfma_f32_16x16x32_bf16 v[132:135], v[164:167], a[100:103], v[132:135]
s_waitcnt lgkmcnt(5)
v_mfma_f32_16x16x32_bf16 v[136:139], v[168:171], a[96:99], v[136:139]
ds_read_b128 v[164:167], v5 offset:48128
s_add_u32 s45, s44, 131072
v_mfma_f32_16x16x32_bf16 v[140:143], v[168:171], a[100:103], v[140:143]
s_waitcnt lgkmcnt(5) vmcnt(13)
buffer_load_dwordx4 a[128:131], v1, s[8:11], s45 offen offset:0 sc1
v_mfma_f32_16x16x32_bf16 v[32:35], v[144:147], a[104:107], v[32:35]
ds_read_b128 v[168:171], v5 offset:49152
v_mfma_f32_16x16x32_bf16 v[36:39], v[144:147], a[108:111], v[36:39]
s_waitcnt lgkmcnt(5)
v_mfma_f32_16x16x32_bf16 v[40:43], v[148:151], a[104:107], v[40:43]
ds_read_b128 v[144:147], v5 offset:50176
v_mfma_f32_16x16x32_bf16 v[44:47], v[148:151], a[108:111], v[44:47]
s_waitcnt lgkmcnt(5)
v_mfma_f32_16x16x32_bf16 v[48:51], v[152:155], a[104:107], v[48:51]
ds_read_b128 v[148:151], v5 offset:51200
buffer_load_dwordx4 v1, s[8:11], s43 offen offset:2048 lds
v_mfma_f32_16x16x32_bf16 v[52:55], v[152:155], a[108:111], v[52:55]
s_waitcnt lgkmcnt(5)
v_mfma_f32_16x16x32_bf16 v[56:59], v[156:159], a[104:107], v[56:59]
ds_read_b128 v[152:155], v5 offset:52224
v_mfma_f32_16x16x32_bf16 v[60:63], v[156:159], a[108:111], v[60:63]
s_waitcnt lgkmcnt(5)
v_mfma_f32_16x16x32_bf16 v[64:67], v[160:163], a[104:107], v[64:67]
ds_read_b128 v[156:159], v5 offset:53248
buffer_load_dwordx4 a[132:135], v1, s[8:11], s45 offen offset:1024 sc1
v_mfma_f32_16x16x32_bf16 v[68:71], v[160:163], a[108:111], v[68:71]
s_waitcnt lgkmcnt(5)
v_mfma_f32_16x16x32_bf16 v[72:75], v[164:167], a[104:107], v[72:75]
ds_read_b128 v[160:163], v5 offset:54272
v_mfma_f32_16x16x32_bf16 v[76:79], v[164:167], a[108:111], v[76:79]
s_waitcnt lgkmcnt(5)
v_mfma_f32_16x16x32_bf16 v[80:83], v[168:171], a[104:107], v[80:83]
ds_read_b128 v[164:167], v5 offset:55296
v_mfma_f32_16x16x32_bf16 v[84:87], v[168:171], a[108:111], v[84:87]
s_waitcnt lgkmcnt(5)
v_mfma_f32_16x16x32_bf16 v[88:91], v[144:147], a[104:107], v[88:91]
ds_read_b128 v[168:171], v5 offset:56320
v_mfma_f32_16x16x32_bf16 v[92:95], v[144:147], a[108:111], v[92:95]
s_waitcnt lgkmcnt(5)
v_mfma_f32_16x16x32_bf16 v[96:99], v[148:151], a[104:107], v[96:99]
s_waitcnt vmcnt(12)
s_barrier
ds_read_b128 v[144:147], v6 offset:0
s_add_u32 m0, s30, 114688
v_mfma_f32_16x16x32_bf16 v[100:103], v[148:151], a[108:111], v[100:103]
s_waitcnt lgkmcnt(5)
s_add_u32 s43, s27, 258048
v_mfma_f32_16x16x32_bf16 v[104:107], v[152:155], a[104:107], v[104:107]
ds_read_b128 v[148:151], v6 offset:1024
buffer_load_dwordx4 v1, s[8:11], s43 offen offset:0 lds
v_mfma_f32_16x16x32_bf16 v[108:111], v[152:155], a[108:111], v[108:111]
s_waitcnt lgkmcnt(5)
buffer_load_dwordx4 v1, s[8:11], s43 offen offset:1024 lds
v_mfma_f32_16x16x32_bf16 v[112:115], v[156:159], a[104:107], v[112:115]
ds_read_b128 v[152:155], v6 offset:2048
s_add_u32 s45, s44, 139264
v_mfma_f32_16x16x32_bf16 v[116:119], v[156:159], a[108:111], v[116:119]
s_waitcnt lgkmcnt(5)
buffer_load_dwordx4 a[136:139], v1, s[8:11], s45 offen offset:0 sc1
v_mfma_f32_16x16x32_bf16 v[120:123], v[160:163], a[104:107], v[120:123]
ds_read_b128 v[156:159], v6 offset:3072
v_mfma_f32_16x16x32_bf16 v[124:127], v[160:163], a[108:111], v[124:127]
s_waitcnt lgkmcnt(5)
v_mfma_f32_16x16x32_bf16 v[128:131], v[164:167], a[104:107], v[128:131]
ds_read_b128 v[160:163], v6 offset:4096
buffer_load_dwordx4 v1, s[8:11], s43 offen offset:2048 lds
v_mfma_f32_16x16x32_bf16 v[132:135], v[164:167], a[108:111], v[132:135]
s_waitcnt lgkmcnt(5)
v_mfma_f32_16x16x32_bf16 v[136:139], v[168:171], a[104:107], v[136:139]
ds_read_b128 v[164:167], v6 offset:5120
buffer_load_dwordx4 v1, s[8:11], s43 offen offset:3072 lds
v_mfma_f32_16x16x32_bf16 v[140:143], v[168:171], a[108:111], v[140:143]
s_waitcnt lgkmcnt(5) vmcnt(16)
v_mfma_f32_16x16x32_bf16 v[32:35], v[144:147], a[112:115], v[32:35]
ds_read_b128 v[168:171], v6 offset:6144
v_mfma_f32_16x16x32_bf16 v[36:39], v[144:147], a[116:119], v[36:39]
s_waitcnt lgkmcnt(5)
v_mfma_f32_16x16x32_bf16 v[40:43], v[148:151], a[112:115], v[40:43]
ds_read_b128 v[144:147], v6 offset:7168
buffer_load_dwordx4 a[140:143], v1, s[8:11], s45 offen offset:1024 sc1
v_mfma_f32_16x16x32_bf16 v[44:47], v[148:151], a[116:119], v[44:47]
s_waitcnt lgkmcnt(5)
v_mfma_f32_16x16x32_bf16 v[48:51], v[152:155], a[112:115], v[48:51]
ds_read_b128 v[148:151], v6 offset:8192
s_add_u32 m0, s30, 118784
v_mfma_f32_16x16x32_bf16 v[52:55], v[152:155], a[116:119], v[52:55]
s_waitcnt lgkmcnt(5)
s_add_u32 s43, s27, 262144
v_mfma_f32_16x16x32_bf16 v[56:59], v[156:159], a[112:115], v[56:59]
ds_read_b128 v[152:155], v6 offset:9216
buffer_load_dwordx4 v1, s[8:11], s43 offen offset:0 lds
v_mfma_f32_16x16x32_bf16 v[60:63], v[156:159], a[116:119], v[60:63]
s_waitcnt lgkmcnt(5)
buffer_load_dwordx4 v1, s[8:11], s43 offen offset:1024 lds
v_mfma_f32_16x16x32_bf16 v[64:67], v[160:163], a[112:115], v[64:67]
ds_read_b128 v[156:159], v6 offset:10240
v_mfma_f32_16x16x32_bf16 v[68:71], v[160:163], a[116:119], v[68:71]
s_waitcnt lgkmcnt(5)
v_mfma_f32_16x16x32_bf16 v[72:75], v[164:167], a[112:115], v[72:75]
ds_read_b128 v[160:163], v6 offset:11264
s_add_u32 s45, s44, 147456
v_mfma_f32_16x16x32_bf16 v[76:79], v[164:167], a[116:119], v[76:79]
s_waitcnt lgkmcnt(5)
buffer_load_dwordx4 a[144:147], v1, s[8:11], s45 offen offset:0 sc1
v_mfma_f32_16x16x32_bf16 v[80:83], v[168:171], a[112:115], v[80:83]
ds_read_b128 v[164:167], v6 offset:12288
buffer_load_dwordx4 v1, s[8:11], s43 offen offset:2048 lds
v_mfma_f32_16x16x32_bf16 v[84:87], v[168:171], a[116:119], v[84:87]
s_waitcnt lgkmcnt(5)
v_mfma_f32_16x16x32_bf16 v[88:91], v[144:147], a[112:115], v[88:91]
ds_read_b128 v[168:171], v6 offset:13312
v_mfma_f32_16x16x32_bf16 v[92:95], v[144:147], a[116:119], v[92:95]
s_waitcnt lgkmcnt(5)
v_mfma_f32_16x16x32_bf16 v[96:99], v[148:151], a[112:115], v[96:99]
ds_read_b128 v[144:147], v6 offset:14336
s_add_u32 m0, s30, 0
v_mfma_f32_16x16x32_bf16 v[100:103], v[148:151], a[116:119], v[100:103]
s_waitcnt lgkmcnt(5)
s_add_u32 s42, s60, 0
v_mfma_f32_16x16x32_bf16 v[104:107], v[152:155], a[112:115], v[104:107]
ds_read_b128 v[148:151], v6 offset:15360
buffer_load_dwordx4 v1, s[8:11], s42 offen offset:0 lds
v_mfma_f32_16x16x32_bf16 v[108:111], v[152:155], a[116:119], v[108:111]
s_waitcnt lgkmcnt(5)
buffer_load_dwordx4 a[148:151], v1, s[8:11], s45 offen offset:1024 sc1
v_mfma_f32_16x16x32_bf16 v[112:115], v[156:159], a[112:115], v[112:115]
ds_read_b128 v[152:155], v6 offset:16384
v_mfma_f32_16x16x32_bf16 v[116:119], v[156:159], a[116:119], v[116:119]
s_waitcnt lgkmcnt(5)
v_mfma_f32_16x16x32_bf16 v[120:123], v[160:163], a[112:115], v[120:123]
ds_read_b128 v[156:159], v6 offset:17408
buffer_load_dwordx4 v1, s[8:11], s42 offen offset:1024 lds
v_mfma_f32_16x16x32_bf16 v[124:127], v[160:163], a[116:119], v[124:127]
s_waitcnt lgkmcnt(5)
v_mfma_f32_16x16x32_bf16 v[128:131], v[164:167], a[112:115], v[128:131]
ds_read_b128 v[160:163], v6 offset:18432
buffer_load_dwordx4 v1, s[8:11], s42 offen offset:2048 lds
v_mfma_f32_16x16x32_bf16 v[132:135], v[164:167], a[116:119], v[132:135]
s_waitcnt lgkmcnt(5)
v_mfma_f32_16x16x32_bf16 v[136:139], v[168:171], a[112:115], v[136:139]
ds_read_b128 v[164:167], v6 offset:19456
buffer_load_dwordx4 v1, s[8:11], s42 offen offset:3072 lds
v_mfma_f32_16x16x32_bf16 v[140:143], v[168:171], a[116:119], v[140:143]
s_waitcnt lgkmcnt(5) vmcnt(20)
v_mfma_f32_16x16x32_bf16 v[32:35], v[144:147], a[120:123], v[32:35]
ds_read_b128 v[168:171], v6 offset:20480
v_mfma_f32_16x16x32_bf16 v[36:39], v[144:147], a[124:127], v[36:39]
s_waitcnt lgkmcnt(5)
v_mfma_f32_16x16x32_bf16 v[40:43], v[148:151], a[120:123], v[40:43]
ds_read_b128 v[144:147], v6 offset:21504
s_add_u32 m0, s30, 4096
v_mfma_f32_16x16x32_bf16 v[44:47], v[148:151], a[124:127], v[44:47]
s_waitcnt lgkmcnt(5)
s_add_u32 s42, s60, 4096
v_mfma_f32_16x16x32_bf16 v[48:51], v[152:155], a[120:123], v[48:51]
ds_read_b128 v[148:151], v6 offset:22528
buffer_load_dwordx4 v1, s[8:11], s42 offen offset:0 lds
v_mfma_f32_16x16x32_bf16 v[52:55], v[152:155], a[124:127], v[52:55]
s_waitcnt lgkmcnt(5)
buffer_load_dwordx4 v1, s[8:11], s42 offen offset:1024 lds
v_mfma_f32_16x16x32_bf16 v[56:59], v[156:159], a[120:123], v[56:59]
ds_read_b128 v[152:155], v6 offset:23552
v_mfma_f32_16x16x32_bf16 v[60:63], v[156:159], a[124:127], v[60:63]
s_waitcnt lgkmcnt(5)
v_mfma_f32_16x16x32_bf16 v[64:67], v[160:163], a[120:123], v[64:67]
ds_read_b128 v[156:159], v6 offset:24576
buffer_load_dwordx4 v1, s[8:11], s42 offen offset:2048 lds
v_mfma_f32_16x16x32_bf16 v[68:71], v[160:163], a[124:127], v[68:71]
s_waitcnt lgkmcnt(5)
v_mfma_f32_16x16x32_bf16 v[72:75], v[164:167], a[120:123], v[72:75]
ds_read_b128 v[160:163], v6 offset:25600
s_add_u32 m0, s61, 143360
v_mfma_f32_16x16x32_bf16 v[76:79], v[164:167], a[124:127], v[76:79]
s_waitcnt lgkmcnt(5)
s_add_u32 s42, s62, 0
v_mfma_f32_16x16x32_bf16 v[80:83], v[168:171], a[120:123], v[80:83]
ds_read_b128 v[164:167], v6 offset:26624
buffer_load_dwordx4 v1, s[8:11], s42 offen lds
v_mfma_f32_16x16x32_bf16 v[84:87], v[168:171], a[124:127], v[84:87]
s_waitcnt lgkmcnt(5)
v_mfma_f32_16x16x32_bf16 v[88:91], v[144:147], a[120:123], v[88:91]
ds_read_b128 v[168:171], v6 offset:27648
v_mfma_f32_16x16x32_bf16 v[92:95], v[144:147], a[124:127], v[92:95]
s_waitcnt lgkmcnt(5)
v_mfma_f32_16x16x32_bf16 v[96:99], v[148:151], a[120:123], v[96:99]
s_waitcnt vmcnt(20)
s_barrier
ds_read_b128 v[144:147], v6 offset:28672
s_add_u32 m0, s30, 28672
v_mfma_f32_16x16x32_bf16 v[100:103], v[148:151], a[124:127], v[100:103]
s_waitcnt lgkmcnt(5)
s_add_u32 s42, s60, 30720
v_mfma_f32_16x16x32_bf16 v[104:107], v[152:155], a[120:123], v[104:107]
ds_read_b128 v[148:151], v6 offset:29696
buffer_load_dwordx4 v1, s[8:11], s42 offen offset:0 lds
v_mfma_f32_16x16x32_bf16 v[108:111], v[152:155], a[124:127], v[108:111]
s_waitcnt lgkmcnt(5)
v_mfma_f32_16x16x32_bf16 v[112:115], v[156:159], a[120:123], v[112:115]
ds_read_b128 v[152:155], v6 offset:30720
buffer_load_dwordx4 v1, s[8:11], s42 offen offset:1024 lds
v_mfma_f32_16x16x32_bf16 v[116:119], v[156:159], a[124:127], v[116:119]
s_waitcnt lgkmcnt(5)
v_mfma_f32_16x16x32_bf16 v[120:123], v[160:163], a[120:123], v[120:123]
ds_read_b128 v[156:159], v6 offset:31744
v_mfma_f32_16x16x32_bf16 v[124:127], v[160:163], a[124:127], v[124:127]
s_waitcnt lgkmcnt(5)
v_mfma_f32_16x16x32_bf16 v[128:131], v[164:167], a[120:123], v[128:131]
ds_read_b128 v[160:163], v6 offset:32768
v_mfma_f32_16x16x32_bf16 v[132:135], v[164:167], a[124:127], v[132:135]
s_waitcnt lgkmcnt(5)
v_mfma_f32_16x16x32_bf16 v[136:139], v[168:171], a[120:123], v[136:139]
ds_read_b128 v[164:167], v6 offset:33792
s_add_u32 s45, s44, 155648
v_mfma_f32_16x16x32_bf16 v[140:143], v[168:171], a[124:127], v[140:143]
s_waitcnt lgkmcnt(5) vmcnt(21)
buffer_load_dwordx4 a[152:155], v1, s[8:11], s45 offen offset:0 sc1
v_mfma_f32_16x16x32_bf16 v[32:35], v[144:147], a[128:131], v[32:35]
ds_read_b128 v[168:171], v6 offset:34816
v_mfma_f32_16x16x32_bf16 v[36:39], v[144:147], a[132:135], v[36:39]
s_waitcnt lgkmcnt(5)
v_mfma_f32_16x16x32_bf16 v[40:43], v[148:151], a[128:131], v[40:43]
ds_read_b128 v[144:147], v6 offset:35840
v_mfma_f32_16x16x32_bf16 v[44:47], v[148:151], a[132:135], v[44:47]
s_waitcnt lgkmcnt(5)
v_mfma_f32_16x16x32_bf16 v[48:51], v[152:155], a[128:131], v[48:51]
ds_read_b128 v[148:151], v6 offset:36864
buffer_load_dwordx4 v1, s[8:11], s42 offen offset:2048 lds
v_mfma_f32_16x16x32_bf16 v[52:55], v[152:155], a[132:135], v[52:55]
s_waitcnt lgkmcnt(5)
v_mfma_f32_16x16x32_bf16 v[56:59], v[156:159], a[128:131], v[56:59]
ds_read_b128 v[152:155], v6 offset:37888
v_mfma_f32_16x16x32_bf16 v[60:63], v[156:159], a[132:135], v[60:63]
s_waitcnt lgkmcnt(5)
v_mfma_f32_16x16x32_bf16 v[64:67], v[160:163], a[128:131], v[64:67]
ds_read_b128 v[156:159], v6 offset:38912
buffer_load_dwordx4 v1, s[8:11], s42 offen offset:3072 lds
v_mfma_f32_16x16x32_bf16 v[68:71], v[160:163], a[132:135], v[68:71]
s_waitcnt lgkmcnt(5)
v_mfma_f32_16x16x32_bf16 v[72:75], v[164:167], a[128:131], v[72:75]
ds_read_b128 v[160:163], v6 offset:39936
v_mfma_f32_16x16x32_bf16 v[76:79], v[164:167], a[132:135], v[76:79]
s_waitcnt lgkmcnt(5)
v_mfma_f32_16x16x32_bf16 v[80:83], v[168:171], a[128:131], v[80:83]
ds_read_b128 v[164:167], v6 offset:40960
v_lshlrev_b32 v21, 4, v4
v_mfma_f32_16x16x32_bf16 v[84:87], v[168:171], a[132:135], v[84:87]
s_waitcnt lgkmcnt(5)
v_add_u32 v21, 153600, v21
v_mfma_f32_16x16x32_bf16 v[88:91], v[144:147], a[128:131], v[88:91]
ds_read_b128 v[168:171], v6 offset:41984
v_mov_b32 v8, -2.302208198144325
v_mfma_f32_16x16x32_bf16 v[92:95], v[144:147], a[132:135], v[92:95]
s_waitcnt lgkmcnt(5)
v_mov_b32 v9, -0.1029432395800235
v_mfma_f32_16x16x32_bf16 v[96:99], v[148:151], a[128:131], v[96:99]
ds_read_b128 v[144:147], v6 offset:43008
v_mul_f32 v10, v25, v25
v_mfma_f32_16x16x32_bf16 v[100:103], v[148:151], a[132:135], v[100:103]
s_waitcnt lgkmcnt(5)
v_mul_f32 v11, v27, v27
v_mfma_f32_16x16x32_bf16 v[104:107], v[152:155], a[128:131], v[104:107]
ds_read_b128 v[148:151], v6 offset:44032
v_mul_f32 v12, v8, v25
v_mfma_f32_16x16x32_bf16 v[108:111], v[152:155], a[132:135], v[108:111]
s_waitcnt lgkmcnt(5)
v_mul_f32 v13, v9, v25
v_mfma_f32_16x16x32_bf16 v[112:115], v[156:159], a[128:131], v[112:115]
ds_read_b128 v[152:155], v6 offset:45056
v_rcp_f32 v14, v10
v_mfma_f32_16x16x32_bf16 v[116:119], v[156:159], a[132:135], v[116:119]
s_waitcnt lgkmcnt(5)
v_mul_f32 v13, v13, v10
v_mfma_f32_16x16x32_bf16 v[120:123], v[160:163], a[128:131], v[120:123]
ds_read_b128 v[156:159], v6 offset:46080
v_mul_f32 v16, v8, v27
v_mfma_f32_16x16x32_bf16 v[124:127], v[160:163], a[132:135], v[124:127]
s_waitcnt lgkmcnt(5)
v_mul_f32 v17, v9, v27
v_mfma_f32_16x16x32_bf16 v[128:131], v[164:167], a[128:131], v[128:131]
ds_read_b128 v[160:163], v6 offset:47104
v_rcp_f32 v18, v11
v_mfma_f32_16x16x32_bf16 v[132:135], v[164:167], a[132:135], v[132:135]
s_waitcnt lgkmcnt(5)
v_mul_f32 v17, v17, v11
v_mfma_f32_16x16x32_bf16 v[136:139], v[168:171], a[128:131], v[136:139]
ds_read_b128 v[164:167], v6 offset:48128
buffer_load_dwordx4 a[156:159], v1, s[8:11], s45 offen offset:1024 sc1
v_mfma_f32_16x16x32_bf16 v[140:143], v[168:171], a[132:135], v[140:143]
s_waitcnt lgkmcnt(5) vmcnt(19)
s_add_u32 m0, s30, 32768
v_mfma_f32_16x16x32_bf16 v[32:35], v[144:147], a[136:139], v[32:35]
ds_read_b128 v[168:171], v6 offset:49152
s_add_u32 s42, s60, 34816
v_mfma_f32_16x16x32_bf16 v[36:39], v[144:147], a[140:143], v[36:39]
s_waitcnt lgkmcnt(5)
buffer_load_dwordx4 v1, s[8:11], s42 offen offset:0 lds
v_mfma_f32_16x16x32_bf16 v[40:43], v[148:151], a[136:139], v[40:43]
ds_read_b128 v[144:147], v6 offset:50176
buffer_load_dwordx4 v1, s[8:11], s42 offen offset:1024 lds
v_mfma_f32_16x16x32_bf16 v[44:47], v[148:151], a[140:143], v[44:47]
s_waitcnt lgkmcnt(5)
buffer_load_dwordx4 v1, s[8:11], s42 offen offset:2048 lds
v_mfma_f32_16x16x32_bf16 v[48:51], v[152:155], a[136:139], v[48:51]
ds_read_b128 v[148:151], v6 offset:51200
v_mfma_f32_16x16x32_bf16 v[52:55], v[152:155], a[140:143], v[52:55]
s_waitcnt lgkmcnt(5)
v_mfma_f32_16x16x32_bf16 v[56:59], v[156:159], a[136:139], v[56:59]
ds_read_b128 v[152:155], v6 offset:52224
v_mfma_f32_16x16x32_bf16 v[60:63], v[156:159], a[140:143], v[60:63]
s_waitcnt lgkmcnt(5)
v_mfma_f32_16x16x32_bf16 v[64:67], v[160:163], a[136:139], v[64:67]
ds_read_b128 v[156:159], v6 offset:53248
s_add_u32 m0, s61, 145408
v_mfma_f32_16x16x32_bf16 v[68:71], v[160:163], a[140:143], v[68:71]
s_waitcnt lgkmcnt(5)
s_add_u32 s42, s62, 30720
v_mfma_f32_16x16x32_bf16 v[72:75], v[164:167], a[136:139], v[72:75]
ds_read_b128 v[160:163], v6 offset:54272
buffer_load_dwordx4 v1, s[8:11], s42 offen lds
v_mfma_f32_16x16x32_bf16 v[76:79], v[164:167], a[140:143], v[76:79]
s_waitcnt lgkmcnt(5)
v_mfma_f32_16x16x32_bf16 v[80:83], v[168:171], a[136:139], v[80:83]
ds_read_b128 v[164:167], v6 offset:55296
ds_read_b128 v[176:179], v21 offset:0
v_mfma_f32_16x16x32_bf16 v[84:87], v[168:171], a[140:143], v[84:87]
s_waitcnt lgkmcnt(6)
v_mfma_f32_16x16x32_bf16 v[88:91], v[144:147], a[136:139], v[88:91]
ds_read_b128 v[168:171], v6 offset:56320
v_mfma_f32_16x16x32_bf16 v[92:95], v[144:147], a[140:143], v[92:95]
s_waitcnt lgkmcnt(6)
v_mfma_f32_16x16x32_bf16 v[96:99], v[148:151], a[136:139], v[96:99]
s_waitcnt vmcnt(19)
s_barrier
ds_read_b128 v[144:147], v7 offset:0
s_add_u32 m0, s30, 57344
v_mfma_f32_16x16x32_bf16 v[100:103], v[148:151], a[140:143], v[100:103]
s_waitcnt lgkmcnt(6)
s_add_u32 s42, s60, 61440
v_mfma_f32_16x16x32_bf16 v[104:107], v[152:155], a[136:139], v[104:107]
ds_read_b128 v[148:151], v7 offset:1024
buffer_load_dwordx4 v1, s[8:11], s42 offen offset:0 lds
v_mfma_f32_16x16x32_bf16 v[108:111], v[152:155], a[140:143], v[108:111]
s_waitcnt lgkmcnt(6)
ds_read_b128 v[180:183], v21 offset:64
v_mfma_f32_16x16x32_bf16 v[112:115], v[156:159], a[136:139], v[112:115]
ds_read_b128 v[152:155], v7 offset:2048
ds_read_b128 v[184:187], v21 offset:128
v_mfma_f32_16x16x32_bf16 v[116:119], v[156:159], a[140:143], v[116:119]
s_waitcnt lgkmcnt(8)
v_mfma_f32_16x16x32_bf16 v[120:123], v[160:163], a[136:139], v[120:123]
ds_read_b128 v[156:159], v7 offset:3072
buffer_load_dwordx4 v1, s[8:11], s42 offen offset:1024 lds
v_mfma_f32_16x16x32_bf16 v[124:127], v[160:163], a[140:143], v[124:127]
s_waitcnt lgkmcnt(8)
v_mfma_f32_16x16x32_bf16 v[128:131], v[164:167], a[136:139], v[128:131]
ds_read_b128 v[160:163], v7 offset:4096
ds_read_b128 v[188:191], v21 offset:192
v_mfma_f32_16x16x32_bf16 v[132:135], v[164:167], a[140:143], v[132:135]
s_waitcnt lgkmcnt(8)
v_mfma_f32_16x16x32_bf16 v[136:139], v[168:171], a[136:139], v[136:139]
ds_read_b128 v[164:167], v7 offset:5120
v_mfma_f32_16x16x32_bf16 v[140:143], v[168:171], a[140:143], v[140:143]
s_waitcnt lgkmcnt(8) vmcnt(19)
v_mfma_f32_16x16x32_bf16 v[32:35], v[144:147], a[144:147], v[32:35]
ds_read_b128 v[168:171], v7 offset:6144
buffer_load_dwordx4 v1, s[8:11], s42 offen offset:2048 lds
v_mfma_f32_16x16x32_bf16 v[36:39], v[144:147], a[148:151], v[36:39]
s_waitcnt lgkmcnt(8)
ds_read_b128 v[192:195], v21 offset:256
v_mfma_f32_16x16x32_bf16 v[40:43], v[148:151], a[144:147], v[40:43]
ds_read_b128 v[144:147], v7 offset:7168
v_mfma_f32_16x16x32_bf16 v[44:47], v[148:151], a[148:151], v[44:47]
s_waitcnt lgkmcnt(8)
v_mfma_f32_16x16x32_bf16 v[48:51], v[152:155], a[144:147], v[48:51]
ds_read_b128 v[148:151], v7 offset:8192
ds_read_b128 v[196:199], v21 offset:320
v_mfma_f32_16x16x32_bf16 v[52:55], v[152:155], a[148:151], v[52:55]
s_waitcnt lgkmcnt(8)
v_mfma_f32_16x16x32_bf16 v[56:59], v[156:159], a[144:147], v[56:59]
ds_read_b128 v[152:155], v7 offset:9216
v_mfma_f32_16x16x32_bf16 v[60:63], v[156:159], a[148:151], v[60:63]
s_waitcnt lgkmcnt(8)
v_mfma_f32_16x16x32_bf16 v[64:67], v[160:163], a[144:147], v[64:67]
ds_read_b128 v[156:159], v7 offset:10240
buffer_load_dwordx4 v1, s[8:11], s42 offen offset:3072 lds
v_mfma_f32_16x16x32_bf16 v[68:71], v[160:163], a[148:151], v[68:71]
s_waitcnt lgkmcnt(7)
ds_read_b128 v[200:203], v21 offset:384
v_mfma_f32_16x16x32_bf16 v[72:75], v[164:167], a[144:147], v[72:75]
ds_read_b128 v[160:163], v7 offset:11264
v_mfma_f32_16x16x32_bf16 v[76:79], v[164:167], a[148:151], v[76:79]
s_waitcnt lgkmcnt(8)
v_mfma_f32_16x16x32_bf16 v[80:83], v[168:171], a[144:147], v[80:83]
ds_read_b128 v[164:167], v7 offset:12288
ds_read_b128 v[204:207], v21 offset:448
v_mfma_f32_16x16x32_bf16 v[84:87], v[168:171], a[148:151], v[84:87]
s_waitcnt lgkmcnt(8)
v_mfma_f32_16x16x32_bf16 v[88:91], v[144:147], a[144:147], v[88:91]
ds_read_b128 v[168:171], v7 offset:13312
s_add_u32 m0, s30, 61440
v_mfma_f32_16x16x32_bf16 v[92:95], v[144:147], a[148:151], v[92:95]
s_waitcnt lgkmcnt(8)
s_add_u32 s42, s60, 65536
v_mfma_f32_16x16x32_bf16 v[96:99], v[148:151], a[144:147], v[96:99]
ds_read_b128 v[144:147], v7 offset:14336
buffer_load_dwordx4 v1, s[8:11], s42 offen offset:0 lds
v_mfma_f32_16x16x32_bf16 v[100:103], v[148:151], a[148:151], v[100:103]
s_waitcnt lgkmcnt(7)
ds_read_b128 v[208:211], v21 offset:512
v_mfma_f32_16x16x32_bf16 v[104:107], v[152:155], a[144:147], v[104:107]
ds_read_b128 v[148:151], v7 offset:15360
v_mfma_f32_16x16x32_bf16 v[108:111], v[152:155], a[148:151], v[108:111]
s_waitcnt lgkmcnt(8)
v_mfma_f32_16x16x32_bf16 v[112:115], v[156:159], a[144:147], v[112:115]
ds_read_b128 v[152:155], v7 offset:16384
buffer_load_dwordx4 v1, s[8:11], s42 offen offset:1024 lds
v_mfma_f32_16x16x32_bf16 v[116:119], v[156:159], a[148:151], v[116:119]
s_waitcnt lgkmcnt(7)
ds_read_b128 v[212:215], v21 offset:576
v_mfma_f32_16x16x32_bf16 v[120:123], v[160:163], a[144:147], v[120:123]
ds_read_b128 v[156:159], v7 offset:17408
v_mfma_f32_16x16x32_bf16 v[124:127], v[160:163], a[148:151], v[124:127]
s_waitcnt lgkmcnt(8)
v_mfma_f32_16x16x32_bf16 v[128:131], v[164:167], a[144:147], v[128:131]
ds_read_b128 v[160:163], v7 offset:18432
ds_read_b128 v[216:219], v21 offset:640
v_mfma_f32_16x16x32_bf16 v[132:135], v[164:167], a[148:151], v[132:135]
s_waitcnt lgkmcnt(8)
v_mfma_f32_16x16x32_bf16 v[136:139], v[168:171], a[144:147], v[136:139]
ds_read_b128 v[164:167], v7 offset:19456
v_mfma_f32_16x16x32_bf16 v[140:143], v[168:171], a[148:151], v[140:143]
s_waitcnt lgkmcnt(8) vmcnt(10)
v_mfma_f32_16x16x32_bf16 v[32:35], v[144:147], a[152:155], v[32:35]
ds_read_b128 v[168:171], v7 offset:20480
buffer_load_dwordx4 v1, s[8:11], s42 offen offset:2048 lds
v_mfma_f32_16x16x32_bf16 v[36:39], v[144:147], a[156:159], v[36:39]
s_waitcnt lgkmcnt(7)
ds_read_b128 v[220:223], v21 offset:704
v_mfma_f32_16x16x32_bf16 v[40:43], v[148:151], a[152:155], v[40:43]
ds_read_b128 v[144:147], v7 offset:21504
v_mfma_f32_16x16x32_bf16 v[44:47], v[148:151], a[156:159], v[44:47]
s_waitcnt lgkmcnt(8)
v_mfma_f32_16x16x32_bf16 v[48:51], v[152:155], a[152:155], v[48:51]
ds_read_b128 v[148:151], v7 offset:22528
ds_read_b128 v[224:227], v21 offset:768
v_mfma_f32_16x16x32_bf16 v[52:55], v[152:155], a[156:159], v[52:55]
s_waitcnt lgkmcnt(8)
v_mfma_f32_16x16x32_bf16 v[56:59], v[156:159], a[152:155], v[56:59]
ds_read_b128 v[152:155], v7 offset:23552
s_add_u32 m0, s61, 147456
v_mfma_f32_16x16x32_bf16 v[60:63], v[156:159], a[156:159], v[60:63]
s_waitcnt lgkmcnt(8)
s_add_u32 s42, s62, 61440
v_mfma_f32_16x16x32_bf16 v[64:67], v[160:163], a[152:155], v[64:67]
ds_read_b128 v[156:159], v7 offset:24576
buffer_load_dwordx4 v1, s[8:11], s42 offen lds
v_mfma_f32_16x16x32_bf16 v[68:71], v[160:163], a[156:159], v[68:71]
s_waitcnt lgkmcnt(7)
ds_read_b128 v[228:231], v21 offset:832
v_mfma_f32_16x16x32_bf16 v[72:75], v[164:167], a[152:155], v[72:75]
ds_read_b128 v[160:163], v7 offset:25600
v_mfma_f32_16x16x32_bf16 v[76:79], v[164:167], a[156:159], v[76:79]
s_waitcnt lgkmcnt(8)
v_mfma_f32_16x16x32_bf16 v[80:83], v[168:171], a[152:155], v[80:83]
ds_read_b128 v[164:167], v7 offset:26624
v_mfma_f32_16x16x32_bf16 v[84:87], v[168:171], a[156:159], v[84:87]
s_waitcnt lgkmcnt(7)
v_mfma_f32_16x16x32_bf16 v[88:91], v[144:147], a[152:155], v[88:91]
ds_read_b128 v[168:171], v7 offset:27648
v_mfma_f32_16x16x32_bf16 v[92:95], v[144:147], a[156:159], v[92:95]
s_waitcnt lgkmcnt(7)
v_mfma_f32_16x16x32_bf16 v[96:99], v[148:151], a[152:155], v[96:99]
v_mfma_f32_16x16x32_bf16 v[100:103], v[148:151], a[156:159], v[100:103]
s_waitcnt lgkmcnt(5)
v_mfma_f32_16x16x32_bf16 v[104:107], v[152:155], a[152:155], v[104:107]
v_mfma_f32_16x16x32_bf16 v[108:111], v[152:155], a[156:159], v[108:111]
s_waitcnt lgkmcnt(4)
v_mfma_f32_16x16x32_bf16 v[112:115], v[156:159], a[152:155], v[112:115]
v_mfma_f32_16x16x32_bf16 v[116:119], v[156:159], a[156:159], v[116:119]
s_waitcnt lgkmcnt(2)
v_mfma_f32_16x16x32_bf16 v[120:123], v[160:163], a[152:155], v[120:123]
v_mfma_f32_16x16x32_bf16 v[124:127], v[160:163], a[156:159], v[124:127]
s_waitcnt lgkmcnt(1)
v_mfma_f32_16x16x32_bf16 v[128:131], v[164:167], a[152:155], v[128:131]
v_mfma_f32_16x16x32_bf16 v[132:135], v[164:167], a[156:159], v[132:135]
s_waitcnt lgkmcnt(0)
v_mfma_f32_16x16x32_bf16 v[136:139], v[168:171], a[152:155], v[136:139]
v_mfma_f32_16x16x32_bf16 v[140:143], v[168:171], a[156:159], v[140:143]
s_waitcnt lgkmcnt(0)
v_pk_fma_f32 v[32:33], v[176:177], v[24:25], v[32:33] op_sel_hi:[1,0,1] neg_lo:[0,1,0] neg_hi:[0,1,0]
v_pk_fma_f32 v[34:35], v[178:179], v[24:25], v[34:35] op_sel_hi:[1,0,1] neg_lo:[0,1,0] neg_hi:[0,1,0]
v_pk_fma_f32 v[36:37], v[176:177], v[26:27], v[36:37] op_sel_hi:[1,0,1] neg_lo:[0,1,0] neg_hi:[0,1,0]
v_pk_fma_f32 v[38:39], v[178:179], v[26:27], v[38:39] op_sel_hi:[1,0,1] neg_lo:[0,1,0] neg_hi:[0,1,0]
v_pk_mul_f32 v[144:145], v[32:33], v[32:33]
v_pk_mul_f32 v[150:151], v[34:35], v[34:35]
v_pk_mul_f32 v[156:157], v[36:37], v[36:37]
v_pk_mul_f32 v[162:163], v[38:39], v[38:39]
v_pk_fma_f32 v[146:147], v[144:145], v[12:13], v[12:13] op_sel:[0,1,0] op_sel_hi:[1,1,0]
v_pk_fma_f32 v[152:153], v[150:151], v[12:13], v[12:13] op_sel:[0,1,0] op_sel_hi:[1,1,0]
v_pk_fma_f32 v[158:159], v[156:157], v[16:17], v[16:17] op_sel:[0,1,0] op_sel_hi:[1,1,0]
v_pk_fma_f32 v[164:165], v[162:163], v[16:17], v[16:17] op_sel:[0,1,0] op_sel_hi:[1,1,0]
v_pk_mul_f32 v[146:147], v[146:147], v[32:33]
v_pk_mul_f32 v[152:153], v[152:153], v[34:35]
v_pk_mul_f32 v[158:159], v[158:159], v[36:37]
v_pk_mul_f32 v[164:165], v[164:165], v[38:39]
v_exp_f32 v148, v146
v_exp_f32 v149, v147
v_exp_f32 v154, v152
s_barrier
v_exp_f32 v155, v153
v_exp_f32 v160, v158
v_exp_f32 v161, v159
v_exp_f32 v166, v164
v_exp_f32 v167, v165
v_pk_fma_f32 v[40:41], v[180:181], v[24:25], v[40:41] op_sel_hi:[1,0,1] neg_lo:[0,1,0] neg_hi:[0,1,0]
v_pk_fma_f32 v[42:43], v[182:183], v[24:25], v[42:43] op_sel_hi:[1,0,1] neg_lo:[0,1,0] neg_hi:[0,1,0]
v_pk_fma_f32 v[44:45], v[180:181], v[26:27], v[44:45] op_sel_hi:[1,0,1] neg_lo:[0,1,0] neg_hi:[0,1,0]
v_pk_fma_f32 v[46:47], v[182:183], v[26:27], v[46:47] op_sel_hi:[1,0,1] neg_lo:[0,1,0] neg_hi:[0,1,0]
v_pk_fma_f32 v[148:149], v[148:149], v[14:15], v[14:15] op_sel_hi:[1,0,0]
v_pk_fma_f32 v[154:155], v[154:155], v[14:15], v[14:15] op_sel_hi:[1,0,0]
s_add_u32 m0, s30, 86016
s_add_u32 s42, s60, 92160
buffer_load_dwordx4 v1, s[8:11], s42 offen offset:0 lds
v_pk_fma_f32 v[160:161], v[160:161], v[18:19], v[18:19] op_sel_hi:[1,0,0]
v_pk_fma_f32 v[166:167], v[166:167], v[18:19], v[18:19] op_sel_hi:[1,0,0]
v_rcp_f32 v148, v148
v_rcp_f32 v149, v149
v_rcp_f32 v154, v154
v_rcp_f32 v155, v155
v_rcp_f32 v160, v160
v_rcp_f32 v161, v161
v_rcp_f32 v166, v166
v_rcp_f32 v167, v167
v_pk_mul_f32 v[40:41], v[40:41], v[32:33]
buffer_load_dwordx4 v1, s[8:11], s42 offen offset:1024 lds
v_pk_mul_f32 v[42:43], v[42:43], v[34:35]
v_pk_mul_f32 v[44:45], v[44:45], v[36:37]
v_pk_mul_f32 v[46:47], v[46:47], v[38:39]
v_pk_mul_f32 v[40:41], v[40:41], v[148:149]
v_pk_mul_f32 v[42:43], v[42:43], v[154:155]
v_pk_mul_f32 v[44:45], v[44:45], v[160:161]
v_pk_mul_f32 v[46:47], v[46:47], v[166:167]
v_cvt_pk_bf16_f32 v168, v40, v41
v_cvt_pk_bf16_f32 v169, v42, v43
buffer_store_dwordx2 v[168:169], v242, s[8:11], s28 offen offset:0
v_cvt_pk_bf16_f32 v170, v44, v45
buffer_load_dwordx4 v1, s[8:11], s42 offen offset:2048 lds
v_cvt_pk_bf16_f32 v171, v46, v47
buffer_store_dwordx2 v[170:171], v242, s[8:11], s28 offen offset:1024
v_pk_fma_f32 v[48:49], v[184:185], v[24:25], v[48:49] op_sel_hi:[1,0,1] neg_lo:[0,1,0] neg_hi:[0,1,0]
v_pk_fma_f32 v[50:51], v[186:187], v[24:25], v[50:51] op_sel_hi:[1,0,1] neg_lo:[0,1,0] neg_hi:[0,1,0]
v_pk_fma_f32 v[52:53], v[184:185], v[26:27], v[52:53] op_sel_hi:[1,0,1] neg_lo:[0,1,0] neg_hi:[0,1,0]
v_pk_fma_f32 v[54:55], v[186:187], v[26:27], v[54:55] op_sel_hi:[1,0,1] neg_lo:[0,1,0] neg_hi:[0,1,0]
v_pk_mul_f32 v[144:145], v[48:49], v[48:49]
v_pk_mul_f32 v[150:151], v[50:51], v[50:51]
v_pk_mul_f32 v[156:157], v[52:53], v[52:53]
v_pk_mul_f32 v[162:163], v[54:55], v[54:55]
v_pk_fma_f32 v[146:147], v[144:145], v[12:13], v[12:13] op_sel:[0,1,0] op_sel_hi:[1,1,0]
buffer_load_dwordx4 v1, s[8:11], s42 offen offset:3072 lds
v_pk_fma_f32 v[152:153], v[150:151], v[12:13], v[12:13] op_sel:[0,1,0] op_sel_hi:[1,1,0]
v_pk_fma_f32 v[158:159], v[156:157], v[16:17], v[16:17] op_sel:[0,1,0] op_sel_hi:[1,1,0]
v_pk_fma_f32 v[164:165], v[162:163], v[16:17], v[16:17] op_sel:[0,1,0] op_sel_hi:[1,1,0]
v_pk_mul_f32 v[146:147], v[146:147], v[48:49]
v_pk_mul_f32 v[152:153], v[152:153], v[50:51]
v_pk_mul_f32 v[158:159], v[158:159], v[52:53]
v_pk_mul_f32 v[164:165], v[164:165], v[54:55]
v_exp_f32 v148, v146
v_exp_f32 v149, v147
v_exp_f32 v154, v152
v_exp_f32 v155, v153
s_add_u32 m0, s30, 90112
s_add_u32 s42, s60, 96256
buffer_load_dwordx4 v1, s[8:11], s42 offen offset:0 lds
v_exp_f32 v160, v158
v_exp_f32 v161, v159
v_exp_f32 v166, v164
v_exp_f32 v167, v165
v_pk_fma_f32 v[56:57], v[188:189], v[24:25], v[56:57] op_sel_hi:[1,0,1] neg_lo:[0,1,0] neg_hi:[0,1,0]
v_pk_fma_f32 v[58:59], v[190:191], v[24:25], v[58:59] op_sel_hi:[1,0,1] neg_lo:[0,1,0] neg_hi:[0,1,0]
v_pk_fma_f32 v[60:61], v[188:189], v[26:27], v[60:61] op_sel_hi:[1,0,1] neg_lo:[0,1,0] neg_hi:[0,1,0]
v_pk_fma_f32 v[62:63], v[190:191], v[26:27], v[62:63] op_sel_hi:[1,0,1] neg_lo:[0,1,0] neg_hi:[0,1,0]
v_pk_fma_f32 v[148:149], v[148:149], v[14:15], v[14:15] op_sel_hi:[1,0,0]
v_pk_fma_f32 v[154:155], v[154:155], v[14:15], v[14:15] op_sel_hi:[1,0,0]
v_pk_fma_f32 v[160:161], v[160:161], v[18:19], v[18:19] op_sel_hi:[1,0,0]
buffer_load_dwordx4 v1, s[8:11], s42 offen offset:1024 lds
v_pk_fma_f32 v[166:167], v[166:167], v[18:19], v[18:19] op_sel_hi:[1,0,0]
v_rcp_f32 v148, v148
v_rcp_f32 v149, v149
v_rcp_f32 v154, v154
v_rcp_f32 v155, v155
v_rcp_f32 v160, v160
v_rcp_f32 v161, v161
v_rcp_f32 v166, v166
v_rcp_f32 v167, v167
v_pk_mul_f32 v[56:57], v[56:57], v[48:49]
v_pk_mul_f32 v[58:59], v[58:59], v[50:51]
buffer_load_dwordx4 v1, s[8:11], s42 offen offset:2048 lds
v_pk_mul_f32 v[60:61], v[60:61], v[52:53]
v_pk_mul_f32 v[62:63], v[62:63], v[54:55]
v_pk_mul_f32 v[56:57], v[56:57], v[148:149]
v_pk_mul_f32 v[58:59], v[58:59], v[154:155]
v_pk_mul_f32 v[60:61], v[60:61], v[160:161]
v_pk_mul_f32 v[62:63], v[62:63], v[166:167]
v_cvt_pk_bf16_f32 v172, v56, v57
v_cvt_pk_bf16_f32 v173, v58, v59
buffer_store_dwordx2 v[172:173], v243, s[8:11], s28 offen offset:0
v_cvt_pk_bf16_f32 v174, v60, v61
v_cvt_pk_bf16_f32 v175, v62, v63
s_add_u32 m0, s61, 149504
s_add_u32 s42, s62, 92160
buffer_load_dwordx4 v1, s[8:11], s42 offen lds
buffer_store_dwordx2 v[174:175], v243, s[8:11], s28 offen offset:1024
v_pk_fma_f32 v[64:65], v[192:193], v[24:25], v[64:65] op_sel_hi:[1,0,1] neg_lo:[0,1,0] neg_hi:[0,1,0]
v_pk_fma_f32 v[66:67], v[194:195], v[24:25], v[66:67] op_sel_hi:[1,0,1] neg_lo:[0,1,0] neg_hi:[0,1,0]
v_pk_fma_f32 v[68:69], v[192:193], v[26:27], v[68:69] op_sel_hi:[1,0,1] neg_lo:[0,1,0] neg_hi:[0,1,0]
v_pk_fma_f32 v[70:71], v[194:195], v[26:27], v[70:71] op_sel_hi:[1,0,1] neg_lo:[0,1,0] neg_hi:[0,1,0]
v_pk_mul_f32 v[144:145], v[64:65], v[64:65]
v_pk_mul_f32 v[150:151], v[66:67], v[66:67]
v_pk_mul_f32 v[156:157], v[68:69], v[68:69]
v_pk_mul_f32 v[162:163], v[70:71], v[70:71]
v_pk_fma_f32 v[146:147], v[144:145], v[12:13], v[12:13] op_sel:[0,1,0] op_sel_hi:[1,1,0]
v_pk_fma_f32 v[152:153], v[150:151], v[12:13], v[12:13] op_sel:[0,1,0] op_sel_hi:[1,1,0]
s_add_u32 m0, s30, 114688
s_add_u32 s42, s60, 122880
buffer_load_dwordx4 v1, s[8:11], s42 offen offset:0 lds
v_pk_fma_f32 v[158:159], v[156:157], v[16:17], v[16:17] op_sel:[0,1,0] op_sel_hi:[1,1,0]
v_pk_fma_f32 v[164:165], v[162:163], v[16:17], v[16:17] op_sel:[0,1,0] op_sel_hi:[1,1,0]
v_pk_mul_f32 v[146:147], v[146:147], v[64:65]
v_pk_mul_f32 v[152:153], v[152:153], v[66:67]
v_pk_mul_f32 v[158:159], v[158:159], v[68:69]
v_pk_mul_f32 v[164:165], v[164:165], v[70:71]
v_exp_f32 v148, v146
v_exp_f32 v149, v147
v_exp_f32 v154, v152
v_exp_f32 v155, v153
v_exp_f32 v160, v158
buffer_load_dwordx4 v1, s[8:11], s42 offen offset:1024 lds
v_exp_f32 v161, v159
v_exp_f32 v166, v164
v_exp_f32 v167, v165
v_pk_fma_f32 v[72:73], v[196:197], v[24:25], v[72:73] op_sel_hi:[1,0,1] neg_lo:[0,1,0] neg_hi:[0,1,0]
v_pk_fma_f32 v[74:75], v[198:199], v[24:25], v[74:75] op_sel_hi:[1,0,1] neg_lo:[0,1,0] neg_hi:[0,1,0]
v_pk_fma_f32 v[76:77], v[196:197], v[26:27], v[76:77] op_sel_hi:[1,0,1] neg_lo:[0,1,0] neg_hi:[0,1,0]
v_pk_fma_f32 v[78:79], v[198:199], v[26:27], v[78:79] op_sel_hi:[1,0,1] neg_lo:[0,1,0] neg_hi:[0,1,0]
v_pk_fma_f32 v[148:149], v[148:149], v[14:15], v[14:15] op_sel_hi:[1,0,0]
v_pk_fma_f32 v[154:155], v[154:155], v[14:15], v[14:15] op_sel_hi:[1,0,0]
v_pk_fma_f32 v[160:161], v[160:161], v[18:19], v[18:19] op_sel_hi:[1,0,0]
v_pk_fma_f32 v[166:167], v[166:167], v[18:19], v[18:19] op_sel_hi:[1,0,0]
buffer_load_dwordx4 v1, s[8:11], s42 offen offset:2048 lds
v_rcp_f32 v148, v148
v_rcp_f32 v149, v149
v_rcp_f32 v154, v154
v_rcp_f32 v155, v155
v_rcp_f32 v160, v160
v_rcp_f32 v161, v161
v_rcp_f32 v166, v166
v_rcp_f32 v167, v167
v_pk_mul_f32 v[72:73], v[72:73], v[64:65]
v_pk_mul_f32 v[74:75], v[74:75], v[66:67]
v_pk_mul_f32 v[76:77], v[76:77], v[68:69]
buffer_load_dwordx4 v1, s[8:11], s42 offen offset:3072 lds
v_pk_mul_f32 v[78:79], v[78:79], v[70:71]
v_pk_mul_f32 v[72:73], v[72:73], v[148:149]
v_pk_mul_f32 v[74:75], v[74:75], v[154:155]
v_pk_mul_f32 v[76:77], v[76:77], v[160:161]
v_pk_mul_f32 v[78:79], v[78:79], v[166:167]
v_cvt_pk_bf16_f32 v168, v72, v73
v_cvt_pk_bf16_f32 v169, v74, v75
buffer_store_dwordx2 v[168:169], v244, s[8:11], s28 offen offset:0
v_cvt_pk_bf16_f32 v170, v76, v77
v_cvt_pk_bf16_f32 v171, v78, v79
buffer_store_dwordx2 v[170:171], v244, s[8:11], s28 offen offset:1024
s_add_u32 m0, s30, 118784
s_add_u32 s42, s60, 126976
buffer_load_dwordx4 v1, s[8:11], s42 offen offset:0 lds
v_pk_fma_f32 v[80:81], v[200:201], v[24:25], v[80:81] op_sel_hi:[1,0,1] neg_lo:[0,1,0] neg_hi:[0,1,0]
v_pk_fma_f32 v[82:83], v[202:203], v[24:25], v[82:83] op_sel_hi:[1,0,1] neg_lo:[0,1,0] neg_hi:[0,1,0]
v_pk_fma_f32 v[84:85], v[200:201], v[26:27], v[84:85] op_sel_hi:[1,0,1] neg_lo:[0,1,0] neg_hi:[0,1,0]
v_pk_fma_f32 v[86:87], v[202:203], v[26:27], v[86:87] op_sel_hi:[1,0,1] neg_lo:[0,1,0] neg_hi:[0,1,0]
v_pk_mul_f32 v[144:145], v[80:81], v[80:81]
v_pk_mul_f32 v[150:151], v[82:83], v[82:83]
v_pk_mul_f32 v[156:157], v[84:85], v[84:85]
v_pk_mul_f32 v[162:163], v[86:87], v[86:87]
v_pk_fma_f32 v[146:147], v[144:145], v[12:13], v[12:13] op_sel:[0,1,0] op_sel_hi:[1,1,0]
v_pk_fma_f32 v[152:153], v[150:151], v[12:13], v[12:13] op_sel:[0,1,0] op_sel_hi:[1,1,0]
v_pk_fma_f32 v[158:159], v[156:157], v[16:17], v[16:17] op_sel:[0,1,0] op_sel_hi:[1,1,0]
buffer_load_dwordx4 v1, s[8:11], s42 offen offset:1024 lds
v_pk_fma_f32 v[164:165], v[162:163], v[16:17], v[16:17] op_sel:[0,1,0] op_sel_hi:[1,1,0]
v_pk_mul_f32 v[146:147], v[146:147], v[80:81]
v_pk_mul_f32 v[152:153], v[152:153], v[82:83]
v_pk_mul_f32 v[158:159], v[158:159], v[84:85]
v_pk_mul_f32 v[164:165], v[164:165], v[86:87]
v_exp_f32 v148, v146
v_exp_f32 v149, v147
v_exp_f32 v154, v152
v_exp_f32 v155, v153
v_exp_f32 v160, v158
v_exp_f32 v161, v159
buffer_load_dwordx4 v1, s[8:11], s42 offen offset:2048 lds
v_exp_f32 v166, v164
v_exp_f32 v167, v165
v_pk_fma_f32 v[88:89], v[204:205], v[24:25], v[88:89] op_sel_hi:[1,0,1] neg_lo:[0,1,0] neg_hi:[0,1,0]
v_pk_fma_f32 v[90:91], v[206:207], v[24:25], v[90:91] op_sel_hi:[1,0,1] neg_lo:[0,1,0] neg_hi:[0,1,0]
v_pk_fma_f32 v[92:93], v[204:205], v[26:27], v[92:93] op_sel_hi:[1,0,1] neg_lo:[0,1,0] neg_hi:[0,1,0]
v_pk_fma_f32 v[94:95], v[206:207], v[26:27], v[94:95] op_sel_hi:[1,0,1] neg_lo:[0,1,0] neg_hi:[0,1,0]
v_pk_fma_f32 v[148:149], v[148:149], v[14:15], v[14:15] op_sel_hi:[1,0,0]
v_pk_fma_f32 v[154:155], v[154:155], v[14:15], v[14:15] op_sel_hi:[1,0,0]
v_pk_fma_f32 v[160:161], v[160:161], v[18:19], v[18:19] op_sel_hi:[1,0,0]
v_pk_fma_f32 v[166:167], v[166:167], v[18:19], v[18:19] op_sel_hi:[1,0,0]
v_rcp_f32 v148, v148
s_add_u32 m0, s61, 151552
s_add_u32 s42, s62, 122880
buffer_load_dwordx4 v1, s[8:11], s42 offen lds
v_rcp_f32 v149, v149
v_rcp_f32 v154, v154
v_rcp_f32 v155, v155
v_rcp_f32 v160, v160
v_rcp_f32 v161, v161
v_rcp_f32 v166, v166
v_rcp_f32 v167, v167
v_pk_mul_f32 v[88:89], v[88:89], v[80:81]
v_pk_mul_f32 v[90:91], v[90:91], v[82:83]
v_pk_mul_f32 v[92:93], v[92:93], v[84:85]
v_pk_mul_f32 v[94:95], v[94:95], v[86:87]
v_pk_mul_f32 v[88:89], v[88:89], v[148:149]
v_pk_mul_f32 v[90:91], v[90:91], v[154:155]
v_pk_mul_f32 v[92:93], v[92:93], v[160:161]
v_pk_mul_f32 v[94:95], v[94:95], v[166:167]
v_cvt_pk_bf16_f32 v172, v88, v89
v_cvt_pk_bf16_f32 v173, v90, v91
buffer_store_dwordx2 v[172:173], v245, s[8:11], s28 offen offset:0
v_cvt_pk_bf16_f32 v174, v92, v93
v_cvt_pk_bf16_f32 v175, v94, v95
buffer_store_dwordx2 v[174:175], v245, s[8:11], s28 offen offset:1024
v_pk_fma_f32 v[96:97], v[208:209], v[24:25], v[96:97] op_sel_hi:[1,0,1] neg_lo:[0,1,0] neg_hi:[0,1,0]
v_pk_fma_f32 v[98:99], v[210:211], v[24:25], v[98:99] op_sel_hi:[1,0,1] neg_lo:[0,1,0] neg_hi:[0,1,0]
v_pk_fma_f32 v[100:101], v[208:209], v[26:27], v[100:101] op_sel_hi:[1,0,1] neg_lo:[0,1,0] neg_hi:[0,1,0]
v_pk_fma_f32 v[102:103], v[210:211], v[26:27], v[102:103] op_sel_hi:[1,0,1] neg_lo:[0,1,0] neg_hi:[0,1,0]
v_pk_mul_f32 v[144:145], v[96:97], v[96:97]
v_pk_mul_f32 v[150:151], v[98:99], v[98:99]
v_pk_mul_f32 v[156:157], v[100:101], v[100:101]
v_pk_mul_f32 v[162:163], v[102:103], v[102:103]
v_pk_fma_f32 v[146:147], v[144:145], v[12:13], v[12:13] op_sel:[0,1,0] op_sel_hi:[1,1,0]
v_pk_fma_f32 v[152:153], v[150:151], v[12:13], v[12:13] op_sel:[0,1,0] op_sel_hi:[1,1,0]
v_pk_fma_f32 v[158:159], v[156:157], v[16:17], v[16:17] op_sel:[0,1,0] op_sel_hi:[1,1,0]
v_pk_fma_f32 v[164:165], v[162:163], v[16:17], v[16:17] op_sel:[0,1,0] op_sel_hi:[1,1,0]
v_pk_mul_f32 v[146:147], v[146:147], v[96:97]
v_pk_mul_f32 v[152:153], v[152:153], v[98:99]
v_pk_mul_f32 v[158:159], v[158:159], v[100:101]
v_pk_mul_f32 v[164:165], v[164:165], v[102:103]
v_exp_f32 v148, v146
v_exp_f32 v149, v147
v_exp_f32 v154, v152
v_exp_f32 v155, v153
v_exp_f32 v160, v158
v_exp_f32 v161, v159
v_exp_f32 v166, v164
v_exp_f32 v167, v165
v_pk_fma_f32 v[104:105], v[212:213], v[24:25], v[104:105] op_sel_hi:[1,0,1] neg_lo:[0,1,0] neg_hi:[0,1,0]
v_pk_fma_f32 v[106:107], v[214:215], v[24:25], v[106:107] op_sel_hi:[1,0,1] neg_lo:[0,1,0] neg_hi:[0,1,0]
v_pk_fma_f32 v[108:109], v[212:213], v[26:27], v[108:109] op_sel_hi:[1,0,1] neg_lo:[0,1,0] neg_hi:[0,1,0]
v_pk_fma_f32 v[110:111], v[214:215], v[26:27], v[110:111] op_sel_hi:[1,0,1] neg_lo:[0,1,0] neg_hi:[0,1,0]
v_pk_fma_f32 v[148:149], v[148:149], v[14:15], v[14:15] op_sel_hi:[1,0,0]
v_pk_fma_f32 v[154:155], v[154:155], v[14:15], v[14:15] op_sel_hi:[1,0,0]
v_pk_fma_f32 v[160:161], v[160:161], v[18:19], v[18:19] op_sel_hi:[1,0,0]
v_pk_fma_f32 v[166:167], v[166:167], v[18:19], v[18:19] op_sel_hi:[1,0,0]
v_rcp_f32 v148, v148
v_rcp_f32 v149, v149
v_rcp_f32 v154, v154
v_rcp_f32 v155, v155
v_rcp_f32 v160, v160
v_rcp_f32 v161, v161
v_rcp_f32 v166, v166
v_rcp_f32 v167, v167
v_pk_mul_f32 v[104:105], v[104:105], v[96:97]
v_pk_mul_f32 v[106:107], v[106:107], v[98:99]
v_pk_mul_f32 v[108:109], v[108:109], v[100:101]
v_pk_mul_f32 v[110:111], v[110:111], v[102:103]
v_pk_mul_f32 v[104:105], v[104:105], v[148:149]
v_pk_mul_f32 v[106:107], v[106:107], v[154:155]
v_pk_mul_f32 v[108:109], v[108:109], v[160:161]
v_pk_mul_f32 v[110:111], v[110:111], v[166:167]
v_cvt_pk_bf16_f32 v168, v104, v105
v_cvt_pk_bf16_f32 v169, v106, v107
buffer_store_dwordx2 v[168:169], v246, s[8:11], s28 offen offset:0
v_cvt_pk_bf16_f32 v170, v108, v109
v_cvt_pk_bf16_f32 v171, v110, v111
buffer_store_dwordx2 v[170:171], v246, s[8:11], s28 offen offset:1024
v_pk_fma_f32 v[112:113], v[216:217], v[24:25], v[112:113] op_sel_hi:[1,0,1] neg_lo:[0,1,0] neg_hi:[0,1,0]
v_pk_fma_f32 v[114:115], v[218:219], v[24:25], v[114:115] op_sel_hi:[1,0,1] neg_lo:[0,1,0] neg_hi:[0,1,0]
v_pk_fma_f32 v[116:117], v[216:217], v[26:27], v[116:117] op_sel_hi:[1,0,1] neg_lo:[0,1,0] neg_hi:[0,1,0]
v_pk_fma_f32 v[118:119], v[218:219], v[26:27], v[118:119] op_sel_hi:[1,0,1] neg_lo:[0,1,0] neg_hi:[0,1,0]
v_pk_mul_f32 v[144:145], v[112:113], v[112:113]
v_pk_mul_f32 v[150:151], v[114:115], v[114:115]
v_pk_mul_f32 v[156:157], v[116:117], v[116:117]
v_pk_mul_f32 v[162:163], v[118:119], v[118:119]
v_pk_fma_f32 v[146:147], v[144:145], v[12:13], v[12:13] op_sel:[0,1,0] op_sel_hi:[1,1,0]
v_pk_fma_f32 v[152:153], v[150:151], v[12:13], v[12:13] op_sel:[0,1,0] op_sel_hi:[1,1,0]
v_pk_fma_f32 v[158:159], v[156:157], v[16:17], v[16:17] op_sel:[0,1,0] op_sel_hi:[1,1,0]
v_pk_fma_f32 v[164:165], v[162:163], v[16:17], v[16:17] op_sel:[0,1,0] op_sel_hi:[1,1,0]
v_pk_mul_f32 v[146:147], v[146:147], v[112:113]
v_pk_mul_f32 v[152:153], v[152:153], v[114:115]
v_pk_mul_f32 v[158:159], v[158:159], v[116:117]
v_pk_mul_f32 v[164:165], v[164:165], v[118:119]
v_exp_f32 v148, v146
v_exp_f32 v149, v147
v_exp_f32 v154, v152
v_exp_f32 v155, v153
v_exp_f32 v160, v158
v_exp_f32 v161, v159
v_exp_f32 v166, v164
v_exp_f32 v167, v165
v_pk_fma_f32 v[120:121], v[220:221], v[24:25], v[120:121] op_sel_hi:[1,0,1] neg_lo:[0,1,0] neg_hi:[0,1,0]
v_pk_fma_f32 v[122:123], v[222:223], v[24:25], v[122:123] op_sel_hi:[1,0,1] neg_lo:[0,1,0] neg_hi:[0,1,0]
v_pk_fma_f32 v[124:125], v[220:221], v[26:27], v[124:125] op_sel_hi:[1,0,1] neg_lo:[0,1,0] neg_hi:[0,1,0]
v_pk_fma_f32 v[126:127], v[222:223], v[26:27], v[126:127] op_sel_hi:[1,0,1] neg_lo:[0,1,0] neg_hi:[0,1,0]
v_pk_fma_f32 v[148:149], v[148:149], v[14:15], v[14:15] op_sel_hi:[1,0,0]
v_pk_fma_f32 v[154:155], v[154:155], v[14:15], v[14:15] op_sel_hi:[1,0,0]
v_pk_fma_f32 v[160:161], v[160:161], v[18:19], v[18:19] op_sel_hi:[1,0,0]
v_pk_fma_f32 v[166:167], v[166:167], v[18:19], v[18:19] op_sel_hi:[1,0,0]
v_rcp_f32 v148, v148
v_rcp_f32 v149, v149
v_rcp_f32 v154, v154
v_rcp_f32 v155, v155
v_rcp_f32 v160, v160
v_rcp_f32 v161, v161
v_rcp_f32 v166, v166
v_rcp_f32 v167, v167
v_pk_mul_f32 v[120:121], v[120:121], v[112:113]
v_pk_mul_f32 v[122:123], v[122:123], v[114:115]
v_pk_mul_f32 v[124:125], v[124:125], v[116:117]
v_pk_mul_f32 v[126:127], v[126:127], v[118:119]
v_pk_mul_f32 v[120:121], v[120:121], v[148:149]
v_pk_mul_f32 v[122:123], v[122:123], v[154:155]
v_pk_mul_f32 v[124:125], v[124:125], v[160:161]
v_pk_mul_f32 v[126:127], v[126:127], v[166:167]
v_cvt_pk_bf16_f32 v172, v120, v121
v_cvt_pk_bf16_f32 v173, v122, v123
buffer_store_dwordx2 v[172:173], v247, s[8:11], s28 offen offset:0
v_cvt_pk_bf16_f32 v174, v124, v125
v_cvt_pk_bf16_f32 v175, v126, v127
buffer_store_dwordx2 v[174:175], v247, s[8:11], s28 offen offset:1024
v_pk_fma_f32 v[128:129], v[224:225], v[24:25], v[128:129] op_sel_hi:[1,0,1] neg_lo:[0,1,0] neg_hi:[0,1,0]
v_pk_fma_f32 v[130:131], v[226:227], v[24:25], v[130:131] op_sel_hi:[1,0,1] neg_lo:[0,1,0] neg_hi:[0,1,0]
v_pk_fma_f32 v[132:133], v[224:225], v[26:27], v[132:133] op_sel_hi:[1,0,1] neg_lo:[0,1,0] neg_hi:[0,1,0]
v_pk_fma_f32 v[134:135], v[226:227], v[26:27], v[134:135] op_sel_hi:[1,0,1] neg_lo:[0,1,0] neg_hi:[0,1,0]
v_pk_mul_f32 v[144:145], v[128:129], v[128:129]
v_pk_mul_f32 v[150:151], v[130:131], v[130:131]
v_pk_mul_f32 v[156:157], v[132:133], v[132:133]
v_pk_mul_f32 v[162:163], v[134:135], v[134:135]
v_pk_fma_f32 v[146:147], v[144:145], v[12:13], v[12:13] op_sel:[0,1,0] op_sel_hi:[1,1,0]
v_pk_fma_f32 v[152:153], v[150:151], v[12:13], v[12:13] op_sel:[0,1,0] op_sel_hi:[1,1,0]
v_pk_fma_f32 v[158:159], v[156:157], v[16:17], v[16:17] op_sel:[0,1,0] op_sel_hi:[1,1,0]
v_pk_fma_f32 v[164:165], v[162:163], v[16:17], v[16:17] op_sel:[0,1,0] op_sel_hi:[1,1,0]
v_pk_mul_f32 v[146:147], v[146:147], v[128:129]
v_pk_mul_f32 v[152:153], v[152:153], v[130:131]
v_pk_mul_f32 v[158:159], v[158:159], v[132:133]
v_pk_mul_f32 v[164:165], v[164:165], v[134:135]
v_exp_f32 v148, v146
v_exp_f32 v149, v147
v_exp_f32 v154, v152
v_exp_f32 v155, v153
v_exp_f32 v160, v158
v_exp_f32 v161, v159
v_exp_f32 v166, v164
v_exp_f32 v167, v165
v_pk_fma_f32 v[136:137], v[228:229], v[24:25], v[136:137] op_sel_hi:[1,0,1] neg_lo:[0,1,0] neg_hi:[0,1,0]
v_pk_fma_f32 v[138:139], v[230:231], v[24:25], v[138:139] op_sel_hi:[1,0,1] neg_lo:[0,1,0] neg_hi:[0,1,0]
v_pk_fma_f32 v[140:141], v[228:229], v[26:27], v[140:141] op_sel_hi:[1,0,1] neg_lo:[0,1,0] neg_hi:[0,1,0]
v_pk_fma_f32 v[142:143], v[230:231], v[26:27], v[142:143] op_sel_hi:[1,0,1] neg_lo:[0,1,0] neg_hi:[0,1,0]
v_pk_fma_f32 v[148:149], v[148:149], v[14:15], v[14:15] op_sel_hi:[1,0,0]
v_pk_fma_f32 v[154:155], v[154:155], v[14:15], v[14:15] op_sel_hi:[1,0,0]
v_pk_fma_f32 v[160:161], v[160:161], v[18:19], v[18:19] op_sel_hi:[1,0,0]
v_pk_fma_f32 v[166:167], v[166:167], v[18:19], v[18:19] op_sel_hi:[1,0,0]
v_rcp_f32 v148, v148
v_rcp_f32 v149, v149
v_rcp_f32 v154, v154
v_rcp_f32 v155, v155
v_rcp_f32 v160, v160
v_rcp_f32 v161, v161
v_rcp_f32 v166, v166
v_rcp_f32 v167, v167
v_pk_mul_f32 v[136:137], v[136:137], v[128:129]
v_pk_mul_f32 v[138:139], v[138:139], v[130:131]
v_pk_mul_f32 v[140:141], v[140:141], v[132:133]
v_pk_mul_f32 v[142:143], v[142:143], v[134:135]
v_pk_mul_f32 v[136:137], v[136:137], v[148:149]
v_pk_mul_f32 v[138:139], v[138:139], v[154:155]
v_pk_mul_f32 v[140:141], v[140:141], v[160:161]
v_pk_mul_f32 v[142:143], v[142:143], v[166:167]
v_cvt_pk_bf16_f32 v168, v136, v137
v_cvt_pk_bf16_f32 v169, v138, v139
buffer_store_dwordx2 v[168:169], v248, s[8:11], s28 offen offset:0
v_cvt_pk_bf16_f32 v170, v140, v141
v_cvt_pk_bf16_f32 v171, v142, v143
buffer_store_dwordx2 v[170:171], v248, s[8:11], s28 offen offset:1024
s_add_u32 s56, s56, 1
v_mov_b32 v8, s56
v_mov_b32 v9, s57
s_mov_b64 s[38:39], exec
s_waitcnt vmcnt(0)
s_mov_b64 exec, 1
buffer_store_dword v8, v9, s[8:11], 0 offen
s_mov_b64 exec, s[38:39]
s_cmp_lg_u32 s16, 0
s_cbranch_scc1 L_tb_66
v_lshlrev_b32 v10, 2, v2
v_add_u32 v10, s58, v10
s_mov_b32 s40, 0
L_poll_67:
buffer_load_dword v11, v10, s[8:11], 0 offen sc1
s_add_u32 s40, s40, 1
s_cmp_gt_u32 s40, 40000
s_cbranch_scc1 L_polld_68
s_waitcnt vmcnt(0)
v_subrev_u32 v11, s56, v11
v_cmp_lt_u32 vcc, 1, v11
s_cbranch_vccnz L_poll_67
L_polld_68:
L_tb_66:
s_barrier
s_cmp_lg_u32 s31, 0
s_cbranch_scc1 L_g4final_69
s_mul_i32 s44, s96, 221184
s_lshl_b32 s45, s99, 10
s_add_u32 s44, s44, s45
s_add_u32 s44, s44, s28
s_add_u32 s45, s44, 0
s_nop 0
buffer_load_dwordx4 a[0:3], v1, s[8:11], s45 offen offset:0 sc1
buffer_load_dwordx4 a[4:7], v1, s[8:11], s45 offen offset:1024 sc1
s_add_u32 s45, s44, 8192
buffer_load_dwordx4 a[8:11], v1, s[8:11], s45 offen offset:0 sc1
buffer_load_dwordx4 a[12:15], v1, s[8:11], s45 offen offset:1024 sc1
s_add_u32 s45, s44, 16384
buffer_load_dwordx4 a[16:19], v1, s[8:11], s45 offen offset:0 sc1
buffer_load_dwordx4 a[20:23], v1, s[8:11], s45 offen offset:1024 sc1
s_add_u32 s45, s44, 24576
buffer_load_dwordx4 a[24:27], v1, s[8:11], s45 offen offset:0 sc1
buffer_load_dwordx4 a[28:31], v1, s[8:11], s45 offen offset:1024 sc1
s_add_u32 s45, s44, 32768
buffer_load_dwordx4 a[32:35], v1, s[8:11], s45 offen offset:0 sc1
buffer_load_dwordx4 a[36:39], v1, s[8:11], s45 offen offset:1024 sc1
s_mul_i32 s48, s96, 14336
v_add_u32 v5, s48, v1
v_add_u32 v6, 57344, v5
v_add_u32 v7, 114688, v5
s_lshl_b32 s48, s96, 10
s_add_u32 s48, s48, 143360
v_add_u32_e64 v10, s48, v1
ds_read_b128 v[72:75], v5 offset:0
ds_read_b128 v[76:79], v5 offset:1024
ds_read_b128 v[80:83], v5 offset:2048
ds_read_b128 v[84:87], v5 offset:3072
ds_read_b128 v[88:91], v5 offset:4096
ds_read_b128 v[92:95], v5 offset:5120
s_waitcnt lgkmcnt(5) vmcnt(8)
v_mfma_f32_16x16x32_bf16 v[32:35], v[72:75], a[0:3], 0
ds_read_b128 v[96:99], v5 offset:6144
s_add_u32 s45, s44, 40960
v_mfma_f32_16x16x32_bf16 v[52:55], v[72:75], a[4:7], 0
s_waitcnt lgkmcnt(5)
buffer_load_dwordx4 a[40:43], v1, s[8:11], s45 offen offset:0 sc1
v_mfma_f32_16x16x32_bf16 v[36:39], v[76:79], a[0:3], 0
ds_read_b128 v[72:75], v5 offset:7168
buffer_load_dwordx4 a[44:47], v1, s[8:11], s45 offen offset:1024 sc1
v_mfma_f32_16x16x32_bf16 v[56:59], v[76:79], a[4:7], 0
s_waitcnt lgkmcnt(5)
s_add_u32 s45, s44, 49152
v_mfma_f32_16x16x32_bf16 v[40:43], v[80:83], a[0:3], 0
ds_read_b128 v[76:79], v5 offset:8192
buffer_load_dwordx4 a[48:51], v1, s[8:11], s45 offen offset:0 sc1
v_mfma_f32_16x16x32_bf16 v[60:63], v[80:83], a[4:7], 0
s_waitcnt lgkmcnt(5)
buffer_load_dwordx4 a[52:55], v1, s[8:11], s45 offen offset:1024 sc1
v_mfma_f32_16x16x32_bf16 v[44:47], v[84:87], a[0:3], 0
ds_read_b128 v[80:83], v5 offset:9216
s_add_u32 s45, s44, 57344
v_mfma_f32_16x16x32_bf16 v[64:67], v[84:87], a[4:7], 0
s_waitcnt lgkmcnt(5)
buffer_load_dwordx4 a[56:59], v1, s[8:11], s45 offen offset:0 sc1
v_mfma_f32_16x16x32_bf16 v[48:51], v[88:91], a[0:3], 0
ds_read_b128 v[84:87], v5 offset:10240
buffer_load_dwordx4 a[60:63], v1, s[8:11], s45 offen offset:1024 sc1
v_mfma_f32_16x16x32_bf16 v[68:71], v[88:91], a[4:7], 0
s_waitcnt lgkmcnt(5) vmcnt(12)
v_mfma_f32_16x16x32_bf16 v[32:35], v[92:95], a[8:11], v[32:35]
ds_read_b128 v[88:91], v5 offset:11264
s_add_u32 s45, s44, 65536
v_mfma_f32_16x16x32_bf16 v[52:55], v[92:95], a[12:15], v[52:55]
s_waitcnt lgkmcnt(5)
buffer_load_dwordx4 a[64:67], v1, s[8:11], s45 offen offset:0 sc1
v_mfma_f32_16x16x32_bf16 v[36:39], v[96:99], a[8:11], v[36:39]
ds_read_b128 v[92:95], v5 offset:12288
buffer_load_dwordx4 a[68:71], v1, s[8:11], s45 offen offset:1024 sc1
v_mfma_f32_16x16x32_bf16 v[56:59], v[96:99], a[12:15], v[56:59]
s_waitcnt lgkmcnt(5)
v_mfma_f32_16x16x32_bf16 v[40:43], v[72:75], a[8:11], v[40:43]
ds_read_b128 v[96:99], v5 offset:13312
s_add_u32 s45, s44, 73728
v_mfma_f32_16x16x32_bf16 v[60:63], v[72:75], a[12:15], v[60:63]
s_waitcnt lgkmcnt(5)
buffer_load_dwordx4 a[72:75], v1, s[8:11], s45 offen offset:0 sc1
v_mfma_f32_16x16x32_bf16 v[44:47], v[76:79], a[8:11], v[44:47]
ds_read_b128 v[72:75], v10 offset:0
buffer_load_dwordx4 a[76:79], v1, s[8:11], s45 offen offset:1024 sc1
v_mfma_f32_16x16x32_bf16 v[64:67], v[76:79], a[12:15], v[64:67]
s_waitcnt lgkmcnt(5)
v_mfma_f32_16x16x32_bf16 v[48:51], v[80:83], a[8:11], v[48:51]
s_barrier
ds_read_b128 v[76:79], v5 offset:28672
s_add_u32 s45, s44, 81920
v_mfma_f32_16x16x32_bf16 v[68:71], v[80:83], a[12:15], v[68:71]
s_waitcnt lgkmcnt(5) vmcnt(14)
buffer_load_dwordx4 a[80:83], v1, s[8:11], s45 offen offset:0 sc1
v_mfma_f32_16x16x32_bf16 v[32:35], v[84:87], a[16:19], v[32:35]
ds_read_b128 v[80:83], v5 offset:29696
buffer_load_dwordx4 a[84:87], v1, s[8:11], s45 offen offset:1024 sc1
v_mfma_f32_16x16x32_bf16 v[52:55], v[84:87], a[20:23], v[52:55]
s_waitcnt lgkmcnt(5)
v_mfma_f32_16x16x32_bf16 v[36:39], v[88:91], a[16:19], v[36:39]
ds_read_b128 v[84:87], v5 offset:30720
v_mfma_f32_16x16x32_bf16 v[56:59], v[88:91], a[20:23], v[56:59]
s_waitcnt lgkmcnt(5)
v_mfma_f32_16x16x32_bf16 v[40:43], v[92:95], a[16:19], v[40:43]
ds_read_b128 v[88:91], v5 offset:31744
s_add_u32 s45, s44, 90112
v_mfma_f32_16x16x32_bf16 v[60:63], v[92:95], a[20:23], v[60:63]
s_waitcnt lgkmcnt(5)
buffer_load_dwordx4 a[88:91], v1, s[8:11], s45 offen offset:0 sc1
v_mfma_f32_16x16x32_bf16 v[44:47], v[96:99], a[16:19], v[44:47]
ds_read_b128 v[92:95], v5 offset:32768
buffer_load_dwordx4 a[92:95], v1, s[8:11], s45 offen offset:1024 sc1
v_mfma_f32_16x16x32_bf16 v[64:67], v[96:99], a[20:23], v[64:67]
s_waitcnt lgkmcnt(5)
v_mfma_f32_16x16x32_bf16 v[48:51], v[72:75], a[16:19], v[48:51]
ds_read_b128 v[96:99], v5 offset:33792
v_mfma_f32_16x16x32_bf16 v[68:71], v[72:75], a[20:23], v[68:71]
s_waitcnt lgkmcnt(5) vmcnt(16)
v_mfma_f32_16x16x32_bf16 v[32:35], v[76:79], a[24:27], v[32:35]
ds_read_b128 v[72:75], v5 offset:34816
s_add_u32 s45, s44, 98304
v_mfma_f32_16x16x32_bf16 v[52:55], v[76:79], a[28:31], v[52:55]
s_waitcnt lgkmcnt(5)
buffer_load_dwordx4 a[96:99], v1, s[8:11], s45 offen offset:0 sc1
v_mfma_f32_16x16x32_bf16 v[36:39], v[80:83], a[24:27], v[36:39]
ds_read_b128 v[76:79], v5 offset:35840
buffer_load_dwordx4 a[100:103], v1, s[8:11], s45 offen offset:1024 sc1
v_mfma_f32_16x16x32_bf16 v[56:59], v[80:83], a[28:31], v[56:59]
s_waitcnt lgkmcnt(5)
v_mfma_f32_16x16x32_bf16 v[40:43], v[84:87], a[24:27], v[40:43]
ds_read_b128 v[80:83], v5 offset:36864
v_mfma_f32_16x16x32_bf16 v[60:63], v[84:87], a[28:31], v[60:63]
s_waitcnt lgkmcnt(5)
v_mfma_f32_16x16x32_bf16 v[44:47], v[88:91], a[24:27], v[44:47]
ds_read_b128 v[84:87], v5 offset:37888
s_add_u32 s45, s44, 106496
v_mfma_f32_16x16x32_bf16 v[64:67], v[88:91], a[28:31], v[64:67]
s_waitcnt lgkmcnt(5)
buffer_load_dwordx4 a[104:107], v1, s[8:11], s45 offen offset:0 sc1
v_mfma_f32_16x16x32_bf16 v[48:51], v[92:95], a[24:27], v[48:51]
ds_read_b128 v[88:91], v5 offset:38912
buffer_load_dwordx4 a[108:111], v1, s[8:11], s45 offen offset:1024 sc1
v_mfma_f32_16x16x32_bf16 v[68:71], v[92:95], a[28:31], v[68:71]
s_waitcnt lgkmcnt(5) vmcnt(18)
v_mfma_f32_16x16x32_bf16 v[32:35], v[96:99], a[32:35], v[32:35]
ds_read_b128 v[92:95], v5 offset:39936
v_mfma_f32_16x16x32_bf16 v[52:55], v[96:99], a[36:39], v[52:55]
s_waitcnt lgkmcnt(5)
v_mfma_f32_16x16x32_bf16 v[36:39], v[72:75], a[32:35], v[36:39]
ds_read_b128 v[96:99], v5 offset:40960
s_add_u32 s45, s44, 114688
v_mfma_f32_16x16x32_bf16 v[56:59], v[72:75], a[36:39], v[56:59]
s_waitcnt lgkmcnt(5)
buffer_load_dwordx4 a[112:115], v1, s[8:11], s45 offen offset:0 sc1
v_mfma_f32_16x16x32_bf16 v[40:43], v[76:79], a[32:35], v[40:43]
ds_read_b128 v[72:75], v5 offset:41984
buffer_load_dwordx4 a[116:119], v1, s[8:11], s45 offen offset:1024 sc1
v_mfma_f32_16x16x32_bf16 v[60:63], v[76:79], a[36:39], v[60:63]
s_waitcnt lgkmcnt(5)
v_mfma_f32_16x16x32_bf16 v[44:47], v[80:83], a[32:35], v[44:47]
ds_read_b128 v[76:79], v10 offset:2048
v_mfma_f32_16x16x32_bf16 v[64:67], v[80:83], a[36:39], v[64:67]
s_waitcnt lgkmcnt(5)
v_mfma_f32_16x16x32_bf16 v[48:51], v[84:87], a[32:35], v[48:51]
s_barrier
ds_read_b128 v[80:83], v6 offset:0
s_add_u32 s45, s44, 122880
v_mfma_f32_16x16x32_bf16 v[68:71], v[84:87], a[36:39], v[68:71]
s_waitcnt lgkmcnt(5) vmcnt(18)
buffer_load_dwordx4 a[120:123], v1, s[8:11], s45 offen offset:0 sc1
v_mfma_f32_16x16x32_bf16 v[32:35], v[88:91], a[40:43], v[32:35]
ds_read_b128 v[84:87], v6 offset:1024
s_add_u32 m0, s30, 0
v_mfma_f32_16x16x32_bf16 v[52:55], v[88:91], a[44:47], v[52:55]
s_waitcnt lgkmcnt(5)
s_add_u32 s42, s60, 153600
v_mfma_f32_16x16x32_bf16 v[36:39], v[92:95], a[40:43], v[36:39]
ds_read_b128 v[88:91], v6 offset:2048
buffer_load_dwordx4 v1, s[8:11], s42 offen offset:0 lds
v_mfma_f32_16x16x32_bf16 v[56:59], v[92:95], a[44:47], v[56:59]
s_waitcnt lgkmcnt(5)
v_mfma_f32_16x16x32_bf16 v[40:43], v[96:99], a[40:43], v[40:43]
ds_read_b128 v[92:95], v6 offset:3072
buffer_load_dwordx4 a[124:127], v1, s[8:11], s45 offen offset:1024 sc1
v_mfma_f32_16x16x32_bf16 v[60:63], v[96:99], a[44:47], v[60:63]
s_waitcnt lgkmcnt(5)
v_mfma_f32_16x16x32_bf16 v[44:47], v[72:75], a[40:43], v[44:47]
ds_read_b128 v[96:99], v6 offset:4096
v_mfma_f32_16x16x32_bf16 v[64:67], v[72:75], a[44:47], v[64:67]
s_waitcnt lgkmcnt(5)
v_mfma_f32_16x16x32_bf16 v[48:51], v[76:79], a[40:43], v[48:51]
ds_read_b128 v[72:75], v6 offset:5120
buffer_load_dwordx4 v1, s[8:11], s42 offen offset:1024 lds
v_mfma_f32_16x16x32_bf16 v[68:71], v[76:79], a[44:47], v[68:71]
s_waitcnt lgkmcnt(5) vmcnt(20)
v_mfma_f32_16x16x32_bf16 v[32:35], v[80:83], a[48:51], v[32:35]
ds_read_b128 v[76:79], v6 offset:6144
v_mfma_f32_16x16x32_bf16 v[52:55], v[80:83], a[52:55], v[52:55]
s_waitcnt lgkmcnt(5)
v_mfma_f32_16x16x32_bf16 v[36:39], v[84:87], a[48:51], v[36:39]
ds_read_b128 v[80:83], v6 offset:7168
s_add_u32 s45, s44, 131072
v_mfma_f32_16x16x32_bf16 v[56:59], v[84:87], a[52:55], v[56:59]
s_waitcnt lgkmcnt(5)
buffer_load_dwordx4 a[128:131], v1, s[8:11], s45 offen offset:0 sc1
v_mfma_f32_16x16x32_bf16 v[40:43], v[88:91], a[48:51], v[40:43]
ds_read_b128 v[84:87], v6 offset:8192
v_mfma_f32_16x16x32_bf16 v[60:63], v[88:91], a[52:55], v[60:63]
s_waitcnt lgkmcnt(5)
v_mfma_f32_16x16x32_bf16 v[44:47], v[92:95], a[48:51], v[44:47]
ds_read_b128 v[88:91], v6 offset:9216
buffer_load_dwordx4 v1, s[8:11], s42 offen offset:2048 lds
v_mfma_f32_16x16x32_bf16 v[64:67], v[92:95], a[52:55], v[64:67]
s_waitcnt lgkmcnt(5)
v_mfma_f32_16x16x32_bf16 v[48:51], v[96:99], a[48:51], v[48:51]
ds_read_b128 v[92:95], v6 offset:10240
v_mfma_f32_16x16x32_bf16 v[68:71], v[96:99], a[52:55], v[68:71]
s_waitcnt lgkmcnt(5) vmcnt(20)
v_mfma_f32_16x16x32_bf16 v[32:35], v[72:75], a[56:59], v[32:35]
ds_read_b128 v[96:99], v6 offset:11264
buffer_load_dwordx4 a[132:135], v1, s[8:11], s45 offen offset:1024 sc1
v_mfma_f32_16x16x32_bf16 v[52:55], v[72:75], a[60:63], v[52:55]
s_waitcnt lgkmcnt(5)
v_mfma_f32_16x16x32_bf16 v[36:39], v[76:79], a[56:59], v[36:39]
ds_read_b128 v[72:75], v6 offset:12288
v_mfma_f32_16x16x32_bf16 v[56:59], v[76:79], a[60:63], v[56:59]
s_waitcnt lgkmcnt(5)
v_mfma_f32_16x16x32_bf16 v[40:43], v[80:83], a[56:59], v[40:43]
ds_read_b128 v[76:79], v6 offset:13312
buffer_load_dwordx4 v1, s[8:11], s42 offen offset:3072 lds
v_mfma_f32_16x16x32_bf16 v[60:63], v[80:83], a[60:63], v[60:63]
s_waitcnt lgkmcnt(5)
v_mfma_f32_16x16x32_bf16 v[44:47], v[84:87], a[56:59], v[44:47]
ds_read_b128 v[80:83], v10 offset:4096
v_mfma_f32_16x16x32_bf16 v[64:67], v[84:87], a[60:63], v[64:67]
s_waitcnt lgkmcnt(5)
v_mfma_f32_16x16x32_bf16 v[48:51], v[88:91], a[56:59], v[48:51]
s_barrier
ds_read_b128 v[84:87], v6 offset:28672
s_add_u32 s45, s44, 139264
v_mfma_f32_16x16x32_bf16 v[68:71], v[88:91], a[60:63], v[68:71]
s_waitcnt lgkmcnt(5) vmcnt(20)
buffer_load_dwordx4 a[136:139], v1, s[8:11], s45 offen offset:0 sc1
v_mfma_f32_16x16x32_bf16 v[32:35], v[92:95], a[64:67], v[32:35]
ds_read_b128 v[88:91], v6 offset:29696
s_add_u32 m0, s30, 4096
v_mfma_f32_16x16x32_bf16 v[52:55], v[92:95], a[68:71], v[52:55]
s_waitcnt lgkmcnt(5)
s_add_u32 s42, s60, 157696
v_mfma_f32_16x16x32_bf16 v[36:39], v[96:99], a[64:67], v[36:39]
ds_read_b128 v[92:95], v6 offset:30720
buffer_load_dwordx4 v1, s[8:11], s42 offen offset:0 lds
v_mfma_f32_16x16x32_bf16 v[56:59], v[96:99], a[68:71], v[56:59]
s_waitcnt lgkmcnt(5)
buffer_load_dwordx4 a[140:143], v1, s[8:11], s45 offen offset:1024 sc1
v_mfma_f32_16x16x32_bf16 v[40:43], v[72:75], a[64:67], v[40:43]
ds_read_b128 v[96:99], v6 offset:31744
buffer_load_dwordx4 v1, s[8:11], s42 offen offset:1024 lds
v_mfma_f32_16x16x32_bf16 v[60:63], v[72:75], a[68:71], v[60:63]
s_waitcnt lgkmcnt(5)
v_mfma_f32_16x16x32_bf16 v[44:47], v[76:79], a[64:67], v[44:47]
ds_read_b128 v[72:75], v6 offset:32768
v_mfma_f32_16x16x32_bf16 v[64:67], v[76:79], a[68:71], v[64:67]
s_waitcnt lgkmcnt(5)
v_mfma_f32_16x16x32_bf16 v[48:51], v[80:83], a[64:67], v[48:51]
ds_read_b128 v[76:79], v6 offset:33792
s_add_u32 s45, s44, 147456
v_mfma_f32_16x16x32_bf16 v[68:71], v[80:83], a[68:71], v[68:71]
s_waitcnt lgkmcnt(5) vmcnt(22)
buffer_load_dwordx4 a[144:147], v1, s[8:11], s45 offen offset:0 sc1
v_mfma_f32_16x16x32_bf16 v[32:35], v[84:87], a[72:75], v[32:35]
ds_read_b128 v[80:83], v6 offset:34816
buffer_load_dwordx4 v1, s[8:11], s42 offen offset:2048 lds
v_mfma_f32_16x16x32_bf16 v[52:55], v[84:87], a[76:79], v[52:55]
s_waitcnt lgkmcnt(5)
v_mfma_f32_16x16x32_bf16 v[36:39], v[88:91], a[72:75], v[36:39]
ds_read_b128 v[84:87], v6 offset:35840
buffer_load_dwordx4 a[148:151], v1, s[8:11], s45 offen offset:1024 sc1
v_mfma_f32_16x16x32_bf16 v[56:59], v[88:91], a[76:79], v[56:59]
s_waitcnt lgkmcnt(5)
v_mfma_f32_16x16x32_bf16 v[40:43], v[92:95], a[72:75], v[40:43]
ds_read_b128 v[88:91], v6 offset:36864
s_add_u32 m0, s61, 143360
v_mfma_f32_16x16x32_bf16 v[60:63], v[92:95], a[76:79], v[60:63]
s_waitcnt lgkmcnt(5)
s_add_u32 s42, s62, 153600
v_mfma_f32_16x16x32_bf16 v[44:47], v[96:99], a[72:75], v[44:47]
ds_read_b128 v[92:95], v6 offset:37888
buffer_load_dwordx4 v1, s[8:11], s42 offen lds
v_mfma_f32_16x16x32_bf16 v[64:67], v[96:99], a[76:79], v[64:67]
s_waitcnt lgkmcnt(5)
v_mfma_f32_16x16x32_bf16 v[48:51], v[72:75], a[72:75], v[48:51]
ds_read_b128 v[96:99], v6 offset:38912
s_add_u32 m0, s30, 28672
v_mfma_f32_16x16x32_bf16 v[68:71], v[72:75], a[76:79], v[68:71]
s_waitcnt lgkmcnt(5) vmcnt(24)
s_add_u32 s42, s60, 184320
v_mfma_f32_16x16x32_bf16 v[32:35], v[76:79], a[80:83], v[32:35]
ds_read_b128 v[72:75], v6 offset:39936
buffer_load_dwordx4 v1, s[8:11], s42 offen offset:0 lds
v_mfma_f32_16x16x32_bf16 v[52:55], v[76:79], a[84:87], v[52:55]
s_waitcnt lgkmcnt(5)
buffer_load_dwordx4 v1, s[8:11], s42 offen offset:1024 lds
v_mfma_f32_16x16x32_bf16 v[36:39], v[80:83], a[80:83], v[36:39]
ds_read_b128 v[76:79], v6 offset:40960
buffer_load_dwordx4 v1, s[8:11], s42 offen offset:2048 lds
v_mfma_f32_16x16x32_bf16 v[56:59], v[80:83], a[84:87], v[56:59]
s_waitcnt lgkmcnt(5)
v_mfma_f32_16x16x32_bf16 v[40:43], v[84:87], a[80:83], v[40:43]
ds_read_b128 v[80:83], v6 offset:41984
buffer_load_dwordx4 v1, s[8:11], s42 offen offset:3072 lds
v_mfma_f32_16x16x32_bf16 v[60:63], v[84:87], a[84:87], v[60:63]
s_waitcnt lgkmcnt(5)
v_mfma_f32_16x16x32_bf16 v[44:47], v[88:91], a[80:83], v[44:47]
ds_read_b128 v[84:87], v10 offset:6144
v_mfma_f32_16x16x32_bf16 v[64:67], v[88:91], a[84:87], v[64:67]
s_waitcnt lgkmcnt(5)
v_mfma_f32_16x16x32_bf16 v[48:51], v[92:95], a[80:83], v[48:51]
s_barrier
ds_read_b128 v[88:91], v7 offset:0
s_add_u32 s45, s44, 155648
v_mfma_f32_16x16x32_bf16 v[68:71], v[92:95], a[84:87], v[68:71]
s_waitcnt lgkmcnt(5) vmcnt(26)
buffer_load_dwordx4 a[152:155], v1, s[8:11], s45 offen offset:0 sc1
v_mfma_f32_16x16x32_bf16 v[32:35], v[96:99], a[88:91], v[32:35]
ds_read_b128 v[92:95], v7 offset:1024
s_add_u32 m0, s30, 32768
v_mfma_f32_16x16x32_bf16 v[52:55], v[96:99], a[92:95], v[52:55]
s_waitcnt lgkmcnt(5)
s_add_u32 s42, s60, 188416
v_mfma_f32_16x16x32_bf16 v[36:39], v[72:75], a[88:91], v[36:39]
ds_read_b128 v[96:99], v7 offset:2048
buffer_load_dwordx4 v1, s[8:11], s42 offen offset:0 lds
v_mfma_f32_16x16x32_bf16 v[56:59], v[72:75], a[92:95], v[56:59]
s_waitcnt lgkmcnt(5)
buffer_load_dwordx4 a[156:159], v1, s[8:11], s45 offen offset:1024 sc1
v_mfma_f32_16x16x32_bf16 v[40:43], v[76:79], a[88:91], v[40:43]
ds_read_b128 v[72:75], v7 offset:3072
buffer_load_dwordx4 v1, s[8:11], s42 offen offset:1024 lds
v_mfma_f32_16x16x32_bf16 v[60:63], v[76:79], a[92:95], v[60:63]
s_waitcnt lgkmcnt(5)
v_mfma_f32_16x16x32_bf16 v[44:47], v[80:83], a[88:91], v[44:47]
ds_read_b128 v[76:79], v7 offset:4096
v_mfma_f32_16x16x32_bf16 v[64:67], v[80:83], a[92:95], v[64:67]
s_waitcnt lgkmcnt(5)
v_mfma_f32_16x16x32_bf16 v[48:51], v[84:87], a[88:91], v[48:51]
ds_read_b128 v[80:83], v7 offset:5120
s_add_u32 s45, s44, 163840
v_mfma_f32_16x16x32_bf16 v[68:71], v[84:87], a[92:95], v[68:71]
s_waitcnt lgkmcnt(5) vmcnt(28)
buffer_load_dwordx4 a[160:163], v1, s[8:11], s45 offen offset:0 sc1
v_mfma_f32_16x16x32_bf16 v[32:35], v[88:91], a[96:99], v[32:35]
ds_read_b128 v[84:87], v7 offset:6144
buffer_load_dwordx4 v1, s[8:11], s42 offen offset:2048 lds
v_mfma_f32_16x16x32_bf16 v[52:55], v[88:91], a[100:103], v[52:55]
s_waitcnt lgkmcnt(5)
v_mfma_f32_16x16x32_bf16 v[36:39], v[92:95], a[96:99], v[36:39]
ds_read_b128 v[88:91], v7 offset:7168
buffer_load_dwordx4 a[164:167], v1, s[8:11], s45 offen offset:1024 sc1
v_mfma_f32_16x16x32_bf16 v[56:59], v[92:95], a[100:103], v[56:59]
s_waitcnt lgkmcnt(5)
v_mfma_f32_16x16x32_bf16 v[40:43], v[96:99], a[96:99], v[40:43]
ds_read_b128 v[92:95], v7 offset:8192
s_add_u32 m0, s61, 145408
v_mfma_f32_16x16x32_bf16 v[60:63], v[96:99], a[100:103], v[60:63]
s_waitcnt lgkmcnt(5)
s_add_u32 s42, s62, 184320
v_mfma_f32_16x16x32_bf16 v[44:47], v[72:75], a[96:99], v[44:47]
ds_read_b128 v[96:99], v7 offset:9216
buffer_load_dwordx4 v1, s[8:11], s42 offen lds
v_mfma_f32_16x16x32_bf16 v[64:67], v[72:75], a[100:103], v[64:67]
s_waitcnt lgkmcnt(5)
v_mfma_f32_16x16x32_bf16 v[48:51], v[76:79], a[96:99], v[48:51]
ds_read_b128 v[72:75], v7 offset:10240
s_add_u32 m0, s30, 57344
v_mfma_f32_16x16x32_bf16 v[68:71], v[76:79], a[100:103], v[68:71]
s_waitcnt lgkmcnt(5) vmcnt(30)
s_add_u32 s42, s60, 215040
v_mfma_f32_16x16x32_bf16 v[32:35], v[80:83], a[104:107], v[32:35]
ds_read_b128 v[76:79], v7 offset:11264
buffer_load_dwordx4 v1, s[8:11], s42 offen offset:0 lds
v_mfma_f32_16x16x32_bf16 v[52:55], v[80:83], a[108:111], v[52:55]
s_waitcnt lgkmcnt(5)
buffer_load_dwordx4 v1, s[8:11], s42 offen offset:1024 lds
v_mfma_f32_16x16x32_bf16 v[36:39], v[84:87], a[104:107], v[36:39]
ds_read_b128 v[80:83], v7 offset:12288
buffer_load_dwordx4 v1, s[8:11], s42 offen offset:2048 lds
v_mfma_f32_16x16x32_bf16 v[56:59], v[84:87], a[108:111], v[56:59]
s_waitcnt lgkmcnt(5)
v_mfma_f32_16x16x32_bf16 v[40:43], v[88:91], a[104:107], v[40:43]
ds_read_b128 v[84:87], v7 offset:13312
buffer_load_dwordx4 v1, s[8:11], s42 offen offset:3072 lds
v_mfma_f32_16x16x32_bf16 v[60:63], v[88:91], a[108:111], v[60:63]
s_waitcnt lgkmcnt(5)
v_mfma_f32_16x16x32_bf16 v[44:47], v[92:95], a[104:107], v[44:47]
ds_read_b128 v[88:91], v10 offset:8192
v_mfma_f32_16x16x32_bf16 v[64:67], v[92:95], a[108:111], v[64:67]
s_waitcnt lgkmcnt(5)
v_mfma_f32_16x16x32_bf16 v[48:51], v[96:99], a[104:107], v[48:51]
s_waitcnt vmcnt(16)
s_barrier
ds_read_b128 v[92:95], v5 offset:0
s_add_u32 s45, s44, 172032
v_mfma_f32_16x16x32_bf16 v[68:71], v[96:99], a[108:111], v[68:71]
s_waitcnt lgkmcnt(5)
buffer_load_dwordx4 a[168:171], v1, s[8:11], s45 offen offset:0 sc1
v_mfma_f32_16x16x32_bf16 v[32:35], v[72:75], a[112:115], v[32:35]
ds_read_b128 v[96:99], v5 offset:1024
s_add_u32 m0, s30, 61440
v_mfma_f32_16x16x32_bf16 v[52:55], v[72:75], a[116:119], v[52:55]
s_waitcnt lgkmcnt(5)
s_add_u32 s42, s60, 219136
v_mfma_f32_16x16x32_bf16 v[36:39], v[76:79], a[112:115], v[36:39]
ds_read_b128 v[72:75], v5 offset:2048
buffer_load_dwordx4 v1, s[8:11], s42 offen offset:0 lds
v_mfma_f32_16x16x32_bf16 v[56:59], v[76:79], a[116:119], v[56:59]
s_waitcnt lgkmcnt(5)
buffer_load_dwordx4 a[172:175], v1, s[8:11], s45 offen offset:1024 sc1
v_mfma_f32_16x16x32_bf16 v[40:43], v[80:83], a[112:115], v[40:43]
ds_read_b128 v[76:79], v5 offset:3072
buffer_load_dwordx4 v1, s[8:11], s42 offen offset:1024 lds
v_mfma_f32_16x16x32_bf16 v[60:63], v[80:83], a[116:119], v[60:63]
s_waitcnt lgkmcnt(5)
v_mfma_f32_16x16x32_bf16 v[44:47], v[84:87], a[112:115], v[44:47]
ds_read_b128 v[80:83], v5 offset:4096
v_mfma_f32_16x16x32_bf16 v[64:67], v[84:87], a[116:119], v[64:67]
s_waitcnt lgkmcnt(5)
v_mfma_f32_16x16x32_bf16 v[48:51], v[88:91], a[112:115], v[48:51]
ds_read_b128 v[84:87], v5 offset:5120
s_add_u32 s45, s44, 180224
v_mfma_f32_16x16x32_bf16 v[68:71], v[88:91], a[116:119], v[68:71]
s_waitcnt lgkmcnt(5)
buffer_load_dwordx4 a[176:179], v1, s[8:11], s45 offen offset:0 sc1
v_mfma_f32_16x16x32_bf16 v[32:35], v[92:95], a[120:123], v[32:35]
ds_read_b128 v[88:91], v5 offset:6144
buffer_load_dwordx4 v1, s[8:11], s42 offen offset:2048 lds
v_mfma_f32_16x16x32_bf16 v[52:55], v[92:95], a[124:127], v[52:55]
s_waitcnt lgkmcnt(5)
v_mfma_f32_16x16x32_bf16 v[36:39], v[96:99], a[120:123], v[36:39]
ds_read_b128 v[92:95], v5 offset:7168
buffer_load_dwordx4 a[180:183], v1, s[8:11], s45 offen offset:1024 sc1
v_mfma_f32_16x16x32_bf16 v[56:59], v[96:99], a[124:127], v[56:59]
s_waitcnt lgkmcnt(5)
v_mfma_f32_16x16x32_bf16 v[40:43], v[72:75], a[120:123], v[40:43]
ds_read_b128 v[96:99], v5 offset:8192
s_add_u32 m0, s61, 147456
v_mfma_f32_16x16x32_bf16 v[60:63], v[72:75], a[124:127], v[60:63]
s_waitcnt lgkmcnt(5)
s_add_u32 s42, s62, 215040
v_mfma_f32_16x16x32_bf16 v[44:47], v[76:79], a[120:123], v[44:47]
ds_read_b128 v[72:75], v5 offset:9216
buffer_load_dwordx4 v1, s[8:11], s42 offen lds
v_mfma_f32_16x16x32_bf16 v[64:67], v[76:79], a[124:127], v[64:67]
s_waitcnt lgkmcnt(5)
v_mfma_f32_16x16x32_bf16 v[48:51], v[80:83], a[120:123], v[48:51]
ds_read_b128 v[76:79], v5 offset:10240
s_add_u32 m0, s30, 86016
v_mfma_f32_16x16x32_bf16 v[68:71], v[80:83], a[124:127], v[68:71]
s_waitcnt lgkmcnt(5)
s_add_u32 s42, s60, 245760
v_mfma_f32_16x16x32_bf16 v[32:35], v[84:87], a[128:131], v[32:35]
ds_read_b128 v[80:83], v5 offset:11264
buffer_load_dwordx4 v1, s[8:11], s42 offen offset:0 lds
v_mfma_f32_16x16x32_bf16 v[52:55], v[84:87], a[132:135], v[52:55]
s_waitcnt lgkmcnt(5)
buffer_load_dwordx4 v1, s[8:11], s42 offen offset:1024 lds
v_mfma_f32_16x16x32_bf16 v[36:39], v[88:91], a[128:131], v[36:39]
ds_read_b128 v[84:87], v5 offset:12288
buffer_load_dwordx4 v1, s[8:11], s42 offen offset:2048 lds
v_mfma_f32_16x16x32_bf16 v[56:59], v[88:91], a[132:135], v[56:59]
s_waitcnt lgkmcnt(5)
v_mfma_f32_16x16x32_bf16 v[40:43], v[92:95], a[128:131], v[40:43]
ds_read_b128 v[88:91], v5 offset:13312
buffer_load_dwordx4 v1, s[8:11], s42 offen offset:3072 lds
v_mfma_f32_16x16x32_bf16 v[60:63], v[92:95], a[132:135], v[60:63]
s_waitcnt lgkmcnt(5)
v_mfma_f32_16x16x32_bf16 v[44:47], v[96:99], a[128:131], v[44:47]
ds_read_b128 v[92:95], v10 offset:0
v_mfma_f32_16x16x32_bf16 v[64:67], v[96:99], a[132:135], v[64:67]
s_waitcnt lgkmcnt(5)
v_mfma_f32_16x16x32_bf16 v[48:51], v[72:75], a[128:131], v[48:51]
s_waitcnt vmcnt(16)
s_barrier
ds_read_b128 v[96:99], v5 offset:28672
s_add_u32 s45, s44, 188416
v_mfma_f32_16x16x32_bf16 v[68:71], v[72:75], a[132:135], v[68:71]
s_waitcnt lgkmcnt(5)
buffer_load_dwordx4 a[184:187], v1, s[8:11], s45 offen offset:0 sc1
v_mfma_f32_16x16x32_bf16 v[32:35], v[76:79], a[136:139], v[32:35]
ds_read_b128 v[72:75], v5 offset:29696
s_add_u32 m0, s30, 90112
v_mfma_f32_16x16x32_bf16 v[52:55], v[76:79], a[140:143], v[52:55]
s_waitcnt lgkmcnt(5)
s_add_u32 s42, s60, 249856
v_mfma_f32_16x16x32_bf16 v[36:39], v[80:83], a[136:139], v[36:39]
ds_read_b128 v[76:79], v5 offset:30720
buffer_load_dwordx4 v1, s[8:11], s42 offen offset:0 lds
v_mfma_f32_16x16x32_bf16 v[56:59], v[80:83], a[140:143], v[56:59]
s_waitcnt lgkmcnt(5)
v_mfma_f32_16x16x32_bf16 v[40:43], v[84:87], a[136:139], v[40:43]
ds_read_b128 v[80:83], v5 offset:31744
buffer_load_dwordx4 a[188:191], v1, s[8:11], s45 offen offset:1024 sc1
v_mfma_f32_16x16x32_bf16 v[60:63], v[84:87], a[140:143], v[60:63]
s_waitcnt lgkmcnt(5)
v_mfma_f32_16x16x32_bf16 v[44:47], v[88:91], a[136:139], v[44:47]
ds_read_b128 v[84:87], v5 offset:32768
v_mfma_f32_16x16x32_bf16 v[64:67], v[88:91], a[140:143], v[64:67]
s_waitcnt lgkmcnt(5)
v_mfma_f32_16x16x32_bf16 v[48:51], v[92:95], a[136:139], v[48:51]
ds_read_b128 v[88:91], v5 offset:33792
buffer_load_dwordx4 v1, s[8:11], s42 offen offset:1024 lds
v_mfma_f32_16x16x32_bf16 v[68:71], v[92:95], a[140:143], v[68:71]
s_waitcnt lgkmcnt(5)
v_mfma_f32_16x16x32_bf16 v[32:35], v[96:99], a[144:147], v[32:35]
ds_read_b128 v[92:95], v5 offset:34816
v_mfma_f32_16x16x32_bf16 v[52:55], v[96:99], a[148:151], v[52:55]
s_waitcnt lgkmcnt(5)
v_mfma_f32_16x16x32_bf16 v[36:39], v[72:75], a[144:147], v[36:39]
ds_read_b128 v[96:99], v5 offset:35840
s_add_u32 s45, s44, 196608
v_mfma_f32_16x16x32_bf16 v[56:59], v[72:75], a[148:151], v[56:59]
s_waitcnt lgkmcnt(5)
buffer_load_dwordx4 a[192:195], v1, s[8:11], s45 offen offset:0 sc1
v_mfma_f32_16x16x32_bf16 v[40:43], v[76:79], a[144:147], v[40:43]
ds_read_b128 v[72:75], v5 offset:36864
v_mfma_f32_16x16x32_bf16 v[60:63], v[76:79], a[148:151], v[60:63]
s_waitcnt lgkmcnt(5)
v_mfma_f32_16x16x32_bf16 v[44:47], v[80:83], a[144:147], v[44:47]
ds_read_b128 v[76:79], v5 offset:37888
buffer_load_dwordx4 v1, s[8:11], s42 offen offset:2048 lds
v_mfma_f32_16x16x32_bf16 v[64:67], v[80:83], a[148:151], v[64:67]
s_waitcnt lgkmcnt(5)
v_mfma_f32_16x16x32_bf16 v[48:51], v[84:87], a[144:147], v[48:51]
ds_read_b128 v[80:83], v5 offset:38912
v_mfma_f32_16x16x32_bf16 v[68:71], v[84:87], a[148:151], v[68:71]
s_waitcnt lgkmcnt(5)
v_mfma_f32_16x16x32_bf16 v[32:35], v[88:91], a[152:155], v[32:35]
ds_read_b128 v[84:87], v5 offset:39936
buffer_load_dwordx4 a[196:199], v1, s[8:11], s45 offen offset:1024 sc1
v_mfma_f32_16x16x32_bf16 v[52:55], v[88:91], a[156:159], v[52:55]
s_waitcnt lgkmcnt(5)
v_mfma_f32_16x16x32_bf16 v[36:39], v[92:95], a[152:155], v[36:39]
ds_read_b128 v[88:91], v5 offset:40960
v_mfma_f32_16x16x32_bf16 v[56:59], v[92:95], a[156:159], v[56:59]
s_waitcnt lgkmcnt(5)
v_mfma_f32_16x16x32_bf16 v[40:43], v[96:99], a[152:155], v[40:43]
ds_read_b128 v[92:95], v5 offset:41984
s_add_u32 m0, s61, 149504
v_mfma_f32_16x16x32_bf16 v[60:63], v[96:99], a[156:159], v[60:63]
s_waitcnt lgkmcnt(5)
s_add_u32 s42, s62, 245760
v_mfma_f32_16x16x32_bf16 v[44:47], v[72:75], a[152:155], v[44:47]
ds_read_b128 v[96:99], v10 offset:2048
buffer_load_dwordx4 v1, s[8:11], s42 offen lds
v_mfma_f32_16x16x32_bf16 v[64:67], v[72:75], a[156:159], v[64:67]
s_waitcnt lgkmcnt(5)
v_mfma_f32_16x16x32_bf16 v[48:51], v[76:79], a[152:155], v[48:51]
s_waitcnt vmcnt(12)
s_barrier
ds_read_b128 v[72:75], v6 offset:0
s_add_u32 s45, s44, 204800
v_mfma_f32_16x16x32_bf16 v[68:71], v[76:79], a[156:159], v[68:71]
s_waitcnt lgkmcnt(5)
buffer_load_dwordx4 a[200:203], v1, s[8:11], s45 offen offset:0 sc1
v_mfma_f32_16x16x32_bf16 v[32:35], v[80:83], a[160:163], v[32:35]
ds_read_b128 v[76:79], v6 offset:1024
v_mfma_f32_16x16x32_bf16 v[52:55], v[80:83], a[164:167], v[52:55]
s_waitcnt lgkmcnt(5)
v_mfma_f32_16x16x32_bf16 v[36:39], v[84:87], a[160:163], v[36:39]
ds_read_b128 v[80:83], v6 offset:2048
v_mfma_f32_16x16x32_bf16 v[56:59], v[84:87], a[164:167], v[56:59]
s_waitcnt lgkmcnt(5)
v_mfma_f32_16x16x32_bf16 v[40:43], v[88:91], a[160:163], v[40:43]
ds_read_b128 v[84:87], v6 offset:3072
buffer_load_dwordx4 a[204:207], v1, s[8:11], s45 offen offset:1024 sc1
v_mfma_f32_16x16x32_bf16 v[60:63], v[88:91], a[164:167], v[60:63]
s_waitcnt lgkmcnt(5)
v_mfma_f32_16x16x32_bf16 v[44:47], v[92:95], a[160:163], v[44:47]
ds_read_b128 v[88:91], v6 offset:4096
v_mfma_f32_16x16x32_bf16 v[64:67], v[92:95], a[164:167], v[64:67]
s_waitcnt lgkmcnt(5)
v_mfma_f32_16x16x32_bf16 v[48:51], v[96:99], a[160:163], v[48:51]
ds_read_b128 v[92:95], v6 offset:5120
v_mfma_f32_16x16x32_bf16 v[68:71], v[96:99], a[164:167], v[68:71]
s_waitcnt lgkmcnt(5)
v_mfma_f32_16x16x32_bf16 v[32:35], v[72:75], a[168:171], v[32:35]
ds_read_b128 v[96:99], v6 offset:6144
v_mfma_f32_16x16x32_bf16 v[52:55], v[72:75], a[172:175], v[52:55]
s_waitcnt lgkmcnt(5)
v_mfma_f32_16x16x32_bf16 v[36:39], v[76:79], a[168:171], v[36:39]
ds_read_b128 v[72:75], v6 offset:7168
s_add_u32 s45, s44, 212992
v_mfma_f32_16x16x32_bf16 v[56:59], v[76:79], a[172:175], v[56:59]
s_waitcnt lgkmcnt(5)
buffer_load_dwordx4 a[208:211], v1, s[8:11], s45 offen offset:0 sc1
v_mfma_f32_16x16x32_bf16 v[40:43], v[80:83], a[168:171], v[40:43]
ds_read_b128 v[76:79], v6 offset:8192
v_mfma_f32_16x16x32_bf16 v[60:63], v[80:83], a[172:175], v[60:63]
s_waitcnt lgkmcnt(5)
v_mfma_f32_16x16x32_bf16 v[44:47], v[84:87], a[168:171], v[44:47]
ds_read_b128 v[80:83], v6 offset:9216
v_mfma_f32_16x16x32_bf16 v[64:67], v[84:87], a[172:175], v[64:67]
s_waitcnt lgkmcnt(5)
v_mfma_f32_16x16x32_bf16 v[48:51], v[88:91], a[168:171], v[48:51]
ds_read_b128 v[84:87], v6 offset:10240
v_mfma_f32_16x16x32_bf16 v[68:71], v[88:91], a[172:175], v[68:71]
s_waitcnt lgkmcnt(5)
v_mfma_f32_16x16x32_bf16 v[32:35], v[92:95], a[176:179], v[32:35]
ds_read_b128 v[88:91], v6 offset:11264
buffer_load_dwordx4 a[212:215], v1, s[8:11], s45 offen offset:1024 sc1
v_mfma_f32_16x16x32_bf16 v[52:55], v[92:95], a[180:183], v[52:55]
s_waitcnt lgkmcnt(5)
v_mfma_f32_16x16x32_bf16 v[36:39], v[96:99], a[176:179], v[36:39]
ds_read_b128 v[92:95], v6 offset:12288
v_mfma_f32_16x16x32_bf16 v[56:59], v[96:99], a[180:183], v[56:59]
s_waitcnt lgkmcnt(5)
v_mfma_f32_16x16x32_bf16 v[40:43], v[72:75], a[176:179], v[40:43]
ds_read_b128 v[96:99], v6 offset:13312
v_mfma_f32_16x16x32_bf16 v[60:63], v[72:75], a[180:183], v[60:63]
s_waitcnt lgkmcnt(5)
v_mfma_f32_16x16x32_bf16 v[44:47], v[76:79], a[176:179], v[44:47]
ds_read_b128 v[72:75], v10 offset:4096
v_mfma_f32_16x16x32_bf16 v[64:67], v[76:79], a[180:183], v[64:67]
s_waitcnt lgkmcnt(5)
v_mfma_f32_16x16x32_bf16 v[48:51], v[80:83], a[176:179], v[48:51]
s_waitcnt vmcnt(4)
s_barrier
ds_read_b128 v[76:79], v6 offset:28672
v_mfma_f32_16x16x32_bf16 v[68:71], v[80:83], a[180:183], v[68:71]
s_waitcnt lgkmcnt(5)
v_mfma_f32_16x16x32_bf16 v[32:35], v[84:87], a[184:187], v[32:35]
ds_read_b128 v[80:83], v6 offset:29696
v_mfma_f32_16x16x32_bf16 v[52:55], v[84:87], a[188:191], v[52:55]
s_waitcnt lgkmcnt(5)
v_mfma_f32_16x16x32_bf16 v[36:39], v[88:91], a[184:187], v[36:39]
ds_read_b128 v[84:87], v6 offset:30720
v_mfma_f32_16x16x32_bf16 v[56:59], v[88:91], a[188:191], v[56:59]
s_waitcnt lgkmcnt(5)
v_mfma_f32_16x16x32_bf16 v[40:43], v[92:95], a[184:187], v[40:43]
ds_read_b128 v[88:91], v6 offset:31744
v_mfma_f32_16x16x32_bf16 v[60:63], v[92:95], a[188:191], v[60:63]
s_waitcnt lgkmcnt(5)
v_mfma_f32_16x16x32_bf16 v[44:47], v[96:99], a[184:187], v[44:47]
ds_read_b128 v[92:95], v6 offset:32768
v_mfma_f32_16x16x32_bf16 v[64:67], v[96:99], a[188:191], v[64:67]
s_waitcnt lgkmcnt(5)
v_mfma_f32_16x16x32_bf16 v[48:51], v[72:75], a[184:187], v[48:51]
ds_read_b128 v[96:99], v6 offset:33792
v_mfma_f32_16x16x32_bf16 v[68:71], v[72:75], a[188:191], v[68:71]
s_waitcnt lgkmcnt(5)
v_mfma_f32_16x16x32_bf16 v[32:35], v[76:79], a[192:195], v[32:35]
ds_read_b128 v[72:75], v6 offset:34816
v_mfma_f32_16x16x32_bf16 v[52:55], v[76:79], a[196:199], v[52:55]
s_waitcnt lgkmcnt(5)
v_mfma_f32_16x16x32_bf16 v[36:39], v[80:83], a[192:195], v[36:39]
ds_read_b128 v[76:79], v6 offset:35840
v_mfma_f32_16x16x32_bf16 v[56:59], v[80:83], a[196:199], v[56:59]
s_waitcnt lgkmcnt(5)
v_mfma_f32_16x16x32_bf16 v[40:43], v[84:87], a[192:195], v[40:43]
ds_read_b128 v[80:83], v6 offset:36864
v_mfma_f32_16x16x32_bf16 v[60:63], v[84:87], a[196:199], v[60:63]
s_waitcnt lgkmcnt(5)
v_mfma_f32_16x16x32_bf16 v[44:47], v[88:91], a[192:195], v[44:47]
ds_read_b128 v[84:87], v6 offset:37888
v_mfma_f32_16x16x32_bf16 v[64:67], v[88:91], a[196:199], v[64:67]
s_waitcnt lgkmcnt(5)
v_mfma_f32_16x16x32_bf16 v[48:51], v[92:95], a[192:195], v[48:51]
ds_read_b128 v[88:91], v6 offset:38912
v_mfma_f32_16x16x32_bf16 v[68:71], v[92:95], a[196:199], v[68:71]
s_waitcnt lgkmcnt(5) vmcnt(2)
v_mfma_f32_16x16x32_bf16 v[32:35], v[96:99], a[200:203], v[32:35]
ds_read_b128 v[92:95], v6 offset:39936
v_mfma_f32_16x16x32_bf16 v[52:55], v[96:99], a[204:207], v[52:55]
s_waitcnt lgkmcnt(5)
v_mfma_f32_16x16x32_bf16 v[36:39], v[72:75], a[200:203], v[36:39]
ds_read_b128 v[96:99], v6 offset:40960
v_mfma_f32_16x16x32_bf16 v[56:59], v[72:75], a[204:207], v[56:59]
s_waitcnt lgkmcnt(5)
v_mfma_f32_16x16x32_bf16 v[40:43], v[76:79], a[200:203], v[40:43]
ds_read_b128 v[72:75], v6 offset:41984
v_mfma_f32_16x16x32_bf16 v[60:63], v[76:79], a[204:207], v[60:63]
s_waitcnt lgkmcnt(5)
v_mfma_f32_16x16x32_bf16 v[44:47], v[80:83], a[200:203], v[44:47]
ds_read_b128 v[76:79], v10 offset:6144
v_mfma_f32_16x16x32_bf16 v[64:67], v[80:83], a[204:207], v[64:67]
s_waitcnt lgkmcnt(5)
v_mfma_f32_16x16x32_bf16 v[48:51], v[84:87], a[200:203], v[48:51]
v_mfma_f32_16x16x32_bf16 v[68:71], v[84:87], a[204:207], v[68:71]
s_waitcnt lgkmcnt(4) vmcnt(0)
v_mfma_f32_16x16x32_bf16 v[32:35], v[88:91], a[208:211], v[32:35]
v_mfma_f32_16x16x32_bf16 v[52:55], v[88:91], a[212:215], v[52:55]
s_waitcnt lgkmcnt(3)
v_mfma_f32_16x16x32_bf16 v[36:39], v[92:95], a[208:211], v[36:39]
v_mfma_f32_16x16x32_bf16 v[56:59], v[92:95], a[212:215], v[56:59]
s_waitcnt lgkmcnt(2)
v_mfma_f32_16x16x32_bf16 v[40:43], v[96:99], a[208:211], v[40:43]
v_mfma_f32_16x16x32_bf16 v[60:63], v[96:99], a[212:215], v[60:63]
s_waitcnt lgkmcnt(1)
v_mfma_f32_16x16x32_bf16 v[44:47], v[72:75], a[208:211], v[44:47]
v_mfma_f32_16x16x32_bf16 v[64:67], v[72:75], a[212:215], v[64:67]
s_waitcnt lgkmcnt(0)
v_mfma_f32_16x16x32_bf16 v[48:51], v[76:79], a[208:211], v[48:51]
v_mfma_f32_16x16x32_bf16 v[68:71], v[76:79], a[212:215], v[68:71]
s_mul_i32 s48, s16, 5120
s_add_u32 s48, s48, 0
v_add_u32 v5, s48, v1
s_xor_b32 s49, s16, 2
s_mul_i32 s49, s49, 5120
s_add_u32 s49, s49, 0
v_add_u32_e64 v6, s49, v1
v_accvgpr_read_b32 v100, a246
v_accvgpr_read_b32 v101, a247
v_accvgpr_read_b32 v102, a248
v_accvgpr_read_b32 v103, a249
v_accvgpr_read_b32 v104, a250
v_accvgpr_read_b32 v105, a251
v_accvgpr_read_b32 v106, a252
v_accvgpr_read_b32 v107, a253
v_accvgpr_read_b32 v108, a254
v_accvgpr_read_b32 v109, a255
s_barrier
s_cmp_lg_u32 s96, 0
s_cbranch_scc1 L_kh1_70
ds_write_b128 v5, v[52:55] offset:0
ds_write_b128 v5, v[56:59] offset:1024
ds_write_b128 v5, v[60:63] offset:2048
ds_write_b128 v5, v[64:67] offset:3072
ds_write_b128 v5, v[68:71] offset:4096
s_waitcnt lgkmcnt(0)
s_barrier
ds_read_b128 v[112:115], v6 offset:0
ds_read_b128 v[116:119], v6 offset:1024
ds_read_b128 v[120:123], v6 offset:2048
ds_read_b128 v[124:127], v6 offset:3072
ds_read_b128 v[128:131], v6 offset:4096
s_waitcnt lgkmcnt(0)
v_pk_add_f32 v[72:73], v[32:33], v[112:113]
v_pk_add_f32 v[74:75], v[34:35], v[114:115]
v_pk_add_f32 v[76:77], v[36:37], v[116:117]
v_pk_add_f32 v[78:79], v[38:39], v[118:119]
v_pk_add_f32 v[80:81], v[40:41], v[120:121]
v_pk_add_f32 v[82:83], v[42:43], v[122:123]
v_pk_add_f32 v[84:85], v[44:45], v[124:125]
v_pk_add_f32 v[86:87], v[46:47], v[126:127]
v_pk_add_f32 v[88:89], v[48:49], v[128:129]
v_pk_add_f32 v[90:91], v[50:51], v[130:131]
s_branch L_khd_71
L_kh1_70:
ds_write_b128 v5, v[32:35] offset:0
ds_write_b128 v5, v[36:39] offset:1024
ds_write_b128 v5, v[40:43] offset:2048
ds_write_b128 v5, v[44:47] offset:3072
ds_write_b128 v5, v[48:51] offset:4096
s_waitcnt lgkmcnt(0)
s_barrier
ds_read_b128 v[112:115], v6 offset:0
ds_read_b128 v[116:119], v6 offset:1024
ds_read_b128 v[120:123], v6 offset:2048
ds_read_b128 v[124:127], v6 offset:3072
ds_read_b128 v[128:131], v6 offset:4096
s_waitcnt lgkmcnt(0)
v_pk_add_f32 v[72:73], v[52:53], v[112:113]
v_pk_add_f32 v[74:75], v[54:55], v[114:115]
v_pk_add_f32 v[76:77], v[56:57], v[116:117]
v_pk_add_f32 v[78:79], v[58:59], v[118:119]
v_pk_add_f32 v[80:81], v[60:61], v[120:121]
v_pk_add_f32 v[82:83], v[62:63], v[122:123]
v_pk_add_f32 v[84:85], v[64:65], v[124:125]
v_pk_add_f32 v[86:87], v[66:67], v[126:127]
v_pk_add_f32 v[88:89], v[68:69], v[128:129]
v_pk_add_f32 v[90:91], v[70:71], v[130:131]
L_khd_71:
s_mov_b32 s53, 0x00003f80
s_mov_b32 s54, 0x3f800000
s_nop 0
v_dot2_f32_bf16 v72, v100, s53, v72
v_dot2_f32_bf16 v73, v100, s54, v73
v_dot2_f32_bf16 v74, v101, s53, v74
v_dot2_f32_bf16 v75, v101, s54, v75
v_dot2_f32_bf16 v76, v102, s53, v76
v_dot2_f32_bf16 v77, v102, s54, v77
v_dot2_f32_bf16 v78, v103, s53, v78
v_dot2_f32_bf16 v79, v103, s54, v79
v_dot2_f32_bf16 v80, v104, s53, v80
v_dot2_f32_bf16 v81, v104, s54, v81
v_dot2_f32_bf16 v82, v105, s53, v82
v_dot2_f32_bf16 v83, v105, s54, v83
v_dot2_f32_bf16 v84, v106, s53, v84
v_dot2_f32_bf16 v85, v106, s54, v85
v_dot2_f32_bf16 v86, v107, s53, v86
v_dot2_f32_bf16 v87, v107, s54, v87
v_dot2_f32_bf16 v88, v108, s53, v88
v_dot2_f32_bf16 v89, v108, s54, v89
v_dot2_f32_bf16 v90, v109, s53, v90
v_dot2_f32_bf16 v91, v109, s54, v91
s_nop 2
s_nop 0
v_cvt_pk_bf16_f32 v132, v72, v73
v_cvt_pk_bf16_f32 v133, v74, v75
v_cvt_pk_bf16_f32 v134, v76, v77
v_cvt_pk_bf16_f32 v135, v78, v79
v_cvt_pk_bf16_f32 v136, v80, v81
v_cvt_pk_bf16_f32 v137, v82, v83
v_cvt_pk_bf16_f32 v138, v84, v85
v_cvt_pk_bf16_f32 v139, v86, v87
v_cvt_pk_bf16_f32 v140, v88, v89
v_cvt_pk_bf16_f32 v141, v90, v91
buffer_store_dwordx2 v[132:133], v237, s[8:11], s29 offen
buffer_store_dwordx2 v[134:135], v238, s[8:11], s29 offen
buffer_store_dwordx2 v[136:137], v239, s[8:11], s29 offen
buffer_store_dwordx2 v[138:139], v240, s[8:11], s29 offen
buffer_store_dwordx2 v[140:141], v241, s[8:11], s29 offen
v_mov_b32 v8, 0x3f803f80
v_dot2_f32_bf16 v10, v132, v8, 0
v_dot2_f32_bf16 v11, v132, v132, 0
v_dot2_f32_bf16 v10, v133, v8, v10
v_dot2_f32_bf16 v11, v133, v133, v11
v_dot2_f32_bf16 v10, v134, v8, v10
v_dot2_f32_bf16 v11, v134, v134, v11
v_dot2_f32_bf16 v10, v135, v8, v10
v_dot2_f32_bf16 v11, v135, v135, v11
v_dot2_f32_bf16 v10, v136, v8, v10
v_dot2_f32_bf16 v11, v136, v136, v11
v_dot2_f32_bf16 v10, v137, v8, v10
v_dot2_f32_bf16 v11, v137, v137, v11
v_dot2_f32_bf16 v10, v138, v8, v10
v_dot2_f32_bf16 v11, v138, v138, v11
v_dot2_f32_bf16 v10, v139, v8, v10
v_dot2_f32_bf16 v11, v139, v139, v11
v_dot2_f32_bf16 v10, v140, v8, v10
v_dot2_f32_bf16 v11, v140, v140, v11
v_dot2_f32_bf16 v10, v141, v8, v10
v_dot2_f32_bf16 v11, v141, v141, v11
s_nop 2
v_mov_b32 v12, v10
v_mov_b32 v13, v11
s_nop 1
v_permlane16_swap_b32 v10, v12
v_permlane16_swap_b32 v11, v13
s_nop 1
v_add_f32 v10, v10, v12
v_add_f32 v11, v11, v13
v_mov_b32 v12, v10
v_mov_b32 v13, v11
s_nop 1
v_permlane32_swap_b32 v10, v12
v_permlane32_swap_b32 v11, v13
s_nop 1
v_add_f32 v10, v10, v12
v_add_f32 v11, v11, v13
s_mov_b64 s[38:39], exec
s_mov_b64 exec, 0xffff
buffer_store_dwordx2 v[10:11], v251, s[8:11], s21 offen
s_mov_b64 exec, s[38:39]
s_nop 0
v_accvgpr_write_b32 a246, v132
v_accvgpr_write_b32 a247, v133
v_accvgpr_write_b32 a248, v134
v_accvgpr_write_b32 a249, v135
v_accvgpr_write_b32 a250, v136
v_accvgpr_write_b32 a251, v137
v_accvgpr_write_b32 a252, v138
v_accvgpr_write_b32 a253, v139
v_accvgpr_write_b32 a254, v140
v_accvgpr_write_b32 a255, v141
s_cmp_lg_u32 s100, 7
s_cbranch_scc1 L_nohalo_72
s_mul_i32 s53, s17, 20480
s_add_u32 s53, s53, 23048192
s_add_u32 s50, s101, 0
s_lshr_b32 s51, s50, 1
s_lshl_b32 s51, s51, 10
s_and_b32 s50, s50, 1
s_lshl_b32 s50, s50, 3
s_add_u32 s51, s51, s50
s_add_u32 s51, s51, s53
buffer_store_dwordx2 v[132:133], v1, s[8:11], s51 offen sc1
s_add_u32 s50, s101, 1
s_lshr_b32 s51, s50, 1
s_lshl_b32 s51, s51, 10
s_and_b32 s50, s50, 1
s_lshl_b32 s50, s50, 3
s_add_u32 s51, s51, s50
s_add_u32 s51, s51, s53
buffer_store_dwordx2 v[134:135], v1, s[8:11], s51 offen sc1
s_add_u32 s50, s101, 2
s_lshr_b32 s51, s50, 1
s_lshl_b32 s51, s51, 10
s_and_b32 s50, s50, 1
s_lshl_b32 s50, s50, 3
s_add_u32 s51, s51, s50
s_add_u32 s51, s51, s53
buffer_store_dwordx2 v[136:137], v1, s[8:11], s51 offen sc1
s_add_u32 s50, s101, 3
s_lshr_b32 s51, s50, 1
s_lshl_b32 s51, s51, 10
s_and_b32 s50, s50, 1
s_lshl_b32 s50, s50, 3
s_add_u32 s51, s51, s50
s_add_u32 s51, s51, s53
buffer_store_dwordx2 v[138:139], v1, s[8:11], s51 offen sc1
s_add_u32 s50, s101, 4
s_lshr_b32 s51, s50, 1
s_lshl_b32 s51, s51, 10
s_and_b32 s50, s50, 1
s_lshl_b32 s50, s50, 3
s_add_u32 s51, s51, s50
s_add_u32 s51, s51, s53
buffer_store_dwordx2 v[140:141], v1, s[8:11], s51 offen sc1
s_lshl_b32 s53, s17, 10
s_add_u32 s53, s53, 23385088
s_mov_b64 exec, 0xffff
buffer_store_dwordx2 v[10:11], v251, s[8:11], s53 offen sc1
s_mov_b64 exec, s[38:39]
L_nohalo_72:
s_add_u32 s37, s23, 0
buffer_load_dwordx4 a[0:3], v1, s[8:11], s37 offen offset:0
s_add_u32 s37, s23, 0
s_nop 0
buffer_load_dwordx4 a[4:7], v1, s[8:11], s37 offen offset:1024
s_add_u32 s37, s23, 2048
buffer_load_dwordx4 a[8:11], v1, s[8:11], s37 offen offset:0
s_add_u32 s37, s23, 2048
buffer_load_dwordx4 a[12:15], v1, s[8:11], s37 offen offset:1024
s_add_u32 s37, s23, 4096
buffer_load_dwordx4 a[16:19], v1, s[8:11], s37 offen offset:0
s_add_u32 s37, s23, 4096
buffer_load_dwordx4 a[20:23], v1, s[8:11], s37 offen offset:1024
s_add_u32 s37, s23, 6144
buffer_load_dwordx4 a[24:27], v1, s[8:11], s37 offen offset:0
s_add_u32 s37, s23, 6144
buffer_load_dwordx4 a[28:31], v1, s[8:11], s37 offen offset:1024
s_add_u32 s37, s23, 8192
buffer_load_dwordx4 a[32:35], v1, s[8:11], s37 offen offset:0
s_add_u32 s37, s23, 8192
buffer_load_dwordx4 a[36:39], v1, s[8:11], s37 offen offset:1024
s_add_u32 s37, s23, 10240
buffer_load_dwordx4 a[40:43], v1, s[8:11], s37 offen offset:0
s_add_u32 s37, s23, 10240
buffer_load_dwordx4 a[44:47], v1, s[8:11], s37 offen offset:1024
s_add_u32 s37, s23, 12288
buffer_load_dwordx4 a[48:51], v1, s[8:11], s37 offen offset:0
s_add_u32 s37, s23, 12288
buffer_load_dwordx4 a[52:55], v1, s[8:11], s37 offen offset:1024
s_add_u32 s37, s23, 14336
buffer_load_dwordx4 a[56:59], v1, s[8:11], s37 offen offset:0
s_add_u32 s37, s23, 14336
buffer_load_dwordx4 a[60:63], v1, s[8:11], s37 offen offset:1024
s_add_u32 s56, s56, 1
v_mov_b32 v8, s56
v_mov_b32 v9, s57
s_mov_b64 s[38:39], exec
s_waitcnt vmcnt(16)
s_mov_b64 exec, 1
buffer_store_dword v8, v9, s[8:11], 0 offen
s_mov_b64 exec, s[38:39]
s_cmp_lg_u32 s16, 0
s_cbranch_scc1 L_tb_73
v_lshlrev_b32 v10, 2, v2
v_add_u32 v10, s58, v10
s_mov_b32 s40, 0
L_poll_74:
buffer_load_dword v11, v10, s[8:11], 0 offen sc1
s_add_u32 s40, s40, 1
s_cmp_gt_u32 s40, 40000
s_cbranch_scc1 L_polld_75
s_waitcnt vmcnt(0)
v_subrev_u32 v11, s56, v11
v_cmp_lt_u32 vcc, 1, v11
s_cbranch_vccnz L_poll_74
L_polld_75:
L_tb_73:
s_barrier
s_cmp_lg_u32 s100, 7
s_cbranch_scc1 L_nohf_76
s_waitcnt vmcnt(17)
s_lshl_b32 s53, s17, 7
s_lshl_b32 s51, s98, 2
s_add_u32 s53, s53, s51
s_add_u32 s53, s53, 23412736
v_mov_b32 v13, s59
v_mov_b32 v14, 0
s_mov_b64 s[38:39], exec
s_mov_b64 exec, 1
buffer_store_dword v13, v14, s[8:11], s53 offen sc1
s_mov_b64 exec, s[38:39]
L_nohf_76:
s_mov_b32 s32, s20
s_mov_b32 s20, s25
s_mov_b32 s25, s32
s_mov_b32 s26, s20
s_mov_b32 s31, 1
s_add_u32 s22, s22, 327680
s_add_u32 s24, s24, 16384
s_lshl_b32 s34, s16, 13
s_add_u32 s35, s34, s20
s_add_u32 s34, s34, 0
s_add_u32 m0, s34, 0
s_add_u32 s36, s35, 0
buffer_load_dwordx4 v1, s[8:11], s36 offen offset:0 sc1 lds
buffer_load_dwordx4 v1, s[8:11], s36 offen offset:1024 sc1 lds
buffer_load_dwordx4 v1, s[8:11], s36 offen offset:2048 sc1 lds
buffer_load_dwordx4 v1, s[8:11], s36 offen offset:3072 sc1 lds
s_add_u32 m0, s34, 4096
s_add_u32 s36, s35, 4096
buffer_load_dwordx4 v1, s[8:11], s36 offen offset:0 sc1 lds
buffer_load_dwordx4 v1, s[8:11], s36 offen offset:1024 sc1 lds
buffer_load_dwordx4 v1, s[8:11], s36 offen offset:2048 sc1 lds
buffer_load_dwordx4 v1, s[8:11], s36 offen offset:3072 sc1 lds
s_add_u32 m0, s34, 32768
s_add_u32 s36, s35, 32768
buffer_load_dwordx4 v1, s[8:11], s36 offen offset:0 sc1 lds
buffer_load_dwordx4 v1, s[8:11], s36 offen offset:1024 sc1 lds
buffer_load_dwordx4 v1, s[8:11], s36 offen offset:2048 sc1 lds
buffer_load_dwordx4 v1, s[8:11], s36 offen offset:3072 sc1 lds
s_lshl_b32 s33, s16, 10
s_add_u32 s33, s33, s21
buffer_load_dwordx4 v[8:11], v1, s[8:11], s33 offen sc1
s_add_u32 s33, s33, 4096
buffer_load_dwordx4 v[12:15], v1, s[8:11], s33 offen sc1
v_add_u32 v5, 0, v1
v_add_u32 v6, 65536, v1
v_add_u32 v7, 143360, v1
s_waitcnt vmcnt(6)
s_barrier
s_nop 0
ds_read_b128 v[104:107], v5 offset:0
ds_read_b128 v[108:111], v5 offset:1024
ds_read_b128 v[112:115], v5 offset:2048
ds_read_b128 v[116:119], v5 offset:3072
ds_read_b128 v[120:123], v5 offset:4096
ds_read_b128 v[124:127], v5 offset:5120
s_waitcnt lgkmcnt(5)
v_mfma_f32_16x16x32_bf16 v[40:43], a[0:3], v[104:107], 0
ds_read_b128 v[128:131], v5 offset:6144
s_add_u32 m0, s34, 36864
v_mfma_f32_16x16x32_bf16 v[44:47], a[4:7], v[104:107], 0
s_waitcnt lgkmcnt(5)
s_add_u32 s36, s35, 36864
v_mfma_f32_16x16x32_bf16 v[48:51], a[0:3], v[108:111], 0
ds_read_b128 v[104:107], v5 offset:7168
buffer_load_dwordx4 v1, s[8:11], s36 offen offset:0 sc1 lds
v_mfma_f32_16x16x32_bf16 v[52:55], a[4:7], v[108:111], 0
s_waitcnt lgkmcnt(5)
v_mfma_f32_16x16x32_bf16 v[56:59], a[0:3], v[112:115], 0
ds_read_b128 v[108:111], v5 offset:8192
buffer_load_dwordx4 v1, s[8:11], s36 offen offset:1024 sc1 lds
v_mfma_f32_16x16x32_bf16 v[60:63], a[4:7], v[112:115], 0
s_waitcnt lgkmcnt(5)
v_mfma_f32_16x16x32_bf16 v[64:67], a[0:3], v[116:119], 0
ds_read_b128 v[112:115], v5 offset:9216
v_mfma_f32_16x16x32_bf16 v[68:71], a[4:7], v[116:119], 0
s_waitcnt lgkmcnt(5)
v_mfma_f32_16x16x32_bf16 v[72:75], a[0:3], v[120:123], 0
ds_read_b128 v[116:119], v5 offset:10240
buffer_load_dwordx4 v1, s[8:11], s36 offen offset:2048 sc1 lds
v_mfma_f32_16x16x32_bf16 v[76:79], a[4:7], v[120:123], 0
s_waitcnt lgkmcnt(5)
v_mfma_f32_16x16x32_bf16 v[80:83], a[0:3], v[124:127], 0
ds_read_b128 v[120:123], v5 offset:11264
v_mfma_f32_16x16x32_bf16 v[84:87], a[4:7], v[124:127], 0
s_waitcnt lgkmcnt(5)
v_mfma_f32_16x16x32_bf16 v[88:91], a[0:3], v[128:131], 0
ds_read_b128 v[124:127], v5 offset:12288
buffer_load_dwordx4 v1, s[8:11], s36 offen offset:3072 sc1 lds
v_mfma_f32_16x16x32_bf16 v[92:95], a[4:7], v[128:131], 0
s_waitcnt lgkmcnt(5)
v_mfma_f32_16x16x32_bf16 v[96:99], a[0:3], v[104:107], 0
ds_read_b128 v[128:131], v5 offset:13312
v_mfma_f32_16x16x32_bf16 v[100:103], a[4:7], v[104:107], 0
s_waitcnt lgkmcnt(5)
v_mfma_f32_16x16x32_bf16 v[40:43], a[8:11], v[108:111], v[40:43]
ds_read_b128 v[104:107], v5 offset:14336
s_add_u32 m0, s34, 65536
v_mfma_f32_16x16x32_bf16 v[44:47], a[12:15], v[108:111], v[44:47]
s_waitcnt lgkmcnt(5)
s_add_u32 s36, s35, 65536
v_mfma_f32_16x16x32_bf16 v[48:51], a[8:11], v[112:115], v[48:51]
ds_read_b128 v[108:111], v5 offset:15360
buffer_load_dwordx4 v1, s[8:11], s36 offen offset:0 sc1 lds
v_mfma_f32_16x16x32_bf16 v[52:55], a[12:15], v[112:115], v[52:55]
s_waitcnt lgkmcnt(5)
v_mfma_f32_16x16x32_bf16 v[56:59], a[8:11], v[116:119], v[56:59]
ds_read_b128 v[112:115], v5 offset:16384
buffer_load_dwordx4 v1, s[8:11], s36 offen offset:1024 sc1 lds
v_mfma_f32_16x16x32_bf16 v[60:63], a[12:15], v[116:119], v[60:63]
s_waitcnt lgkmcnt(5)
v_mfma_f32_16x16x32_bf16 v[64:67], a[8:11], v[120:123], v[64:67]
ds_read_b128 v[116:119], v5 offset:17408
v_mfma_f32_16x16x32_bf16 v[68:71], a[12:15], v[120:123], v[68:71]
s_waitcnt lgkmcnt(5)
v_mfma_f32_16x16x32_bf16 v[72:75], a[8:11], v[124:127], v[72:75]
ds_read_b128 v[120:123], v5 offset:18432
buffer_load_dwordx4 v1, s[8:11], s36 offen offset:2048 sc1 lds
v_mfma_f32_16x16x32_bf16 v[76:79], a[12:15], v[124:127], v[76:79]
s_waitcnt lgkmcnt(5)
v_mfma_f32_16x16x32_bf16 v[80:83], a[8:11], v[128:131], v[80:83]
ds_read_b128 v[124:127], v5 offset:19456
v_mfma_f32_16x16x32_bf16 v[84:87], a[12:15], v[128:131], v[84:87]
s_waitcnt lgkmcnt(5)
v_mfma_f32_16x16x32_bf16 v[88:91], a[8:11], v[104:107], v[88:91]
ds_read_b128 v[128:131], v5 offset:20480
v_mfma_f32_16x16x32_bf16 v[92:95], a[12:15], v[104:107], v[92:95]
s_waitcnt lgkmcnt(5)
v_mfma_f32_16x16x32_bf16 v[96:99], a[8:11], v[108:111], v[96:99]
ds_read_b128 v[104:107], v5 offset:21504
buffer_load_dwordx4 v1, s[8:11], s36 offen offset:3072 sc1 lds
v_mfma_f32_16x16x32_bf16 v[100:103], a[12:15], v[108:111], v[100:103]
s_waitcnt lgkmcnt(5)
v_mfma_f32_16x16x32_bf16 v[40:43], a[16:19], v[112:115], v[40:43]
ds_read_b128 v[108:111], v5 offset:22528
v_mfma_f32_16x16x32_bf16 v[44:47], a[20:23], v[112:115], v[44:47]
s_waitcnt lgkmcnt(5)
v_mfma_f32_16x16x32_bf16 v[48:51], a[16:19], v[116:119], v[48:51]
ds_read_b128 v[112:115], v5 offset:23552
s_add_u32 m0, s34, 69632
v_mfma_f32_16x16x32_bf16 v[52:55], a[20:23], v[116:119], v[52:55]
s_waitcnt lgkmcnt(5)
s_add_u32 s36, s35, 69632
v_mfma_f32_16x16x32_bf16 v[56:59], a[16:19], v[120:123], v[56:59]
ds_read_b128 v[116:119], v5 offset:24576
buffer_load_dwordx4 v1, s[8:11], s36 offen offset:0 sc1 lds
v_mfma_f32_16x16x32_bf16 v[60:63], a[20:23], v[120:123], v[60:63]
s_waitcnt lgkmcnt(5)
v_mfma_f32_16x16x32_bf16 v[64:67], a[16:19], v[124:127], v[64:67]
ds_read_b128 v[120:123], v5 offset:25600
buffer_load_dwordx4 v1, s[8:11], s36 offen offset:1024 sc1 lds
v_mfma_f32_16x16x32_bf16 v[68:71], a[20:23], v[124:127], v[68:71]
s_waitcnt lgkmcnt(5)
v_mfma_f32_16x16x32_bf16 v[72:75], a[16:19], v[128:131], v[72:75]
ds_read_b128 v[124:127], v5 offset:26624
s_waitcnt vmcnt(10)
v_mfma_f32_16x16x32_bf16 v[76:79], a[20:23], v[128:131], v[76:79]
s_waitcnt lgkmcnt(5)
v_mfma_f32_16x16x32_bf16 v[80:83], a[16:19], v[104:107], v[80:83]
ds_read_b128 v[128:131], v5 offset:27648
buffer_load_dwordx4 v1, s[8:11], s36 offen offset:2048 sc1 lds
v_mfma_f32_16x16x32_bf16 v[84:87], a[20:23], v[104:107], v[84:87]
s_waitcnt lgkmcnt(5)
v_mfma_f32_16x16x32_bf16 v[88:91], a[16:19], v[108:111], v[88:91]
ds_read_b128 v[104:107], v5 offset:28672
v_add_f32 v24, v8, v10
v_mfma_f32_16x16x32_bf16 v[92:95], a[20:23], v[108:111], v[92:95]
s_waitcnt lgkmcnt(5)
v_add_f32 v25, v9, v11
v_mfma_f32_16x16x32_bf16 v[96:99], a[16:19], v[112:115], v[96:99]
ds_read_b128 v[108:111], v5 offset:29696
v_add_f32 v26, v12, v14
v_mfma_f32_16x16x32_bf16 v[100:103], a[20:23], v[112:115], v[100:103]
s_waitcnt lgkmcnt(5)
v_add_f32 v27, v13, v15
v_mfma_f32_16x16x32_bf16 v[40:43], a[24:27], v[116:119], v[40:43]
ds_read_b128 v[112:115], v5 offset:30720
v_mov_b32 v28, v24
v_mfma_f32_16x16x32_bf16 v[44:47], a[28:31], v[116:119], v[44:47]
s_waitcnt lgkmcnt(5)
v_mov_b32 v29, v25
v_mfma_f32_16x16x32_bf16 v[48:51], a[24:27], v[120:123], v[48:51]
ds_read_b128 v[116:119], v5 offset:31744
v_mov_b32 v30, v26
v_mfma_f32_16x16x32_bf16 v[52:55], a[28:31], v[120:123], v[52:55]
s_waitcnt lgkmcnt(5)
v_mov_b32 v31, v27
v_mfma_f32_16x16x32_bf16 v[56:59], a[24:27], v[124:127], v[56:59]
s_waitcnt vmcnt(7)
s_barrier
ds_read_b128 v[120:123], v5 offset:32768
buffer_load_dwordx4 v1, s[8:11], s36 offen offset:3072 sc1 lds
v_mfma_f32_16x16x32_bf16 v[60:63], a[28:31], v[124:127], v[60:63]
s_waitcnt lgkmcnt(5)
s_nop 1
v_mfma_f32_16x16x32_bf16 v[64:67], a[24:27], v[128:131], v[64:67]
ds_read_b128 v[124:127], v5 offset:33792
v_permlane16_swap_b32 v24, v28
v_mfma_f32_16x16x32_bf16 v[68:71], a[28:31], v[128:131], v[68:71]
s_waitcnt lgkmcnt(5)
v_permlane16_swap_b32 v25, v29
v_mfma_f32_16x16x32_bf16 v[72:75], a[24:27], v[104:107], v[72:75]
ds_read_b128 v[128:131], v5 offset:34816
v_permlane16_swap_b32 v26, v30
v_mfma_f32_16x16x32_bf16 v[76:79], a[28:31], v[104:107], v[76:79]
s_waitcnt lgkmcnt(5)
v_permlane16_swap_b32 v27, v31
v_mfma_f32_16x16x32_bf16 v[80:83], a[24:27], v[108:111], v[80:83]
ds_read_b128 v[104:107], v5 offset:35840
s_add_u32 s37, s23, 16384
v_mfma_f32_16x16x32_bf16 v[84:87], a[28:31], v[108:111], v[84:87]
s_waitcnt lgkmcnt(5)
buffer_load_dwordx4 a[64:67], v1, s[8:11], s37 offen offset:0
v_mfma_f32_16x16x32_bf16 v[88:91], a[24:27], v[112:115], v[88:91]
ds_read_b128 v[108:111], v5 offset:36864
s_nop 1
v_mfma_f32_16x16x32_bf16 v[92:95], a[28:31], v[112:115], v[92:95]
s_waitcnt lgkmcnt(5)
v_add_f32 v24, v24, v28
v_mfma_f32_16x16x32_bf16 v[96:99], a[24:27], v[116:119], v[96:99]
ds_read_b128 v[112:115], v5 offset:37888
v_add_f32 v25, v25, v29
v_mfma_f32_16x16x32_bf16 v[100:103], a[28:31], v[116:119], v[100:103]
s_waitcnt lgkmcnt(5)
v_add_f32 v26, v26, v30
v_mfma_f32_16x16x32_bf16 v[40:43], a[32:35], v[120:123], v[40:43]
ds_read_b128 v[116:119], v5 offset:38912
v_add_f32 v27, v27, v31
v_mfma_f32_16x16x32_bf16 v[44:47], a[36:39], v[120:123], v[44:47]
s_waitcnt lgkmcnt(5)
v_mov_b32 v28, v24
v_mfma_f32_16x16x32_bf16 v[48:51], a[32:35], v[124:127], v[48:51]
ds_read_b128 v[120:123], v5 offset:39936
v_mov_b32 v29, v25
v_mfma_f32_16x16x32_bf16 v[52:55], a[36:39], v[124:127], v[52:55]
s_waitcnt lgkmcnt(5)
v_mov_b32 v30, v26
v_mfma_f32_16x16x32_bf16 v[56:59], a[32:35], v[128:131], v[56:59]
ds_read_b128 v[124:127], v5 offset:40960
v_mov_b32 v31, v27
v_mfma_f32_16x16x32_bf16 v[60:63], a[36:39], v[128:131], v[60:63]
s_waitcnt lgkmcnt(5)
s_add_u32 s37, s23, 16384
v_mfma_f32_16x16x32_bf16 v[64:67], a[32:35], v[104:107], v[64:67]
ds_read_b128 v[128:131], v5 offset:41984
buffer_load_dwordx4 a[68:71], v1, s[8:11], s37 offen offset:1024
v_mfma_f32_16x16x32_bf16 v[68:71], a[36:39], v[104:107], v[68:71]
s_waitcnt lgkmcnt(5)
s_nop 1
v_mfma_f32_16x16x32_bf16 v[72:75], a[32:35], v[108:111], v[72:75]
ds_read_b128 v[104:107], v5 offset:43008
v_permlane32_swap_b32 v24, v28
v_mfma_f32_16x16x32_bf16 v[76:79], a[36:39], v[108:111], v[76:79]
s_waitcnt lgkmcnt(5)
v_permlane32_swap_b32 v25, v29
v_mfma_f32_16x16x32_bf16 v[80:83], a[32:35], v[112:115], v[80:83]
ds_read_b128 v[108:111], v5 offset:44032
v_permlane32_swap_b32 v26, v30
v_mfma_f32_16x16x32_bf16 v[84:87], a[36:39], v[112:115], v[84:87]
s_waitcnt lgkmcnt(5)
v_permlane32_swap_b32 v27, v31
v_mfma_f32_16x16x32_bf16 v[88:91], a[32:35], v[116:119], v[88:91]
ds_read_b128 v[112:115], v5 offset:45056
s_add_u32 s37, s23, 18432
v_mfma_f32_16x16x32_bf16 v[92:95], a[36:39], v[116:119], v[92:95]
s_waitcnt lgkmcnt(5)
buffer_load_dwordx4 a[72:75], v1, s[8:11], s37 offen offset:0
v_mfma_f32_16x16x32_bf16 v[96:99], a[32:35], v[120:123], v[96:99]
ds_read_b128 v[116:119], v5 offset:46080
s_nop 1
v_mfma_f32_16x16x32_bf16 v[100:103], a[36:39], v[120:123], v[100:103]
s_waitcnt lgkmcnt(5)
v_add_f32 v24, v24, v28
v_mfma_f32_16x16x32_bf16 v[40:43], a[40:43], v[124:127], v[40:43]
ds_read_b128 v[120:123], v5 offset:47104
v_add_f32 v25, v25, v29
v_mfma_f32_16x16x32_bf16 v[44:47], a[44:47], v[124:127], v[44:47]
s_waitcnt lgkmcnt(5)
v_add_f32 v26, v26, v30
v_mfma_f32_16x16x32_bf16 v[48:51], a[40:43], v[128:131], v[48:51]
ds_read_b128 v[124:127], v5 offset:48128
v_add_f32 v27, v27, v31
v_mfma_f32_16x16x32_bf16 v[52:55], a[44:47], v[128:131], v[52:55]
s_waitcnt lgkmcnt(5)
v_mul_f32 v24, 0.0015625, v24
v_mfma_f32_16x16x32_bf16 v[56:59], a[40:43], v[104:107], v[56:59]
ds_read_b128 v[128:131], v5 offset:49152
v_mul_f32 v25, 0.0015625, v25
v_mfma_f32_16x16x32_bf16 v[60:63], a[44:47], v[104:107], v[60:63]
s_waitcnt lgkmcnt(5)
v_mul_f32 v26, 0.0015625, v26
v_mfma_f32_16x16x32_bf16 v[64:67], a[40:43], v[108:111], v[64:67]
ds_read_b128 v[104:107], v5 offset:50176
v_mul_f32 v27, 0.0015625, v27
v_mfma_f32_16x16x32_bf16 v[68:71], a[44:47], v[108:111], v[68:71]
s_waitcnt lgkmcnt(5)
s_add_u32 s37, s23, 18432
v_mfma_f32_16x16x32_bf16 v[72:75], a[40:43], v[112:115], v[72:75]
ds_read_b128 v[108:111], v5 offset:51200
buffer_load_dwordx4 a[76:79], v1, s[8:11], s37 offen offset:1024
v_mfma_f32_16x16x32_bf16 v[76:79], a[44:47], v[112:115], v[76:79]
s_waitcnt lgkmcnt(5)
v_fma_f32 v25, -v24, v24, v25
v_mfma_f32_16x16x32_bf16 v[80:83], a[40:43], v[116:119], v[80:83]
ds_read_b128 v[112:115], v5 offset:52224
v_max_f32 v25, 0, v25
v_mfma_f32_16x16x32_bf16 v[84:87], a[44:47], v[116:119], v[84:87]
s_waitcnt lgkmcnt(5)
v_add_f32 v25, 0x3727c5ac, v25
v_mfma_f32_16x16x32_bf16 v[88:91], a[40:43], v[120:123], v[88:91]
ds_read_b128 v[116:119], v5 offset:53248
v_rsq_f32 v25, v25
v_mfma_f32_16x16x32_bf16 v[92:95], a[44:47], v[120:123], v[92:95]
s_waitcnt lgkmcnt(5)
v_fma_f32 v27, -v26, v26, v27
v_mfma_f32_16x16x32_bf16 v[96:99], a[40:43], v[124:127], v[96:99]
ds_read_b128 v[120:123], v5 offset:54272
v_max_f32 v27, 0, v27
v_mfma_f32_16x16x32_bf16 v[100:103], a[44:47], v[124:127], v[100:103]
s_waitcnt lgkmcnt(5)
v_add_f32 v27, 0x3727c5ac, v27
v_mfma_f32_16x16x32_bf16 v[40:43], a[48:51], v[128:131], v[40:43]
ds_read_b128 v[124:127], v5 offset:55296
v_rsq_f32 v27, v27
v_mfma_f32_16x16x32_bf16 v[44:47], a[52:55], v[128:131], v[44:47]
s_waitcnt lgkmcnt(5)
s_nop 0
v_mfma_f32_16x16x32_bf16 v[48:51], a[48:51], v[104:107], v[48:51]
ds_read_b128 v[128:131], v5 offset:56320
s_add_u32 s37, s23, 20480
v_mfma_f32_16x16x32_bf16 v[52:55], a[52:55], v[104:107], v[52:55]
s_waitcnt lgkmcnt(5)
buffer_load_dwordx4 a[80:83], v1, s[8:11], s37 offen offset:0
v_mfma_f32_16x16x32_bf16 v[56:59], a[48:51], v[108:111], v[56:59]
ds_read_b128 v[104:107], v5 offset:57344
s_lshl_b32 s33, s16, 7
s_add_u32 s33, s33, 131200
v_lshlrev_b32 v16, 3, v3
v_add_u32 v16, s33, v16
s_mov_b64 s[38:39], exec
s_mov_b64 exec, 0xffff
ds_write_b64 v16, v[24:25]
ds_write_b64 v16, v[26:27] offset:512
s_mov_b64 exec, s[38:39]
v_mfma_f32_16x16x32_bf16 v[60:63], a[52:55], v[108:111], v[60:63]
s_waitcnt lgkmcnt(7)
s_add_u32 s37, s23, 20480
v_mfma_f32_16x16x32_bf16 v[64:67], a[48:51], v[112:115], v[64:67]
ds_read_b128 v[108:111], v5 offset:58368
buffer_load_dwordx4 a[84:87], v1, s[8:11], s37 offen offset:1024
v_mfma_f32_16x16x32_bf16 v[68:71], a[52:55], v[112:115], v[68:71]
s_waitcnt lgkmcnt(7)
s_add_u32 s37, s23, 22528
v_mfma_f32_16x16x32_bf16 v[72:75], a[48:51], v[116:119], v[72:75]
ds_read_b128 v[112:115], v5 offset:59392
buffer_load_dwordx4 a[88:91], v1, s[8:11], s37 offen offset:0
v_mfma_f32_16x16x32_bf16 v[76:79], a[52:55], v[116:119], v[76:79]
s_waitcnt lgkmcnt(7)
s_add_u32 s37, s23, 22528
v_mfma_f32_16x16x32_bf16 v[80:83], a[48:51], v[120:123], v[80:83]
ds_read_b128 v[116:119], v5 offset:60416
buffer_load_dwordx4 a[92:95], v1, s[8:11], s37 offen offset:1024
v_mfma_f32_16x16x32_bf16 v[84:87], a[52:55], v[120:123], v[84:87]
s_waitcnt lgkmcnt(7)
s_add_u32 m0, s34, 98304
v_mfma_f32_16x16x32_bf16 v[88:91], a[48:51], v[124:127], v[88:91]
ds_read_b128 v[120:123], v5 offset:61440
s_add_u32 s36, s35, 98304
v_mfma_f32_16x16x32_bf16 v[92:95], a[52:55], v[124:127], v[92:95]
s_waitcnt lgkmcnt(7)
buffer_load_dwordx4 v1, s[8:11], s36 offen offset:0 sc1 lds
v_mfma_f32_16x16x32_bf16 v[96:99], a[48:51], v[128:131], v[96:99]
ds_read_b128 v[124:127], v5 offset:62464
buffer_load_dwordx4 v1, s[8:11], s36 offen offset:1024 sc1 lds
v_mfma_f32_16x16x32_bf16 v[100:103], a[52:55], v[128:131], v[100:103]
s_waitcnt lgkmcnt(7)
buffer_load_dwordx4 v1, s[8:11], s36 offen offset:2048 sc1 lds
v_mfma_f32_16x16x32_bf16 v[40:43], a[56:59], v[104:107], v[40:43]
ds_read_b128 v[128:131], v5 offset:63488
buffer_load_dwordx4 v1, s[8:11], s36 offen offset:3072 sc1 lds
v_mfma_f32_16x16x32_bf16 v[44:47], a[60:63], v[104:107], v[44:47]
s_waitcnt lgkmcnt(5)
s_add_u32 m0, s34, 102400
v_mfma_f32_16x16x32_bf16 v[48:51], a[56:59], v[108:111], v[48:51]
ds_read_b128 v[104:107], v5 offset:64512
s_add_u32 s36, s35, 102400
v_mfma_f32_16x16x32_bf16 v[52:55], a[60:63], v[108:111], v[52:55]
s_waitcnt lgkmcnt(5)
buffer_load_dwordx4 v1, s[8:11], s36 offen offset:0 sc1 lds
v_mfma_f32_16x16x32_bf16 v[56:59], a[56:59], v[112:115], v[56:59]
s_waitcnt vmcnt(13)
s_barrier
ds_read_b128 v[108:111], v6 offset:0
buffer_load_dwordx4 v1, s[8:11], s36 offen offset:1024 sc1 lds
v_mfma_f32_16x16x32_bf16 v[60:63], a[60:63], v[112:115], v[60:63]
s_waitcnt lgkmcnt(5)
buffer_load_dwordx4 v1, s[8:11], s36 offen offset:2048 sc1 lds
v_mfma_f32_16x16x32_bf16 v[64:67], a[56:59], v[116:119], v[64:67]
ds_read_b128 v[112:115], v6 offset:1024
buffer_load_dwordx4 v1, s[8:11], s36 offen offset:3072 sc1 lds
v_mfma_f32_16x16x32_bf16 v[68:71], a[60:63], v[116:119], v[68:71]
s_waitcnt lgkmcnt(5)
v_mfma_f32_16x16x32_bf16 v[72:75], a[56:59], v[120:123], v[72:75]
ds_read_b128 v[116:119], v6 offset:2048
s_add_u32 s37, s23, 24576
v_mfma_f32_16x16x32_bf16 v[76:79], a[60:63], v[120:123], v[76:79]
s_waitcnt lgkmcnt(5)
buffer_load_dwordx4 a[96:99], v1, s[8:11], s37 offen offset:0
v_mfma_f32_16x16x32_bf16 v[80:83], a[56:59], v[124:127], v[80:83]
ds_read_b128 v[120:123], v6 offset:3072
v_mfma_f32_16x16x32_bf16 v[84:87], a[60:63], v[124:127], v[84:87]
s_waitcnt lgkmcnt(5)
v_mfma_f32_16x16x32_bf16 v[88:91], a[56:59], v[128:131], v[88:91]
ds_read_b128 v[124:127], v6 offset:4096
s_add_u32 s37, s23, 24576
v_mfma_f32_16x16x32_bf16 v[92:95], a[60:63], v[128:131], v[92:95]
s_waitcnt lgkmcnt(5)
buffer_load_dwordx4 a[100:103], v1, s[8:11], s37 offen offset:1024
v_mfma_f32_16x16x32_bf16 v[96:99], a[56:59], v[104:107], v[96:99]
ds_read_b128 v[128:131], v6 offset:5120
v_mfma_f32_16x16x32_bf16 v[100:103], a[60:63], v[104:107], v[100:103]
s_waitcnt lgkmcnt(5) vmcnt(16)
v_mfma_f32_16x16x32_bf16 v[40:43], a[64:67], v[108:111], v[40:43]
ds_read_b128 v[104:107], v6 offset:6144
s_add_u32 s37, s23, 26624
v_mfma_f32_16x16x32_bf16 v[44:47], a[68:71], v[108:111], v[44:47]
s_waitcnt lgkmcnt(5)
buffer_load_dwordx4 a[104:107], v1, s[8:11], s37 offen offset:0
v_mfma_f32_16x16x32_bf16 v[48:51], a[64:67], v[112:115], v[48:51]
ds_read_b128 v[108:111], v6 offset:7168
v_mfma_f32_16x16x32_bf16 v[52:55], a[68:71], v[112:115], v[52:55]
s_waitcnt lgkmcnt(5)
v_mfma_f32_16x16x32_bf16 v[56:59], a[64:67], v[116:119], v[56:59]
ds_read_b128 v[112:115], v6 offset:8192
s_add_u32 s37, s23, 26624
v_mfma_f32_16x16x32_bf16 v[60:63], a[68:71], v[116:119], v[60:63]
s_waitcnt lgkmcnt(5)
buffer_load_dwordx4 a[108:111], v1, s[8:11], s37 offen offset:1024
v_mfma_f32_16x16x32_bf16 v[64:67], a[64:67], v[120:123], v[64:67]
ds_read_b128 v[116:119], v6 offset:9216
v_mfma_f32_16x16x32_bf16 v[68:71], a[68:71], v[120:123], v[68:71]
s_waitcnt lgkmcnt(5)
v_mfma_f32_16x16x32_bf16 v[72:75], a[64:67], v[124:127], v[72:75]
ds_read_b128 v[120:123], v6 offset:10240
s_add_u32 s37, s23, 28672
v_mfma_f32_16x16x32_bf16 v[76:79], a[68:71], v[124:127], v[76:79]
s_waitcnt lgkmcnt(5)
buffer_load_dwordx4 a[112:115], v1, s[8:11], s37 offen offset:0
v_mfma_f32_16x16x32_bf16 v[80:83], a[64:67], v[128:131], v[80:83]
ds_read_b128 v[124:127], v6 offset:11264
v_mfma_f32_16x16x32_bf16 v[84:87], a[68:71], v[128:131], v[84:87]
s_waitcnt lgkmcnt(5)
v_mfma_f32_16x16x32_bf16 v[88:91], a[64:67], v[104:107], v[88:91]
ds_read_b128 v[128:131], v6 offset:12288
v_mfma_f32_16x16x32_bf16 v[92:95], a[68:71], v[104:107], v[92:95]
s_waitcnt lgkmcnt(5)
v_mfma_f32_16x16x32_bf16 v[96:99], a[64:67], v[108:111], v[96:99]
ds_read_b128 v[104:107], v6 offset:13312
s_add_u32 s37, s23, 28672
v_mfma_f32_16x16x32_bf16 v[100:103], a[68:71], v[108:111], v[100:103]
s_waitcnt lgkmcnt(5) vmcnt(17)
buffer_load_dwordx4 a[116:119], v1, s[8:11], s37 offen offset:1024
v_mfma_f32_16x16x32_bf16 v[40:43], a[72:75], v[112:115], v[40:43]
ds_read_b128 v[108:111], v6 offset:14336
v_mfma_f32_16x16x32_bf16 v[44:47], a[76:79], v[112:115], v[44:47]
s_waitcnt lgkmcnt(5)
v_mfma_f32_16x16x32_bf16 v[48:51], a[72:75], v[116:119], v[48:51]
ds_read_b128 v[112:115], v6 offset:15360
s_add_u32 s37, s23, 30720
v_mfma_f32_16x16x32_bf16 v[52:55], a[76:79], v[116:119], v[52:55]
s_waitcnt lgkmcnt(5)
buffer_load_dwordx4 a[120:123], v1, s[8:11], s37 offen offset:0
v_mfma_f32_16x16x32_bf16 v[56:59], a[72:75], v[120:123], v[56:59]
ds_read_b128 v[116:119], v6 offset:16384
v_mfma_f32_16x16x32_bf16 v[60:63], a[76:79], v[120:123], v[60:63]
s_waitcnt lgkmcnt(5)
v_mfma_f32_16x16x32_bf16 v[64:67], a[72:75], v[124:127], v[64:67]
ds_read_b128 v[120:123], v6 offset:17408
s_add_u32 s37, s23, 30720
v_mfma_f32_16x16x32_bf16 v[68:71], a[76:79], v[124:127], v[68:71]
s_waitcnt lgkmcnt(5)
buffer_load_dwordx4 a[124:127], v1, s[8:11], s37 offen offset:1024
v_mfma_f32_16x16x32_bf16 v[72:75], a[72:75], v[128:131], v[72:75]
ds_read_b128 v[124:127], v6 offset:18432
v_mfma_f32_16x16x32_bf16 v[76:79], a[76:79], v[128:131], v[76:79]
s_waitcnt lgkmcnt(5)
v_mfma_f32_16x16x32_bf16 v[80:83], a[72:75], v[104:107], v[80:83]
ds_read_b128 v[128:131], v6 offset:19456
s_add_u32 m0, s34, 0
v_mfma_f32_16x16x32_bf16 v[84:87], a[76:79], v[104:107], v[84:87]
s_waitcnt lgkmcnt(5)
s_add_u32 s36, s35, 131072
v_mfma_f32_16x16x32_bf16 v[88:91], a[72:75], v[108:111], v[88:91]
ds_read_b128 v[104:107], v6 offset:20480
buffer_load_dwordx4 v1, s[8:11], s36 offen offset:0 sc1 lds
v_mfma_f32_16x16x32_bf16 v[92:95], a[76:79], v[108:111], v[92:95]
s_waitcnt lgkmcnt(5)
v_mfma_f32_16x16x32_bf16 v[96:99], a[72:75], v[112:115], v[96:99]
ds_read_b128 v[108:111], v6 offset:21504
buffer_load_dwordx4 v1, s[8:11], s36 offen offset:1024 sc1 lds
v_mfma_f32_16x16x32_bf16 v[100:103], a[76:79], v[112:115], v[100:103]
s_waitcnt lgkmcnt(5) vmcnt(20)
v_mfma_f32_16x16x32_bf16 v[40:43], a[80:83], v[116:119], v[40:43]
ds_read_b128 v[112:115], v6 offset:22528
v_mfma_f32_16x16x32_bf16 v[44:47], a[84:87], v[116:119], v[44:47]
s_waitcnt lgkmcnt(5)
v_mfma_f32_16x16x32_bf16 v[48:51], a[80:83], v[120:123], v[48:51]
ds_read_b128 v[116:119], v6 offset:23552
buffer_load_dwordx4 v1, s[8:11], s36 offen offset:2048 sc1 lds
v_mfma_f32_16x16x32_bf16 v[52:55], a[84:87], v[120:123], v[52:55]
s_waitcnt lgkmcnt(5)
v_mfma_f32_16x16x32_bf16 v[56:59], a[80:83], v[124:127], v[56:59]
ds_read_b128 v[120:123], v6 offset:24576
v_mfma_f32_16x16x32_bf16 v[60:63], a[84:87], v[124:127], v[60:63]
s_waitcnt lgkmcnt(5)
v_mfma_f32_16x16x32_bf16 v[64:67], a[80:83], v[128:131], v[64:67]
ds_read_b128 v[124:127], v6 offset:25600
v_mfma_f32_16x16x32_bf16 v[68:71], a[84:87], v[128:131], v[68:71]
s_waitcnt lgkmcnt(5)
v_mfma_f32_16x16x32_bf16 v[72:75], a[80:83], v[104:107], v[72:75]
ds_read_b128 v[128:131], v6 offset:26624
buffer_load_dwordx4 v1, s[8:11], s36 offen offset:3072 sc1 lds
v_mfma_f32_16x16x32_bf16 v[76:79], a[84:87], v[104:107], v[76:79]
s_waitcnt lgkmcnt(5)
v_mfma_f32_16x16x32_bf16 v[80:83], a[80:83], v[108:111], v[80:83]
ds_read_b128 v[104:107], v6 offset:27648
v_mfma_f32_16x16x32_bf16 v[84:87], a[84:87], v[108:111], v[84:87]
s_waitcnt lgkmcnt(5)
v_mfma_f32_16x16x32_bf16 v[88:91], a[80:83], v[112:115], v[88:91]
ds_read_b128 v[108:111], v6 offset:28672
s_add_u32 m0, s34, 4096
v_mfma_f32_16x16x32_bf16 v[92:95], a[84:87], v[112:115], v[92:95]
s_waitcnt lgkmcnt(5)
s_add_u32 s36, s35, 135168
v_mfma_f32_16x16x32_bf16 v[96:99], a[80:83], v[116:119], v[96:99]
ds_read_b128 v[112:115], v6 offset:29696
buffer_load_dwordx4 v1, s[8:11], s36 offen offset:0 sc1 lds
v_mfma_f32_16x16x32_bf16 v[100:103], a[84:87], v[116:119], v[100:103]
s_waitcnt lgkmcnt(5) vmcnt(21)
v_mfma_f32_16x16x32_bf16 v[40:43], a[88:91], v[120:123], v[40:43]
ds_read_b128 v[116:119], v6 offset:30720
buffer_load_dwordx4 v1, s[8:11], s36 offen offset:1024 sc1 lds
v_mfma_f32_16x16x32_bf16 v[44:47], a[92:95], v[120:123], v[44:47]
s_waitcnt lgkmcnt(5)
v_mfma_f32_16x16x32_bf16 v[48:51], a[88:91], v[124:127], v[48:51]
ds_read_b128 v[120:123], v6 offset:31744
v_mfma_f32_16x16x32_bf16 v[52:55], a[92:95], v[124:127], v[52:55]
s_waitcnt lgkmcnt(5)
v_mfma_f32_16x16x32_bf16 v[56:59], a[88:91], v[128:131], v[56:59]
s_waitcnt vmcnt(14)
s_barrier
ds_read_b128 v[124:127], v6 offset:32768
buffer_load_dwordx4 v1, s[8:11], s36 offen offset:2048 sc1 lds
v_mfma_f32_16x16x32_bf16 v[60:63], a[92:95], v[128:131], v[60:63]
s_waitcnt lgkmcnt(5)
v_mfma_f32_16x16x32_bf16 v[64:67], a[88:91], v[104:107], v[64:67]
ds_read_b128 v[128:131], v6 offset:33792
v_mfma_f32_16x16x32_bf16 v[68:71], a[92:95], v[104:107], v[68:71]
s_waitcnt lgkmcnt(5)
v_mfma_f32_16x16x32_bf16 v[72:75], a[88:91], v[108:111], v[72:75]
ds_read_b128 v[104:107], v6 offset:34816
buffer_load_dwordx4 v1, s[8:11], s36 offen offset:3072 sc1 lds
v_mfma_f32_16x16x32_bf16 v[76:79], a[92:95], v[108:111], v[76:79]
s_waitcnt lgkmcnt(5)
v_mfma_f32_16x16x32_bf16 v[80:83], a[88:91], v[112:115], v[80:83]
ds_read_b128 v[108:111], v6 offset:35840
v_mfma_f32_16x16x32_bf16 v[84:87], a[92:95], v[112:115], v[84:87]
s_waitcnt lgkmcnt(5)
v_mfma_f32_16x16x32_bf16 v[88:91], a[88:91], v[116:119], v[88:91]
ds_read_b128 v[112:115], v6 offset:36864
s_add_u32 s37, s23, 32768
v_mfma_f32_16x16x32_bf16 v[92:95], a[92:95], v[116:119], v[92:95]
s_waitcnt lgkmcnt(5)
buffer_load_dwordx4 a[128:131], v1, s[8:11], s37 offen offset:0
v_mfma_f32_16x16x32_bf16 v[96:99], a[88:91], v[120:123], v[96:99]
ds_read_b128 v[116:119], v6 offset:37888
v_mfma_f32_16x16x32_bf16 v[100:103], a[92:95], v[120:123], v[100:103]
s_waitcnt lgkmcnt(5) vmcnt(15)
v_mfma_f32_16x16x32_bf16 v[40:43], a[96:99], v[124:127], v[40:43]
ds_read_b128 v[120:123], v6 offset:38912
s_add_u32 s37, s23, 32768
v_mfma_f32_16x16x32_bf16 v[44:47], a[100:103], v[124:127], v[44:47]
s_waitcnt lgkmcnt(5)
buffer_load_dwordx4 a[132:135], v1, s[8:11], s37 offen offset:1024
v_mfma_f32_16x16x32_bf16 v[48:51], a[96:99], v[128:131], v[48:51]
ds_read_b128 v[124:127], v6 offset:39936
s_max_u32 s40, s17, 1
v_mfma_f32_16x16x32_bf16 v[52:55], a[100:103], v[128:131], v[52:55]
s_waitcnt lgkmcnt(5)
s_sub_u32 s40, s40, 1
v_mfma_f32_16x16x32_bf16 v[56:59], a[96:99], v[104:107], v[56:59]
ds_read_b128 v[128:131], v6 offset:40960
s_lshl_b32 s40, s40, 7
v_mfma_f32_16x16x32_bf16 v[60:63], a[100:103], v[104:107], v[60:63]
s_waitcnt lgkmcnt(5)
s_add_u32 s40, s40, 23412736
v_mfma_f32_16x16x32_bf16 v[64:67], a[96:99], v[108:111], v[64:67]
ds_read_b128 v[104:107], v6 offset:41984
v_and_b32 v21, 7, v2
v_mfma_f32_16x16x32_bf16 v[68:71], a[100:103], v[108:111], v[68:71]
s_waitcnt lgkmcnt(5)
v_lshlrev_b32 v21, 2, v21
v_mfma_f32_16x16x32_bf16 v[72:75], a[96:99], v[112:115], v[72:75]
ds_read_b128 v[108:111], v6 offset:43008
buffer_load_dword v20, v21, s[8:11], s40 offen sc1
v_mfma_f32_16x16x32_bf16 v[76:79], a[100:103], v[112:115], v[76:79]
s_waitcnt lgkmcnt(5)
s_add_u32 s37, s23, 34816
v_mfma_f32_16x16x32_bf16 v[80:83], a[96:99], v[116:119], v[80:83]
ds_read_b128 v[112:115], v6 offset:44032
buffer_load_dwordx4 a[136:139], v1, s[8:11], s37 offen offset:0
v_mfma_f32_16x16x32_bf16 v[84:87], a[100:103], v[116:119], v[84:87]
s_waitcnt lgkmcnt(5)
s_add_u32 s37, s23, 34816
v_mfma_f32_16x16x32_bf16 v[88:91], a[96:99], v[120:123], v[88:91]
ds_read_b128 v[116:119], v6 offset:45056
buffer_load_dwordx4 a[140:143], v1, s[8:11], s37 offen offset:1024
v_mfma_f32_16x16x32_bf16 v[92:95], a[100:103], v[120:123], v[92:95]
s_waitcnt lgkmcnt(5)
v_mfma_f32_16x16x32_bf16 v[96:99], a[96:99], v[124:127], v[96:99]
ds_read_b128 v[120:123], v6 offset:46080
s_add_u32 s37, s23, 36864
v_mfma_f32_16x16x32_bf16 v[100:103], a[100:103], v[124:127], v[100:103]
s_waitcnt lgkmcnt(5) vmcnt(17)
buffer_load_dwordx4 a[144:147], v1, s[8:11], s37 offen offset:0
v_mfma_f32_16x16x32_bf16 v[40:43], a[104:107], v[128:131], v[40:43]
ds_read_b128 v[124:127], v6 offset:47104
v_mfma_f32_16x16x32_bf16 v[44:47], a[108:111], v[128:131], v[44:47]
s_waitcnt lgkmcnt(5)
v_mfma_f32_16x16x32_bf16 v[48:51], a[104:107], v[104:107], v[48:51]
ds_read_b128 v[128:131], v6 offset:48128
s_add_u32 s37, s23, 36864
v_mfma_f32_16x16x32_bf16 v[52:55], a[108:111], v[104:107], v[52:55]
s_waitcnt lgkmcnt(5)
buffer_load_dwordx4 a[148:151], v1, s[8:11], s37 offen offset:1024
v_mfma_f32_16x16x32_bf16 v[56:59], a[104:107], v[108:111], v[56:59]
ds_read_b128 v[104:107], v6 offset:49152
v_mfma_f32_16x16x32_bf16 v[60:63], a[108:111], v[108:111], v[60:63]
s_waitcnt lgkmcnt(5)
v_mfma_f32_16x16x32_bf16 v[64:67], a[104:107], v[112:115], v[64:67]
ds_read_b128 v[108:111], v6 offset:50176
s_add_u32 s37, s23, 38912
v_mfma_f32_16x16x32_bf16 v[68:71], a[108:111], v[112:115], v[68:71]
s_waitcnt lgkmcnt(5)
buffer_load_dwordx4 a[152:155], v1, s[8:11], s37 offen offset:0
v_mfma_f32_16x16x32_bf16 v[72:75], a[104:107], v[116:119], v[72:75]
ds_read_b128 v[112:115], v6 offset:51200
v_mfma_f32_16x16x32_bf16 v[76:79], a[108:111], v[116:119], v[76:79]
s_waitcnt lgkmcnt(5)
v_mfma_f32_16x16x32_bf16 v[80:83], a[104:107], v[120:123], v[80:83]
ds_read_b128 v[116:119], v6 offset:52224
s_add_u32 s37, s23, 38912
v_mfma_f32_16x16x32_bf16 v[84:87], a[108:111], v[120:123], v[84:87]
s_waitcnt lgkmcnt(5)
buffer_load_dwordx4 a[156:159], v1, s[8:11], s37 offen offset:1024
v_mfma_f32_16x16x32_bf16 v[88:91], a[104:107], v[124:127], v[88:91]
ds_read_b128 v[120:123], v6 offset:53248
v_mfma_f32_16x16x32_bf16 v[92:95], a[108:111], v[124:127], v[92:95]
s_waitcnt lgkmcnt(5)
v_mfma_f32_16x16x32_bf16 v[96:99], a[104:107], v[128:131], v[96:99]
ds_read_b128 v[124:127], v6 offset:54272
v_mfma_f32_16x16x32_bf16 v[100:103], a[108:111], v[128:131], v[100:103]
s_waitcnt lgkmcnt(5) vmcnt(19)
v_mfma_f32_16x16x32_bf16 v[40:43], a[112:115], v[104:107], v[40:43]
ds_read_b128 v[128:131], v6 offset:55296
v_mfma_f32_16x16x32_bf16 v[44:47], a[116:119], v[104:107], v[44:47]
s_waitcnt lgkmcnt(5)
v_mfma_f32_16x16x32_bf16 v[48:51], a[112:115], v[108:111], v[48:51]
ds_read_b128 v[104:107], v6 offset:56320
v_mfma_f32_16x16x32_bf16 v[52:55], a[116:119], v[108:111], v[52:55]
s_waitcnt lgkmcnt(5)
v_mfma_f32_16x16x32_bf16 v[56:59], a[112:115], v[112:115], v[56:59]
ds_read_b128 v[108:111], v6 offset:57344
v_mfma_f32_16x16x32_bf16 v[60:63], a[116:119], v[112:115], v[60:63]
s_waitcnt lgkmcnt(5)
v_mfma_f32_16x16x32_bf16 v[64:67], a[112:115], v[116:119], v[64:67]
ds_read_b128 v[112:115], v6 offset:58368
v_mfma_f32_16x16x32_bf16 v[68:71], a[116:119], v[116:119], v[68:71]
s_waitcnt lgkmcnt(5)
v_mfma_f32_16x16x32_bf16 v[72:75], a[112:115], v[120:123], v[72:75]
ds_read_b128 v[116:119], v6 offset:59392
v_mfma_f32_16x16x32_bf16 v[76:79], a[116:119], v[120:123], v[76:79]
s_waitcnt lgkmcnt(5)
v_mfma_f32_16x16x32_bf16 v[80:83], a[112:115], v[124:127], v[80:83]
ds_read_b128 v[120:123], v6 offset:60416
v_mfma_f32_16x16x32_bf16 v[84:87], a[116:119], v[124:127], v[84:87]
s_waitcnt lgkmcnt(5)
v_mfma_f32_16x16x32_bf16 v[88:91], a[112:115], v[128:131], v[88:91]
ds_read_b128 v[124:127], v6 offset:61440
v_mfma_f32_16x16x32_bf16 v[92:95], a[116:119], v[128:131], v[92:95]
s_waitcnt lgkmcnt(5)
v_mfma_f32_16x16x32_bf16 v[96:99], a[112:115], v[104:107], v[96:99]
ds_read_b128 v[128:131], v6 offset:62464
v_mfma_f32_16x16x32_bf16 v[100:103], a[116:119], v[104:107], v[100:103]
s_waitcnt lgkmcnt(5) vmcnt(17)
v_mfma_f32_16x16x32_bf16 v[40:43], a[120:123], v[108:111], v[40:43]
ds_read_b128 v[104:107], v6 offset:63488
v_mfma_f32_16x16x32_bf16 v[44:47], a[124:127], v[108:111], v[44:47]
s_waitcnt lgkmcnt(5)
v_mfma_f32_16x16x32_bf16 v[48:51], a[120:123], v[112:115], v[48:51]
ds_read_b128 v[108:111], v6 offset:64512
v_mfma_f32_16x16x32_bf16 v[52:55], a[124:127], v[112:115], v[52:55]
s_waitcnt lgkmcnt(5)
v_mfma_f32_16x16x32_bf16 v[56:59], a[120:123], v[116:119], v[56:59]
s_waitcnt vmcnt(6)
s_cmp_lg_u32 s16, 0
s_cbranch_scc1 L_nohp_77
v_cmp_ne_u32 vcc, s59, v20
s_cbranch_vccz L_nohp_77
s_mov_b32 s41, 0
L_hpoll_78:
buffer_load_dword v20, v21, s[8:11], s40 offen sc1
s_add_u32 s41, s41, 1
s_cmp_gt_u32 s41, 40000
s_cbranch_scc1 L_nohp_77
s_waitcnt vmcnt(0)
v_cmp_ne_u32 vcc, s59, v20
s_cbranch_vccnz L_hpoll_78
L_nohp_77:
s_barrier
ds_read_b128 v[112:115], v5 offset:0
s_mul_i32 s46, s16, 5120
v_mfma_f32_16x16x32_bf16 v[60:63], a[124:127], v[116:119], v[60:63]
s_waitcnt lgkmcnt(5)
s_add_u32 s47, s46, s22
v_mfma_f32_16x16x32_bf16 v[64:67], a[120:123], v[120:123], v[64:67]
ds_read_b128 v[116:119], v5 offset:1024
s_add_u32 s46, s46, 143360
v_mfma_f32_16x16x32_bf16 v[68:71], a[124:127], v[120:123], v[68:71]
s_waitcnt lgkmcnt(5)
s_add_u32 m0, s46, 0
v_mfma_f32_16x16x32_bf16 v[72:75], a[120:123], v[124:127], v[72:75]
ds_read_b128 v[120:123], v5 offset:2048
s_add_u32 s48, s47, 0
v_mfma_f32_16x16x32_bf16 v[76:79], a[124:127], v[124:127], v[76:79]
s_waitcnt lgkmcnt(5)
buffer_load_dwordx4 v1, s[8:11], s48 offen offset:0 sc1 lds
v_mfma_f32_16x16x32_bf16 v[80:83], a[120:123], v[128:131], v[80:83]
ds_read_b128 v[124:127], v5 offset:3072
buffer_load_dwordx4 v1, s[8:11], s48 offen offset:1024 sc1 lds
v_mfma_f32_16x16x32_bf16 v[84:87], a[124:127], v[128:131], v[84:87]
s_waitcnt lgkmcnt(5)
v_mfma_f32_16x16x32_bf16 v[88:91], a[120:123], v[104:107], v[88:91]
ds_read_b128 v[128:131], v5 offset:4096
buffer_load_dwordx4 v1, s[8:11], s48 offen offset:2048 sc1 lds
v_mfma_f32_16x16x32_bf16 v[92:95], a[124:127], v[104:107], v[92:95]
s_waitcnt lgkmcnt(5)
v_mfma_f32_16x16x32_bf16 v[96:99], a[120:123], v[108:111], v[96:99]
ds_read_b128 v[104:107], v5 offset:5120
v_mfma_f32_16x16x32_bf16 v[100:103], a[124:127], v[108:111], v[100:103]
s_waitcnt lgkmcnt(5)
v_mfma_f32_16x16x32_bf16 v[40:43], a[128:131], v[112:115], v[40:43]
ds_read_b128 v[108:111], v5 offset:6144
buffer_load_dwordx4 v1, s[8:11], s48 offen offset:3072 sc1 lds
v_mfma_f32_16x16x32_bf16 v[44:47], a[132:135], v[112:115], v[44:47]
s_waitcnt lgkmcnt(5)
v_mfma_f32_16x16x32_bf16 v[48:51], a[128:131], v[116:119], v[48:51]
ds_read_b128 v[112:115], v5 offset:7168
v_mfma_f32_16x16x32_bf16 v[52:55], a[132:135], v[116:119], v[52:55]
s_waitcnt lgkmcnt(5)
v_mfma_f32_16x16x32_bf16 v[56:59], a[128:131], v[120:123], v[56:59]
ds_read_b128 v[116:119], v5 offset:8192
s_add_u32 m0, s46, 4096
v_mfma_f32_16x16x32_bf16 v[60:63], a[132:135], v[120:123], v[60:63]
s_waitcnt lgkmcnt(5)
s_add_u32 s48, s47, 4096
v_mfma_f32_16x16x32_bf16 v[64:67], a[128:131], v[124:127], v[64:67]
ds_read_b128 v[120:123], v5 offset:9216
buffer_load_dwordx4 v1, s[8:11], s48 offen offset:0 sc1 lds
v_mfma_f32_16x16x32_bf16 v[68:71], a[132:135], v[124:127], v[68:71]
s_waitcnt lgkmcnt(5)
v_mfma_f32_16x16x32_bf16 v[72:75], a[128:131], v[128:131], v[72:75]
ds_read_b128 v[124:127], v5 offset:10240
buffer_load_dwordx4 v[20:23], v1, s[8:11], s24 offen sc1
v_mfma_f32_16x16x32_bf16 v[76:79], a[132:135], v[128:131], v[76:79]
s_waitcnt lgkmcnt(5)
v_mfma_f32_16x16x32_bf16 v[80:83], a[128:131], v[104:107], v[80:83]
ds_read_b128 v[128:131], v5 offset:11264
v_mfma_f32_16x16x32_bf16 v[84:87], a[132:135], v[104:107], v[84:87]
s_waitcnt lgkmcnt(5)
v_mfma_f32_16x16x32_bf16 v[88:91], a[128:131], v[108:111], v[88:91]
ds_read_b128 v[104:107], v5 offset:12288
v_mfma_f32_16x16x32_bf16 v[92:95], a[132:135], v[108:111], v[92:95]
s_waitcnt lgkmcnt(5)
v_mfma_f32_16x16x32_bf16 v[96:99], a[128:131], v[112:115], v[96:99]
ds_read_b128 v[108:111], v5 offset:13312
v_mfma_f32_16x16x32_bf16 v[100:103], a[132:135], v[112:115], v[100:103]
s_waitcnt lgkmcnt(5) vmcnt(10)
v_mfma_f32_16x16x32_bf16 v[40:43], a[136:139], v[116:119], v[40:43]
ds_read_b128 v[112:115], v5 offset:14336
v_mfma_f32_16x16x32_bf16 v[44:47], a[140:143], v[116:119], v[44:47]
s_waitcnt lgkmcnt(5)
v_mfma_f32_16x16x32_bf16 v[48:51], a[136:139], v[120:123], v[48:51]
ds_read_b128 v[116:119], v5 offset:15360
v_mfma_f32_16x16x32_bf16 v[52:55], a[140:143], v[120:123], v[52:55]
s_waitcnt lgkmcnt(5)
v_mfma_f32_16x16x32_bf16 v[56:59], a[136:139], v[124:127], v[56:59]
ds_read_b128 v[120:123], v5 offset:16384
v_mfma_f32_16x16x32_bf16 v[60:63], a[140:143], v[124:127], v[60:63]
s_waitcnt lgkmcnt(5)
v_mfma_f32_16x16x32_bf16 v[64:67], a[136:139], v[128:131], v[64:67]
ds_read_b128 v[124:127], v5 offset:17408
v_mfma_f32_16x16x32_bf16 v[68:71], a[140:143], v[128:131], v[68:71]
s_waitcnt lgkmcnt(5)
v_mfma_f32_16x16x32_bf16 v[72:75], a[136:139], v[104:107], v[72:75]
ds_read_b128 v[128:131], v5 offset:18432
v_mfma_f32_16x16x32_bf16 v[76:79], a[140:143], v[104:107], v[76:79]
s_waitcnt lgkmcnt(5)
v_mfma_f32_16x16x32_bf16 v[80:83], a[136:139], v[108:111], v[80:83]
ds_read_b128 v[104:107], v5 offset:19456
v_mfma_f32_16x16x32_bf16 v[84:87], a[140:143], v[108:111], v[84:87]
s_waitcnt lgkmcnt(5)
v_mfma_f32_16x16x32_bf16 v[88:91], a[136:139], v[112:115], v[88:91]
ds_read_b128 v[108:111], v5 offset:20480
v_mfma_f32_16x16x32_bf16 v[92:95], a[140:143], v[112:115], v[92:95]
s_waitcnt lgkmcnt(5)
v_mfma_f32_16x16x32_bf16 v[96:99], a[136:139], v[116:119], v[96:99]
ds_read_b128 v[112:115], v5 offset:21504
v_mfma_f32_16x16x32_bf16 v[100:103], a[140:143], v[116:119], v[100:103]
s_waitcnt lgkmcnt(5) vmcnt(8)
v_mfma_f32_16x16x32_bf16 v[40:43], a[144:147], v[120:123], v[40:43]
ds_read_b128 v[116:119], v5 offset:22528
v_mfma_f32_16x16x32_bf16 v[44:47], a[148:151], v[120:123], v[44:47]
s_waitcnt lgkmcnt(5)
v_mfma_f32_16x16x32_bf16 v[48:51], a[144:147], v[124:127], v[48:51]
ds_read_b128 v[120:123], v5 offset:23552
v_mfma_f32_16x16x32_bf16 v[52:55], a[148:151], v[124:127], v[52:55]
s_waitcnt lgkmcnt(5)
v_mfma_f32_16x16x32_bf16 v[56:59], a[144:147], v[128:131], v[56:59]
ds_read_b128 v[124:127], v5 offset:24576
v_mfma_f32_16x16x32_bf16 v[60:63], a[148:151], v[128:131], v[60:63]
s_waitcnt lgkmcnt(5)
v_mfma_f32_16x16x32_bf16 v[64:67], a[144:147], v[104:107], v[64:67]
ds_read_b128 v[128:131], v5 offset:25600
v_mfma_f32_16x16x32_bf16 v[68:71], a[148:151], v[104:107], v[68:71]
s_waitcnt lgkmcnt(5)
v_mfma_f32_16x16x32_bf16 v[72:75], a[144:147], v[108:111], v[72:75]
ds_read_b128 v[104:107], v5 offset:26624
v_mfma_f32_16x16x32_bf16 v[76:79], a[148:151], v[108:111], v[76:79]
s_waitcnt lgkmcnt(5)
v_mfma_f32_16x16x32_bf16 v[80:83], a[144:147], v[112:115], v[80:83]
ds_read_b128 v[108:111], v5 offset:27648
v_mfma_f32_16x16x32_bf16 v[84:87], a[148:151], v[112:115], v[84:87]
s_waitcnt lgkmcnt(5)
v_mfma_f32_16x16x32_bf16 v[88:91], a[144:147], v[116:119], v[88:91]
ds_read_b128 v[112:115], v5 offset:28672
v_mfma_f32_16x16x32_bf16 v[92:95], a[148:151], v[116:119], v[92:95]
s_waitcnt lgkmcnt(5)
v_mfma_f32_16x16x32_bf16 v[96:99], a[144:147], v[120:123], v[96:99]
ds_read_b128 v[116:119], v5 offset:29696
v_mfma_f32_16x16x32_bf16 v[100:103], a[148:151], v[120:123], v[100:103]
s_waitcnt lgkmcnt(5) vmcnt(6)
v_mfma_f32_16x16x32_bf16 v[40:43], a[152:155], v[124:127], v[40:43]
ds_read_b128 v[120:123], v5 offset:30720
v_mfma_f32_16x16x32_bf16 v[44:47], a[156:159], v[124:127], v[44:47]
s_waitcnt lgkmcnt(5)
v_mfma_f32_16x16x32_bf16 v[48:51], a[152:155], v[128:131], v[48:51]
ds_read_b128 v[124:127], v5 offset:31744
v_mfma_f32_16x16x32_bf16 v[52:55], a[156:159], v[128:131], v[52:55]
s_waitcnt lgkmcnt(5)
v_mfma_f32_16x16x32_bf16 v[56:59], a[152:155], v[104:107], v[56:59]
s_waitcnt vmcnt(0)
s_barrier
ds_read_b128 v[128:131], v7 offset:0
v_mfma_f32_16x16x32_bf16 v[60:63], a[156:159], v[104:107], v[60:63]
s_waitcnt lgkmcnt(5)
v_mfma_f32_16x16x32_bf16 v[64:67], a[152:155], v[108:111], v[64:67]
ds_read_b128 v[104:107], v7 offset:1024
v_mfma_f32_16x16x32_bf16 v[68:71], a[156:159], v[108:111], v[68:71]
s_waitcnt lgkmcnt(5)
v_mfma_f32_16x16x32_bf16 v[72:75], a[152:155], v[112:115], v[72:75]
ds_read_b128 v[108:111], v7 offset:2048
v_mfma_f32_16x16x32_bf16 v[76:79], a[156:159], v[112:115], v[76:79]
s_waitcnt lgkmcnt(5)
v_mfma_f32_16x16x32_bf16 v[80:83], a[152:155], v[116:119], v[80:83]
ds_read_b128 v[112:115], v7 offset:3072
v_mfma_f32_16x16x32_bf16 v[84:87], a[156:159], v[116:119], v[84:87]
s_waitcnt lgkmcnt(5)
v_mfma_f32_16x16x32_bf16 v[88:91], a[152:155], v[120:123], v[88:91]
ds_read_b128 v[116:119], v7 offset:4096
v_mfma_f32_16x16x32_bf16 v[92:95], a[156:159], v[120:123], v[92:95]
s_waitcnt lgkmcnt(5)
v_mfma_f32_16x16x32_bf16 v[96:99], a[152:155], v[124:127], v[96:99]
ds_read_b128 v[120:123], v7 offset:5120
v_mfma_f32_16x16x32_bf16 v[100:103], a[156:159], v[124:127], v[100:103]
s_waitcnt lgkmcnt(5)
v_mfma_f32_16x16x32_bf16 v[32:35], a[0:3], v[128:131], 0
ds_read_b128 v[124:127], v7 offset:6144
v_mfma_f32_16x16x32_bf16 v[36:39], a[4:7], v[128:131], 0
s_waitcnt lgkmcnt(5)
v_mfma_f32_16x16x32_bf16 v[32:35], a[8:11], v[104:107], v[32:35]
ds_read_b128 v[128:131], v7 offset:7168
v_mfma_f32_16x16x32_bf16 v[36:39], a[12:15], v[104:107], v[36:39]
s_waitcnt lgkmcnt(5)
v_mfma_f32_16x16x32_bf16 v[32:35], a[16:19], v[108:111], v[32:35]
ds_read_b128 v[104:107], v7 offset:8192
v_mfma_f32_16x16x32_bf16 v[36:39], a[20:23], v[108:111], v[36:39]
s_waitcnt lgkmcnt(5)
v_mfma_f32_16x16x32_bf16 v[32:35], a[24:27], v[112:115], v[32:35]
ds_read_b128 v[108:111], v7 offset:9216
v_mfma_f32_16x16x32_bf16 v[36:39], a[28:31], v[112:115], v[36:39]
s_waitcnt lgkmcnt(5)
v_mfma_f32_16x16x32_bf16 v[32:35], a[32:35], v[116:119], v[32:35]
ds_read_b128 v[112:115], v7 offset:10240
v_mfma_f32_16x16x32_bf16 v[36:39], a[36:39], v[116:119], v[36:39]
s_waitcnt lgkmcnt(5)
v_mfma_f32_16x16x32_bf16 v[32:35], a[40:43], v[120:123], v[32:35]
ds_read_b128 v[116:119], v7 offset:11264
v_mfma_f32_16x16x32_bf16 v[36:39], a[44:47], v[120:123], v[36:39]
s_waitcnt lgkmcnt(5)
v_mfma_f32_16x16x32_bf16 v[32:35], a[48:51], v[124:127], v[32:35]
ds_read_b128 v[120:123], v7 offset:12288
v_mfma_f32_16x16x32_bf16 v[36:39], a[52:55], v[124:127], v[36:39]
s_waitcnt lgkmcnt(5)
v_mfma_f32_16x16x32_bf16 v[32:35], a[56:59], v[128:131], v[32:35]
ds_read_b128 v[124:127], v7 offset:13312
v_mfma_f32_16x16x32_bf16 v[36:39], a[60:63], v[128:131], v[36:39]
s_waitcnt lgkmcnt(5)
v_mfma_f32_16x16x32_bf16 v[32:35], a[64:67], v[104:107], v[32:35]
ds_read_b128 v[128:131], v7 offset:14336
v_mfma_f32_16x16x32_bf16 v[36:39], a[68:71], v[104:107], v[36:39]
s_waitcnt lgkmcnt(5)
v_mfma_f32_16x16x32_bf16 v[32:35], a[72:75], v[108:111], v[32:35]
ds_read_b128 v[104:107], v7 offset:15360
v_mfma_f32_16x16x32_bf16 v[36:39], a[76:79], v[108:111], v[36:39]
s_waitcnt lgkmcnt(5)
v_mfma_f32_16x16x32_bf16 v[32:35], a[80:83], v[112:115], v[32:35]
ds_read_b128 v[108:111], v7 offset:16384
v_mfma_f32_16x16x32_bf16 v[36:39], a[84:87], v[112:115], v[36:39]
s_waitcnt lgkmcnt(5)
v_mfma_f32_16x16x32_bf16 v[32:35], a[88:91], v[116:119], v[32:35]
ds_read_b128 v[112:115], v7 offset:17408
v_mfma_f32_16x16x32_bf16 v[36:39], a[92:95], v[116:119], v[36:39]
s_waitcnt lgkmcnt(5)
v_mfma_f32_16x16x32_bf16 v[32:35], a[96:99], v[120:123], v[32:35]
ds_read_b128 v[116:119], v7 offset:18432
v_mfma_f32_16x16x32_bf16 v[36:39], a[100:103], v[120:123], v[36:39]
s_waitcnt lgkmcnt(5)
v_mfma_f32_16x16x32_bf16 v[32:35], a[104:107], v[124:127], v[32:35]
ds_read_b128 v[120:123], v7 offset:19456
v_mfma_f32_16x16x32_bf16 v[36:39], a[108:111], v[124:127], v[36:39]
s_waitcnt lgkmcnt(5)
v_mfma_f32_16x16x32_bf16 v[32:35], a[112:115], v[128:131], v[32:35]
v_mfma_f32_16x16x32_bf16 v[36:39], a[116:119], v[128:131], v[36:39]
s_waitcnt lgkmcnt(4)
v_mfma_f32_16x16x32_bf16 v[32:35], a[120:123], v[104:107], v[32:35]
v_mfma_f32_16x16x32_bf16 v[36:39], a[124:127], v[104:107], v[36:39]
s_waitcnt lgkmcnt(3)
v_mfma_f32_16x16x32_bf16 v[32:35], a[128:131], v[108:111], v[32:35]
v_mfma_f32_16x16x32_bf16 v[36:39], a[132:135], v[108:111], v[36:39]
s_waitcnt lgkmcnt(2)
v_mfma_f32_16x16x32_bf16 v[32:35], a[136:139], v[112:115], v[32:35]
v_mfma_f32_16x16x32_bf16 v[36:39], a[140:143], v[112:115], v[36:39]
s_waitcnt lgkmcnt(1)
v_mfma_f32_16x16x32_bf16 v[32:35], a[144:147], v[116:119], v[32:35]
v_mfma_f32_16x16x32_bf16 v[36:39], a[148:151], v[116:119], v[36:39]
s_waitcnt lgkmcnt(0)
v_mfma_f32_16x16x32_bf16 v[32:35], a[152:155], v[120:123], v[32:35]
v_mfma_f32_16x16x32_bf16 v[36:39], a[156:159], v[120:123], v[36:39]
v_add_f32 v24, v20, v22
v_add_f32 v25, v21, v23
v_mov_b32 v28, v24
v_mov_b32 v29, v25
s_nop 1
v_permlane16_swap_b32 v24, v28
v_permlane16_swap_b32 v25, v29
s_nop 1
v_add_f32 v24, v24, v28
v_add_f32 v25, v25, v29
v_mov_b32 v28, v24
v_mov_b32 v29, v25
s_nop 1
v_permlane32_swap_b32 v24, v28
v_permlane32_swap_b32 v25, v29
s_nop 1
v_add_f32 v24, v24, v28
v_add_f32 v25, v25, v29
v_mul_f32 v24, 0.0015625, v24
v_mul_f32 v25, 0.0015625, v25
v_fma_f32 v25, -v24, v24, v25
v_max_f32 v25, 0, v25
v_add_f32 v25, 0x3727c5ac, v25
v_rsq_f32 v25, v25
s_nop 0
v_lshlrev_b32 v16, 3, v3
v_add_u32 v16, 131072, v16
s_mov_b64 s[38:39], exec
s_mov_b64 exec, 0xffff
ds_write_b64 v16, v[24:25]
s_mov_b64 exec, s[38:39]
s_waitcnt lgkmcnt(0)
s_barrier
s_mul_i32 s46, s98, 102400
s_mul_i32 s47, s16, 25600
s_add_u32 s46, s46, s47
s_add_u32 s46, s46, 2621440
s_add_u32 s47, s47, 57344
v_lshlrev_b32 v7, 3, v3
v_add_u32 v7, 131072, v7
ds_read_b64 v[104:105], v7 offset:0
ds_read_b64 v[106:107], v7 offset:128
ds_read_b64 v[108:109], v7 offset:256
ds_read_b64 v[110:111], v7 offset:384
ds_read_b64 v[112:113], v7 offset:512
ds_read_b64 v[114:115], v7 offset:640
ds_read_b64 v[116:117], v7 offset:768
ds_read_b64 v[118:119], v7 offset:896
ds_read_b64 v[120:121], v7 offset:1024
v_accvgpr_read_b32 v124, a236
v_accvgpr_read_b32 v125, a237
v_accvgpr_read_b32 v126, a238
v_accvgpr_read_b32 v127, a239
v_accvgpr_read_b32 v128, a240
v_accvgpr_read_b32 v129, a241
v_accvgpr_read_b32 v130, a242
v_accvgpr_read_b32 v131, a243
s_waitcnt lgkmcnt(0)
s_nop 0
v_pk_fma_f32 v[32:33], v[124:125], v[104:105], v[32:33] op_sel_hi:[1,0,1] neg_lo:[0,1,0] neg_hi:[0,1,0]
v_pk_fma_f32 v[34:35], v[126:127], v[104:105], v[34:35] op_sel_hi:[1,0,1] neg_lo:[0,1,0] neg_hi:[0,1,0]
v_pk_mul_f32 v[32:33], v[32:33], v[104:105] op_sel:[0,1] op_sel_hi:[1,1]
v_pk_mul_f32 v[34:35], v[34:35], v[104:105] op_sel:[0,1] op_sel_hi:[1,1]
v_cvt_pk_bf16_f32 v32, v32, v33
v_cvt_pk_bf16_f32 v33, v34, v35
ds_write_b64 v252, v[32:33] offset:0
v_pk_fma_f32 v[36:37], v[128:129], v[104:105], v[36:37] op_sel_hi:[1,0,1] neg_lo:[0,1,0] neg_hi:[0,1,0]
v_pk_fma_f32 v[38:39], v[130:131], v[104:105], v[38:39] op_sel_hi:[1,0,1] neg_lo:[0,1,0] neg_hi:[0,1,0]
v_pk_mul_f32 v[36:37], v[36:37], v[104:105] op_sel:[0,1] op_sel_hi:[1,1]
v_pk_mul_f32 v[38:39], v[38:39], v[104:105] op_sel:[0,1] op_sel_hi:[1,1]
v_cvt_pk_bf16_f32 v36, v36, v37
v_cvt_pk_bf16_f32 v37, v38, v39
ds_write_b64 v253, v[36:37] offset:0
v_pk_fma_f32 v[40:41], v[124:125], v[106:107], v[40:41] op_sel_hi:[1,0,1] neg_lo:[0,1,0] neg_hi:[0,1,0]
v_pk_fma_f32 v[42:43], v[126:127], v[106:107], v[42:43] op_sel_hi:[1,0,1] neg_lo:[0,1,0] neg_hi:[0,1,0]
v_pk_mul_f32 v[40:41], v[40:41], v[106:107] op_sel:[0,1] op_sel_hi:[1,1]
v_pk_mul_f32 v[42:43], v[42:43], v[106:107] op_sel:[0,1] op_sel_hi:[1,1]
v_cvt_pk_bf16_f32 v40, v40, v41
v_cvt_pk_bf16_f32 v41, v42, v43
ds_write_b64 v252, v[40:41] offset:4864
v_pk_fma_f32 v[44:45], v[128:129], v[106:107], v[44:45] op_sel_hi:[1,0,1] neg_lo:[0,1,0] neg_hi:[0,1,0]
v_pk_fma_f32 v[46:47], v[130:131], v[106:107], v[46:47] op_sel_hi:[1,0,1] neg_lo:[0,1,0] neg_hi:[0,1,0]
v_pk_mul_f32 v[44:45], v[44:45], v[106:107] op_sel:[0,1] op_sel_hi:[1,1]
v_pk_mul_f32 v[46:47], v[46:47], v[106:107] op_sel:[0,1] op_sel_hi:[1,1]
v_cvt_pk_bf16_f32 v44, v44, v45
v_cvt_pk_bf16_f32 v45, v46, v47
ds_write_b64 v253, v[44:45] offset:4864
v_pk_fma_f32 v[48:49], v[124:125], v[108:109], v[48:49] op_sel_hi:[1,0,1] neg_lo:[0,1,0] neg_hi:[0,1,0]
v_pk_fma_f32 v[50:51], v[126:127], v[108:109], v[50:51] op_sel_hi:[1,0,1] neg_lo:[0,1,0] neg_hi:[0,1,0]
v_pk_mul_f32 v[48:49], v[48:49], v[108:109] op_sel:[0,1] op_sel_hi:[1,1]
v_pk_mul_f32 v[50:51], v[50:51], v[108:109] op_sel:[0,1] op_sel_hi:[1,1]
v_cvt_pk_bf16_f32 v48, v48, v49
v_cvt_pk_bf16_f32 v49, v50, v51
ds_write_b64 v252, v[48:49] offset:9728
v_pk_fma_f32 v[52:53], v[128:129], v[108:109], v[52:53] op_sel_hi:[1,0,1] neg_lo:[0,1,0] neg_hi:[0,1,0]
v_pk_fma_f32 v[54:55], v[130:131], v[108:109], v[54:55] op_sel_hi:[1,0,1] neg_lo:[0,1,0] neg_hi:[0,1,0]
v_pk_mul_f32 v[52:53], v[52:53], v[108:109] op_sel:[0,1] op_sel_hi:[1,1]
v_pk_mul_f32 v[54:55], v[54:55], v[108:109] op_sel:[0,1] op_sel_hi:[1,1]
v_cvt_pk_bf16_f32 v52, v52, v53
v_cvt_pk_bf16_f32 v53, v54, v55
ds_write_b64 v253, v[52:53] offset:9728
v_pk_fma_f32 v[56:57], v[124:125], v[110:111], v[56:57] op_sel_hi:[1,0,1] neg_lo:[0,1,0] neg_hi:[0,1,0]
v_pk_fma_f32 v[58:59], v[126:127], v[110:111], v[58:59] op_sel_hi:[1,0,1] neg_lo:[0,1,0] neg_hi:[0,1,0]
v_pk_mul_f32 v[56:57], v[56:57], v[110:111] op_sel:[0,1] op_sel_hi:[1,1]
v_pk_mul_f32 v[58:59], v[58:59], v[110:111] op_sel:[0,1] op_sel_hi:[1,1]
v_cvt_pk_bf16_f32 v56, v56, v57
v_cvt_pk_bf16_f32 v57, v58, v59
ds_write_b64 v252, v[56:57] offset:14592
v_pk_fma_f32 v[60:61], v[128:129], v[110:111], v[60:61] op_sel_hi:[1,0,1] neg_lo:[0,1,0] neg_hi:[0,1,0]
v_pk_fma_f32 v[62:63], v[130:131], v[110:111], v[62:63] op_sel_hi:[1,0,1] neg_lo:[0,1,0] neg_hi:[0,1,0]
v_pk_mul_f32 v[60:61], v[60:61], v[110:111] op_sel:[0,1] op_sel_hi:[1,1]
v_pk_mul_f32 v[62:63], v[62:63], v[110:111] op_sel:[0,1] op_sel_hi:[1,1]
v_cvt_pk_bf16_f32 v60, v60, v61
v_cvt_pk_bf16_f32 v61, v62, v63
ds_write_b64 v253, v[60:61] offset:14592
v_pk_fma_f32 v[64:65], v[124:125], v[112:113], v[64:65] op_sel_hi:[1,0,1] neg_lo:[0,1,0] neg_hi:[0,1,0]
v_pk_fma_f32 v[66:67], v[126:127], v[112:113], v[66:67] op_sel_hi:[1,0,1] neg_lo:[0,1,0] neg_hi:[0,1,0]
v_pk_mul_f32 v[64:65], v[64:65], v[112:113] op_sel:[0,1] op_sel_hi:[1,1]
v_pk_mul_f32 v[66:67], v[66:67], v[112:113] op_sel:[0,1] op_sel_hi:[1,1]
v_cvt_pk_bf16_f32 v64, v64, v65
v_cvt_pk_bf16_f32 v65, v66, v67
ds_write_b64 v252, v[64:65] offset:19456
v_pk_fma_f32 v[68:69], v[128:129], v[112:113], v[68:69] op_sel_hi:[1,0,1] neg_lo:[0,1,0] neg_hi:[0,1,0]
v_pk_fma_f32 v[70:71], v[130:131], v[112:113], v[70:71] op_sel_hi:[1,0,1] neg_lo:[0,1,0] neg_hi:[0,1,0]
v_pk_mul_f32 v[68:69], v[68:69], v[112:113] op_sel:[0,1] op_sel_hi:[1,1]
v_pk_mul_f32 v[70:71], v[70:71], v[112:113] op_sel:[0,1] op_sel_hi:[1,1]
v_cvt_pk_bf16_f32 v68, v68, v69
v_cvt_pk_bf16_f32 v69, v70, v71
ds_write_b64 v253, v[68:69] offset:19456
v_pk_fma_f32 v[72:73], v[124:125], v[114:115], v[72:73] op_sel_hi:[1,0,1] neg_lo:[0,1,0] neg_hi:[0,1,0]
v_pk_fma_f32 v[74:75], v[126:127], v[114:115], v[74:75] op_sel_hi:[1,0,1] neg_lo:[0,1,0] neg_hi:[0,1,0]
v_pk_mul_f32 v[72:73], v[72:73], v[114:115] op_sel:[0,1] op_sel_hi:[1,1]
v_pk_mul_f32 v[74:75], v[74:75], v[114:115] op_sel:[0,1] op_sel_hi:[1,1]
v_cvt_pk_bf16_f32 v72, v72, v73
v_cvt_pk_bf16_f32 v73, v74, v75
ds_write_b64 v252, v[72:73] offset:24320
v_pk_fma_f32 v[76:77], v[128:129], v[114:115], v[76:77] op_sel_hi:[1,0,1] neg_lo:[0,1,0] neg_hi:[0,1,0]
v_pk_fma_f32 v[78:79], v[130:131], v[114:115], v[78:79] op_sel_hi:[1,0,1] neg_lo:[0,1,0] neg_hi:[0,1,0]
v_pk_mul_f32 v[76:77], v[76:77], v[114:115] op_sel:[0,1] op_sel_hi:[1,1]
v_pk_mul_f32 v[78:79], v[78:79], v[114:115] op_sel:[0,1] op_sel_hi:[1,1]
v_cvt_pk_bf16_f32 v76, v76, v77
v_cvt_pk_bf16_f32 v77, v78, v79
ds_write_b64 v253, v[76:77] offset:24320
v_pk_fma_f32 v[80:81], v[124:125], v[116:117], v[80:81] op_sel_hi:[1,0,1] neg_lo:[0,1,0] neg_hi:[0,1,0]
v_pk_fma_f32 v[82:83], v[126:127], v[116:117], v[82:83] op_sel_hi:[1,0,1] neg_lo:[0,1,0] neg_hi:[0,1,0]
v_pk_mul_f32 v[80:81], v[80:81], v[116:117] op_sel:[0,1] op_sel_hi:[1,1]
v_pk_mul_f32 v[82:83], v[82:83], v[116:117] op_sel:[0,1] op_sel_hi:[1,1]
v_cvt_pk_bf16_f32 v80, v80, v81
v_cvt_pk_bf16_f32 v81, v82, v83
ds_write_b64 v252, v[80:81] offset:29184
v_pk_fma_f32 v[84:85], v[128:129], v[116:117], v[84:85] op_sel_hi:[1,0,1] neg_lo:[0,1,0] neg_hi:[0,1,0]
v_pk_fma_f32 v[86:87], v[130:131], v[116:117], v[86:87] op_sel_hi:[1,0,1] neg_lo:[0,1,0] neg_hi:[0,1,0]
v_pk_mul_f32 v[84:85], v[84:85], v[116:117] op_sel:[0,1] op_sel_hi:[1,1]
v_pk_mul_f32 v[86:87], v[86:87], v[116:117] op_sel:[0,1] op_sel_hi:[1,1]
v_cvt_pk_bf16_f32 v84, v84, v85
v_cvt_pk_bf16_f32 v85, v86, v87
ds_write_b64 v253, v[84:85] offset:29184
v_pk_fma_f32 v[88:89], v[124:125], v[118:119], v[88:89] op_sel_hi:[1,0,1] neg_lo:[0,1,0] neg_hi:[0,1,0]
v_pk_fma_f32 v[90:91], v[126:127], v[118:119], v[90:91] op_sel_hi:[1,0,1] neg_lo:[0,1,0] neg_hi:[0,1,0]
v_pk_mul_f32 v[88:89], v[88:89], v[118:119] op_sel:[0,1] op_sel_hi:[1,1]
v_pk_mul_f32 v[90:91], v[90:91], v[118:119] op_sel:[0,1] op_sel_hi:[1,1]
v_cvt_pk_bf16_f32 v88, v88, v89
v_cvt_pk_bf16_f32 v89, v90, v91
ds_write_b64 v252, v[88:89] offset:34048
v_pk_fma_f32 v[92:93], v[128:129], v[118:119], v[92:93] op_sel_hi:[1,0,1] neg_lo:[0,1,0] neg_hi:[0,1,0]
v_pk_fma_f32 v[94:95], v[130:131], v[118:119], v[94:95] op_sel_hi:[1,0,1] neg_lo:[0,1,0] neg_hi:[0,1,0]
v_pk_mul_f32 v[92:93], v[92:93], v[118:119] op_sel:[0,1] op_sel_hi:[1,1]
v_pk_mul_f32 v[94:95], v[94:95], v[118:119] op_sel:[0,1] op_sel_hi:[1,1]
v_cvt_pk_bf16_f32 v92, v92, v93
v_cvt_pk_bf16_f32 v93, v94, v95
ds_write_b64 v253, v[92:93] offset:34048
v_pk_fma_f32 v[96:97], v[124:125], v[120:121], v[96:97] op_sel_hi:[1,0,1] neg_lo:[0,1,0] neg_hi:[0,1,0]
v_pk_fma_f32 v[98:99], v[126:127], v[120:121], v[98:99] op_sel_hi:[1,0,1] neg_lo:[0,1,0] neg_hi:[0,1,0]
v_pk_mul_f32 v[96:97], v[96:97], v[120:121] op_sel:[0,1] op_sel_hi:[1,1]
v_pk_mul_f32 v[98:99], v[98:99], v[120:121] op_sel:[0,1] op_sel_hi:[1,1]
v_cvt_pk_bf16_f32 v96, v96, v97
v_cvt_pk_bf16_f32 v97, v98, v99
ds_write_b64 v252, v[96:97] offset:38912
v_pk_fma_f32 v[100:101], v[128:129], v[120:121], v[100:101] op_sel_hi:[1,0,1] neg_lo:[0,1,0] neg_hi:[0,1,0]
v_pk_fma_f32 v[102:103], v[130:131], v[120:121], v[102:103] op_sel_hi:[1,0,1] neg_lo:[0,1,0] neg_hi:[0,1,0]
v_pk_mul_f32 v[100:101], v[100:101], v[120:121] op_sel:[0,1] op_sel_hi:[1,1]
v_pk_mul_f32 v[102:103], v[102:103], v[120:121] op_sel:[0,1] op_sel_hi:[1,1]
v_cvt_pk_bf16_f32 v100, v100, v101
v_cvt_pk_bf16_f32 v101, v102, v103
ds_write_b64 v253, v[100:101] offset:38912
s_waitcnt lgkmcnt(0)
s_barrier
s_and_b32 s36, s16, 1
s_lshr_b32 s37, s16, 1
s_lshl_b32 s40, s36, 6
v_add_u32 v8, s40, v2
v_add_u32 v9, 2, v8
v_mul_u32_u24 v9, 304, v9
s_mul_i32 s41, s37, 144
v_add_u32 v9, s41, v9
s_lshl_b32 s41, s17, 7
v_add_u32 v10, s41, v8
ds_read_b128 v[192:195], v9 offset:4256
ds_read_b128 v[196:199], v9 offset:4272
ds_read_b64 v[200:201], v9 offset:4288
ds_read_b128 v[32:35], v9 offset:4304
ds_read_b128 v[36:39], v9 offset:4320
ds_read_b64 v[40:41], v9 offset:4336
ds_read_b128 v[42:45], v9 offset:3696
ds_read_b128 v[46:49], v9 offset:3712
ds_read_b64 v[50:51], v9 offset:3728
ds_read_b128 v[52:55], v9 offset:3088
s_add_u32 m0, s47, 0
s_add_u32 s48, s46, 0
buffer_load_dwordx4 v1, s[8:11], s48 offen offset:0 lds
ds_read_b128 v[56:59], v9 offset:3104
ds_read_b64 v[60:61], v9 offset:3120
ds_read_b128 v[62:65], v9 offset:2480
ds_read_b128 v[66:69], v9 offset:2496
ds_read_b64 v[70:71], v9 offset:2512
v_mov_b32 v11, 0xf149f2ca
v_mov_b32 v13, 0.3225964182229561
s_mov_b32 s42, 0x05040100
s_mov_b32 s43, 0x07060302
s_waitcnt lgkmcnt(9)
s_nop 0
buffer_load_dwordx4 v1, s[8:11], s48 offen offset:1024 lds
ds_read_b128 v[72:75], v9 offset:1872
ds_read_b128 v[76:79], v9 offset:1888
ds_read_b64 v[80:81], v9 offset:1904
v_dot2_f32_bf16 v204, v192, v32, 0
v_dot2_f32_bf16 v204, v193, v33, v204
v_dot2_f32_bf16 v204, v194, v34, v204
v_dot2_f32_bf16 v204, v195, v35, v204
v_dot2_f32_bf16 v204, v196, v36, v204
v_dot2_f32_bf16 v204, v197, v37, v204
v_dot2_f32_bf16 v204, v198, v38, v204
v_dot2_f32_bf16 v204, v199, v39, v204
buffer_load_dwordx4 v1, s[8:11], s48 offen offset:2048 lds
v_dot2_f32_bf16 v204, v200, v40, v204
v_dot2_f32_bf16 v204, v201, v41, v204
s_waitcnt lgkmcnt(9)
s_nop 0
ds_read_b128 v[82:85], v9 offset:1264
ds_read_b128 v[86:89], v9 offset:1280
ds_read_b64 v[90:91], v9 offset:1296
v_dot2_f32_bf16 v205, v192, v42, 0
v_dot2_f32_bf16 v205, v193, v43, v205
v_dot2_f32_bf16 v205, v194, v44, v205
v_dot2_f32_bf16 v205, v195, v45, v205
v_dot2_f32_bf16 v205, v196, v46, v205
buffer_load_dwordx4 v1, s[8:11], s48 offen offset:3072 lds
v_dot2_f32_bf16 v205, v197, v47, v205
v_dot2_f32_bf16 v205, v198, v48, v205
v_dot2_f32_bf16 v205, v199, v49, v205
v_dot2_f32_bf16 v205, v200, v50, v205
v_dot2_f32_bf16 v205, v201, v51, v205
s_waitcnt lgkmcnt(9)
s_nop 0
ds_read_b128 v[92:95], v9 offset:656
ds_read_b128 v[96:99], v9 offset:672
ds_read_b64 v[100:101], v9 offset:688
v_dot2_f32_bf16 v206, v192, v52, 0
v_dot2_f32_bf16 v206, v193, v53, v206
s_add_u32 m0, s47, 4096
s_add_u32 s48, s46, 4096
buffer_load_dwordx4 v1, s[8:11], s48 offen offset:0 lds
v_dot2_f32_bf16 v206, v194, v54, v206
v_dot2_f32_bf16 v206, v195, v55, v206
v_dot2_f32_bf16 v206, v196, v56, v206
v_dot2_f32_bf16 v206, v197, v57, v206
v_dot2_f32_bf16 v206, v198, v58, v206
v_dot2_f32_bf16 v206, v199, v59, v206
v_dot2_f32_bf16 v206, v200, v60, v206
v_dot2_f32_bf16 v206, v201, v61, v206
s_waitcnt lgkmcnt(9)
s_nop 0
ds_read_b128 v[102:105], v9 offset:48
ds_read_b128 v[106:109], v9 offset:64
buffer_load_dwordx4 v1, s[8:11], s48 offen offset:1024 lds
ds_read_b64 v[110:111], v9 offset:80
v_dot2_f32_bf16 v207, v192, v62, 0
v_dot2_f32_bf16 v207, v193, v63, v207
v_dot2_f32_bf16 v207, v194, v64, v207
v_dot2_f32_bf16 v207, v195, v65, v207
v_dot2_f32_bf16 v207, v196, v66, v207
v_dot2_f32_bf16 v207, v197, v67, v207
v_dot2_f32_bf16 v207, v198, v68, v207
v_dot2_f32_bf16 v207, v199, v69, v207
v_dot2_f32_bf16 v207, v200, v70, v207
v_dot2_f32_bf16 v207, v201, v71, v207
buffer_load_dwordx4 v1, s[8:11], s48 offen offset:2048 lds
s_waitcnt lgkmcnt(9)
s_nop 0
ds_read_b128 v[112:115], v9 offset:4352
ds_read_b128 v[116:119], v9 offset:4368
ds_read_b64 v[120:121], v9 offset:4384
v_dot2_f32_bf16 v208, v192, v72, 0
v_dot2_f32_bf16 v208, v193, v73, v208
v_dot2_f32_bf16 v208, v194, v74, v208
v_dot2_f32_bf16 v208, v195, v75, v208
v_dot2_f32_bf16 v208, v196, v76, v208
v_dot2_f32_bf16 v208, v197, v77, v208
v_dot2_f32_bf16 v208, v198, v78, v208
buffer_load_dwordx4 v1, s[8:11], s48 offen offset:3072 lds
v_dot2_f32_bf16 v208, v199, v79, v208
v_dot2_f32_bf16 v208, v200, v80, v208
v_dot2_f32_bf16 v208, v201, v81, v208
s_waitcnt lgkmcnt(9)
s_nop 0
ds_read_b128 v[122:125], v9 offset:3744
ds_read_b128 v[126:129], v9 offset:3760
ds_read_b64 v[130:131], v9 offset:3776
v_dot2_f32_bf16 v209, v192, v82, 0
v_dot2_f32_bf16 v209, v193, v83, v209
v_dot2_f32_bf16 v209, v194, v84, v209
v_dot2_f32_bf16 v209, v195, v85, v209
s_add_u32 m0, s47, 8192
s_add_u32 s48, s46, 8192
buffer_load_dwordx4 v1, s[8:11], s48 offen offset:0 lds
v_dot2_f32_bf16 v209, v196, v86, v209
v_dot2_f32_bf16 v209, v197, v87, v209
v_dot2_f32_bf16 v209, v198, v88, v209
v_dot2_f32_bf16 v209, v199, v89, v209
v_dot2_f32_bf16 v209, v200, v90, v209
v_dot2_f32_bf16 v209, v201, v91, v209
s_waitcnt lgkmcnt(9)
s_nop 0
ds_read_b128 v[132:135], v9 offset:3136
ds_read_b128 v[136:139], v9 offset:3152
ds_read_b64 v[140:141], v9 offset:3168
buffer_load_dwordx4 v1, s[8:11], s48 offen offset:1024 lds
v_dot2_f32_bf16 v210, v192, v92, 0
v_dot2_f32_bf16 v210, v193, v93, v210
v_dot2_f32_bf16 v210, v194, v94, v210
v_dot2_f32_bf16 v210, v195, v95, v210
v_dot2_f32_bf16 v210, v196, v96, v210
v_dot2_f32_bf16 v210, v197, v97, v210
v_dot2_f32_bf16 v210, v198, v98, v210
v_dot2_f32_bf16 v210, v199, v99, v210
v_dot2_f32_bf16 v210, v200, v100, v210
v_dot2_f32_bf16 v210, v201, v101, v210
s_waitcnt lgkmcnt(9)
s_nop 0
buffer_load_dwordx4 v1, s[8:11], s48 offen offset:2048 lds
ds_read_b128 v[142:145], v9 offset:2528
ds_read_b128 v[146:149], v9 offset:2544
ds_read_b64 v[150:151], v9 offset:2560
v_dot2_f32_bf16 v211, v192, v102, 0
v_dot2_f32_bf16 v211, v193, v103, v211
v_dot2_f32_bf16 v211, v194, v104, v211
v_dot2_f32_bf16 v211, v195, v105, v211
v_dot2_f32_bf16 v211, v196, v106, v211
v_dot2_f32_bf16 v211, v197, v107, v211
v_dot2_f32_bf16 v211, v198, v108, v211
v_dot2_f32_bf16 v211, v199, v109, v211
buffer_load_dwordx4 v1, s[8:11], s48 offen offset:3072 lds
v_dot2_f32_bf16 v211, v200, v110, v211
v_dot2_f32_bf16 v211, v201, v111, v211
ds_read_b128 v[152:155], v9 offset:1920
ds_read_b128 v[156:159], v9 offset:1936
ds_read_b64 v[160:161], v9 offset:1952
ds_read_b128 v[162:165], v9 offset:1312
ds_read_b128 v[166:169], v9 offset:1328
ds_read_b64 v[170:171], v9 offset:1344
ds_read_b128 v[172:175], v9 offset:704
ds_read_b128 v[176:179], v9 offset:720
ds_read_b64 v[180:181], v9 offset:736
s_add_u32 m0, s47, 12288
s_add_u32 s48, s46, 12288
buffer_load_dwordx4 v1, s[8:11], s48 offen offset:0 lds
ds_read_b128 v[182:185], v9 offset:96
ds_read_b128 v[186:189], v9 offset:112
ds_read_b64 v[190:191], v9 offset:128
s_cmp_lg_u32 s17, 0
s_cbranch_scc1 L_nomask_80
v_cmp_le_u32 s[34:35], 2, v10
s_nop 0
s_nop 0
v_cmp_le_u32 s[32:33], 4, v10
v_cndmask_b32 v205, v11, v205, s[34:35]
v_cmp_le_u32 s[34:35], 6, v10
v_cndmask_b32 v206, v11, v206, s[32:33]
v_cmp_le_u32 s[32:33], 8, v10
v_cndmask_b32 v207, v11, v207, s[34:35]
v_cmp_le_u32 s[34:35], 10, v10
v_cndmask_b32 v208, v11, v208, s[32:33]
v_cmp_le_u32 s[32:33], 12, v10
v_cndmask_b32 v209, v11, v209, s[34:35]
v_cmp_le_u32 s[34:35], 14, v10
v_cndmask_b32 v210, v11, v210, s[32:33]
s_nop 0
s_nop 0
v_cndmask_b32 v211, v11, v211, s[34:35]
L_nomask_80:
buffer_load_dwordx4 v1, s[8:11], s48 offen offset:1024 lds
buffer_load_dwordx4 v1, s[8:11], s48 offen offset:2048 lds
v_max3_f32 v12, v204, v205, v206
v_max3_f32 v12, v12, v207, v208
v_max3_f32 v12, v12, v209, v210
v_max_f32 v12, v12, v211
v_mul_f32 v12, v12, v13
v_fma_f32 v204, v204, v13, -v12
v_fma_f32 v205, v205, v13, -v12
v_fma_f32 v206, v206, v13, -v12
v_fma_f32 v207, v207, v13, -v12
v_fma_f32 v208, v208, v13, -v12
v_fma_f32 v209, v209, v13, -v12
buffer_load_dwordx4 v1, s[8:11], s48 offen offset:3072 lds
v_fma_f32 v210, v210, v13, -v12
v_fma_f32 v211, v211, v13, -v12
v_exp_f32 v204, v204
v_exp_f32 v205, v205
v_exp_f32 v206, v206
v_exp_f32 v207, v207
v_exp_f32 v208, v208
v_exp_f32 v209, v209
v_exp_f32 v210, v210
v_exp_f32 v211, v211
s_nop 0
s_add_u32 m0, s47, 16384
s_add_u32 s48, s46, 16384
buffer_load_dwordx4 v1, s[8:11], s48 offen offset:0 lds
v_add_f32 v12, v204, v205
v_add_f32 v14, v206, v207
v_add_f32 v15, v208, v209
v_add_f32 v11, v210, v211
v_add_f32 v12, v12, v14
v_add_f32 v15, v15, v11
v_add_f32 v12, v12, v15
v_rcp_f32 v12, v12
s_nop 0
v_mul_f32 v204, v204, v12
buffer_load_dwordx4 v1, s[8:11], s48 offen offset:1024 lds
v_mul_f32 v205, v205, v12
v_mul_f32 v206, v206, v12
v_mul_f32 v207, v207, v12
v_mul_f32 v208, v208, v12
v_mul_f32 v209, v209, v12
v_mul_f32 v210, v210, v12
v_mul_f32 v211, v211, v12
v_cvt_pk_bf16_f32 v212, v204, v205
v_cvt_pk_bf16_f32 v213, v206, v207
v_cvt_pk_bf16_f32 v214, v208, v209
v_cvt_pk_bf16_f32 v215, v210, v211
buffer_load_dwordx4 v1, s[8:11], s48 offen offset:2048 lds
s_waitcnt lgkmcnt(15)
s_nop 0
v_perm_b32 v216, v122, v112, s42
v_perm_b32 v217, v122, v112, s43
v_dot2_f32_bf16 v32, v212, v216, 0
v_dot2_f32_bf16 v33, v212, v217, 0
v_perm_b32 v218, v123, v113, s42
v_perm_b32 v219, v123, v113, s43
v_dot2_f32_bf16 v34, v212, v218, 0
v_dot2_f32_bf16 v35, v212, v219, 0
v_perm_b32 v220, v124, v114, s42
v_perm_b32 v221, v124, v114, s43
buffer_load_dwordx4 v1, s[8:11], s48 offen offset:3072 lds
v_dot2_f32_bf16 v36, v212, v220, 0
v_dot2_f32_bf16 v37, v212, v221, 0
v_perm_b32 v222, v125, v115, s42
v_perm_b32 v223, v125, v115, s43
v_dot2_f32_bf16 v38, v212, v222, 0
v_dot2_f32_bf16 v39, v212, v223, 0
v_perm_b32 v216, v126, v116, s42
v_perm_b32 v217, v126, v116, s43
v_dot2_f32_bf16 v40, v212, v216, 0
v_dot2_f32_bf16 v41, v212, v217, 0
v_perm_b32 v218, v127, v117, s42
s_add_u32 m0, s47, 20480
s_add_u32 s48, s46, 20480
buffer_load_dwordx4 v1, s[8:11], s48 offen offset:0 lds
v_perm_b32 v219, v127, v117, s43
v_dot2_f32_bf16 v42, v212, v218, 0
v_dot2_f32_bf16 v43, v212, v219, 0
v_perm_b32 v220, v128, v118, s42
v_perm_b32 v221, v128, v118, s43
v_dot2_f32_bf16 v44, v212, v220, 0
v_dot2_f32_bf16 v45, v212, v221, 0
v_perm_b32 v222, v129, v119, s42
v_perm_b32 v223, v129, v119, s43
v_dot2_f32_bf16 v46, v212, v222, 0
v_dot2_f32_bf16 v47, v212, v223, 0
buffer_load_dwordx4 v1, s[8:11], s48 offen offset:1024 lds
v_perm_b32 v216, v130, v120, s42
v_perm_b32 v217, v130, v120, s43
v_dot2_f32_bf16 v48, v212, v216, 0
v_dot2_f32_bf16 v49, v212, v217, 0
v_perm_b32 v218, v131, v121, s42
v_perm_b32 v219, v131, v121, s43
v_dot2_f32_bf16 v50, v212, v218, 0
v_dot2_f32_bf16 v51, v212, v219, 0
s_waitcnt lgkmcnt(12)
s_nop 0
v_perm_b32 v216, v142, v132, s42
v_perm_b32 v217, v142, v132, s43
buffer_load_dwordx4 v1, s[8:11], s48 offen offset:2048 lds
v_dot2_f32_bf16 v32, v213, v216, v32
v_dot2_f32_bf16 v33, v213, v217, v33
v_perm_b32 v218, v143, v133, s42
v_perm_b32 v219, v143, v133, s43
v_dot2_f32_bf16 v34, v213, v218, v34
v_dot2_f32_bf16 v35, v213, v219, v35
v_perm_b32 v220, v144, v134, s42
v_perm_b32 v221, v144, v134, s43
v_dot2_f32_bf16 v36, v213, v220, v36
v_dot2_f32_bf16 v37, v213, v221, v37
v_perm_b32 v222, v145, v135, s42
buffer_load_dwordx4 v1, s[8:11], s48 offen offset:3072 lds
v_perm_b32 v223, v145, v135, s43
v_dot2_f32_bf16 v38, v213, v222, v38
v_dot2_f32_bf16 v39, v213, v223, v39
v_perm_b32 v216, v146, v136, s42
v_perm_b32 v217, v146, v136, s43
v_dot2_f32_bf16 v40, v213, v216, v40
v_dot2_f32_bf16 v41, v213, v217, v41
v_perm_b32 v218, v147, v137, s42
v_perm_b32 v219, v147, v137, s43
v_dot2_f32_bf16 v42, v213, v218, v42
v_dot2_f32_bf16 v43, v213, v219, v43
s_add_u32 m0, s47, 24576
s_add_u32 s48, s46, 24576
buffer_load_dwordx4 v1, s[8:11], s48 offen offset:0 lds
v_perm_b32 v220, v148, v138, s42
v_perm_b32 v221, v148, v138, s43
v_dot2_f32_bf16 v44, v213, v220, v44
v_dot2_f32_bf16 v45, v213, v221, v45
v_perm_b32 v222, v149, v139, s42
v_perm_b32 v223, v149, v139, s43
v_dot2_f32_bf16 v46, v213, v222, v46
v_dot2_f32_bf16 v47, v213, v223, v47
v_perm_b32 v216, v150, v140, s42
v_perm_b32 v217, v150, v140, s43
v_dot2_f32_bf16 v48, v213, v216, v48
v_dot2_f32_bf16 v49, v213, v217, v49
v_perm_b32 v218, v151, v141, s42
v_perm_b32 v219, v151, v141, s43
v_dot2_f32_bf16 v50, v213, v218, v50
v_dot2_f32_bf16 v51, v213, v219, v51
s_waitcnt lgkmcnt(6)
s_nop 0
v_perm_b32 v216, v162, v152, s42
v_perm_b32 v217, v162, v152, s43
v_dot2_f32_bf16 v32, v214, v216, v32
v_dot2_f32_bf16 v33, v214, v217, v33
v_perm_b32 v218, v163, v153, s42
v_perm_b32 v219, v163, v153, s43
v_dot2_f32_bf16 v34, v214, v218, v34
v_dot2_f32_bf16 v35, v214, v219, v35
v_perm_b32 v220, v164, v154, s42
v_perm_b32 v221, v164, v154, s43
v_dot2_f32_bf16 v36, v214, v220, v36
v_dot2_f32_bf16 v37, v214, v221, v37
v_perm_b32 v222, v165, v155, s42
v_perm_b32 v223, v165, v155, s43
v_dot2_f32_bf16 v38, v214, v222, v38
v_dot2_f32_bf16 v39, v214, v223, v39
v_perm_b32 v216, v166, v156, s42
v_perm_b32 v217, v166, v156, s43
v_dot2_f32_bf16 v40, v214, v216, v40
v_dot2_f32_bf16 v41, v214, v217, v41
v_perm_b32 v218, v167, v157, s42
v_perm_b32 v219, v167, v157, s43
v_dot2_f32_bf16 v42, v214, v218, v42
v_dot2_f32_bf16 v43, v214, v219, v43
v_perm_b32 v220, v168, v158, s42
v_perm_b32 v221, v168, v158, s43
v_dot2_f32_bf16 v44, v214, v220, v44
v_dot2_f32_bf16 v45, v214, v221, v45
v_perm_b32 v222, v169, v159, s42
v_perm_b32 v223, v169, v159, s43
v_dot2_f32_bf16 v46, v214, v222, v46
v_dot2_f32_bf16 v47, v214, v223, v47
v_perm_b32 v216, v170, v160, s42
v_perm_b32 v217, v170, v160, s43
v_dot2_f32_bf16 v48, v214, v216, v48
v_dot2_f32_bf16 v49, v214, v217, v49
v_perm_b32 v218, v171, v161, s42
v_perm_b32 v219, v171, v161, s43
v_dot2_f32_bf16 v50, v214, v218, v50
v_dot2_f32_bf16 v51, v214, v219, v51
s_waitcnt lgkmcnt(0)
s_nop 0
v_perm_b32 v216, v182, v172, s42
v_perm_b32 v217, v182, v172, s43
v_dot2_f32_bf16 v32, v215, v216, v32
v_dot2_f32_bf16 v33, v215, v217, v33
v_perm_b32 v218, v183, v173, s42
v_perm_b32 v219, v183, v173, s43
v_dot2_f32_bf16 v34, v215, v218, v34
v_dot2_f32_bf16 v35, v215, v219, v35
v_perm_b32 v220, v184, v174, s42
v_perm_b32 v221, v184, v174, s43
v_dot2_f32_bf16 v36, v215, v220, v36
v_dot2_f32_bf16 v37, v215, v221, v37
v_perm_b32 v222, v185, v175, s42
v_perm_b32 v223, v185, v175, s43
v_dot2_f32_bf16 v38, v215, v222, v38
v_dot2_f32_bf16 v39, v215, v223, v39
v_perm_b32 v216, v186, v176, s42
v_perm_b32 v217, v186, v176, s43
v_dot2_f32_bf16 v40, v215, v216, v40
v_dot2_f32_bf16 v41, v215, v217, v41
v_perm_b32 v218, v187, v177, s42
v_perm_b32 v219, v187, v177, s43
v_dot2_f32_bf16 v42, v215, v218, v42
v_dot2_f32_bf16 v43, v215, v219, v43
v_perm_b32 v220, v188, v178, s42
v_perm_b32 v221, v188, v178, s43
v_dot2_f32_bf16 v44, v215, v220, v44
v_dot2_f32_bf16 v45, v215, v221, v45
v_perm_b32 v222, v189, v179, s42
v_perm_b32 v223, v189, v179, s43
v_dot2_f32_bf16 v46, v215, v222, v46
v_dot2_f32_bf16 v47, v215, v223, v47
v_perm_b32 v216, v190, v180, s42
v_perm_b32 v217, v190, v180, s43
v_dot2_f32_bf16 v48, v215, v216, v48
v_dot2_f32_bf16 v49, v215, v217, v49
v_perm_b32 v218, v191, v181, s42
v_perm_b32 v219, v191, v181, s43
v_dot2_f32_bf16 v50, v215, v218, v50
v_dot2_f32_bf16 v51, v215, v219, v51
s_nop 2
s_nop 0
v_cvt_pk_bf16_f32 v56, v32, v33
v_cvt_pk_bf16_f32 v57, v34, v35
v_cvt_pk_bf16_f32 v58, v36, v37
v_cvt_pk_bf16_f32 v59, v38, v39
v_cvt_pk_bf16_f32 v60, v40, v41
v_cvt_pk_bf16_f32 v61, v42, v43
v_cvt_pk_bf16_f32 v62, v44, v45
v_cvt_pk_bf16_f32 v63, v46, v47
v_cvt_pk_bf16_f32 v64, v48, v49
v_cvt_pk_bf16_f32 v65, v50, v51
buffer_store_dwordx2 v[56:57], v232, s[8:11], s25 offen
buffer_store_dwordx2 v[58:59], v233, s[8:11], s25 offen
buffer_store_dwordx2 v[60:61], v234, s[8:11], s25 offen
buffer_store_dwordx2 v[62:63], v235, s[8:11], s25 offen
buffer_store_dwordx2 v[64:65], v236, s[8:11], s25 offen
s_getpc_b64 s[40:41]
L_pc_main:
s_add_u32 s40, s40, L_mid-L_pc_main
s_addc_u32 s41, s41, -1
s_setpc_b64 s[40:41]
L_g4final_69:
s_mul_i32 s44, s96, 221184
s_lshl_b32 s45, s99, 10
s_add_u32 s44, s44, s45
s_add_u32 s44, s44, s28
s_add_u32 s45, s44, 0
s_nop 0
buffer_load_dwordx4 a[0:3], v1, s[8:11], s45 offen offset:0 sc1
buffer_load_dwordx4 a[4:7], v1, s[8:11], s45 offen offset:1024 sc1
s_add_u32 s45, s44, 8192
buffer_load_dwordx4 a[8:11], v1, s[8:11], s45 offen offset:0 sc1
buffer_load_dwordx4 a[12:15], v1, s[8:11], s45 offen offset:1024 sc1
s_add_u32 s45, s44, 16384
buffer_load_dwordx4 a[16:19], v1, s[8:11], s45 offen offset:0 sc1
buffer_load_dwordx4 a[20:23], v1, s[8:11], s45 offen offset:1024 sc1
s_add_u32 s45, s44, 24576
buffer_load_dwordx4 a[24:27], v1, s[8:11], s45 offen offset:0 sc1
buffer_load_dwordx4 a[28:31], v1, s[8:11], s45 offen offset:1024 sc1
s_add_u32 s45, s44, 32768
buffer_load_dwordx4 a[32:35], v1, s[8:11], s45 offen offset:0 sc1
buffer_load_dwordx4 a[36:39], v1, s[8:11], s45 offen offset:1024 sc1
v_mul_u32_u24 v8, 1280, v3
v_lshlrev_b32 v9, 3, v4
v_add_u32 v8, v8, v9
s_lshl_b32 s50, s17, 3
s_add_u32 s50, s50, s100
s_mul_i32 s50, s50, 20480
s_mul_i32 s51, s98, 160
s_add_u32 s63, s50, s51
s_mul_i32 s48, s96, 14336
v_add_u32 v5, s48, v1
v_add_u32 v6, 57344, v5
v_add_u32 v7, 114688, v5
s_lshl_b32 s48, s96, 10
s_add_u32 s48, s48, 143360
v_add_u32 v10, s48, v1
ds_read_b128 v[72:75], v5 offset:0
ds_read_b128 v[76:79], v5 offset:1024
ds_read_b128 v[80:83], v5 offset:2048
ds_read_b128 v[84:87], v5 offset:3072
ds_read_b128 v[88:91], v5 offset:4096
ds_read_b128 v[92:95], v5 offset:5120
s_waitcnt lgkmcnt(5) vmcnt(8)
v_mfma_f32_16x16x32_bf16 v[32:35], v[72:75], a[0:3], 0
ds_read_b128 v[96:99], v5 offset:6144
s_add_u32 s45, s44, 40960
v_mfma_f32_16x16x32_bf16 v[52:55], v[72:75], a[4:7], 0
s_waitcnt lgkmcnt(5)
buffer_load_dwordx4 a[40:43], v1, s[8:11], s45 offen offset:0 sc1
v_mfma_f32_16x16x32_bf16 v[36:39], v[76:79], a[0:3], 0
ds_read_b128 v[72:75], v5 offset:7168
buffer_load_dwordx4 a[44:47], v1, s[8:11], s45 offen offset:1024 sc1
v_mfma_f32_16x16x32_bf16 v[56:59], v[76:79], a[4:7], 0
s_waitcnt lgkmcnt(5)
s_add_u32 s45, s44, 49152
v_mfma_f32_16x16x32_bf16 v[40:43], v[80:83], a[0:3], 0
ds_read_b128 v[76:79], v5 offset:8192
buffer_load_dwordx4 a[48:51], v1, s[8:11], s45 offen offset:0 sc1
v_mfma_f32_16x16x32_bf16 v[60:63], v[80:83], a[4:7], 0
s_waitcnt lgkmcnt(5)
buffer_load_dwordx4 a[52:55], v1, s[8:11], s45 offen offset:1024 sc1
v_mfma_f32_16x16x32_bf16 v[44:47], v[84:87], a[0:3], 0
ds_read_b128 v[80:83], v5 offset:9216
s_add_u32 s45, s44, 57344
v_mfma_f32_16x16x32_bf16 v[64:67], v[84:87], a[4:7], 0
s_waitcnt lgkmcnt(5)
buffer_load_dwordx4 a[56:59], v1, s[8:11], s45 offen offset:0 sc1
v_mfma_f32_16x16x32_bf16 v[48:51], v[88:91], a[0:3], 0
ds_read_b128 v[84:87], v5 offset:10240
buffer_load_dwordx4 a[60:63], v1, s[8:11], s45 offen offset:1024 sc1
v_mfma_f32_16x16x32_bf16 v[68:71], v[88:91], a[4:7], 0
s_waitcnt lgkmcnt(5) vmcnt(12)
v_mfma_f32_16x16x32_bf16 v[32:35], v[92:95], a[8:11], v[32:35]
ds_read_b128 v[88:91], v5 offset:11264
s_add_u32 s45, s44, 65536
v_mfma_f32_16x16x32_bf16 v[52:55], v[92:95], a[12:15], v[52:55]
s_waitcnt lgkmcnt(5)
buffer_load_dwordx4 a[64:67], v1, s[8:11], s45 offen offset:0 sc1
v_mfma_f32_16x16x32_bf16 v[36:39], v[96:99], a[8:11], v[36:39]
ds_read_b128 v[92:95], v5 offset:12288
buffer_load_dwordx4 a[68:71], v1, s[8:11], s45 offen offset:1024 sc1
v_mfma_f32_16x16x32_bf16 v[56:59], v[96:99], a[12:15], v[56:59]
s_waitcnt lgkmcnt(5)
v_mfma_f32_16x16x32_bf16 v[40:43], v[72:75], a[8:11], v[40:43]
ds_read_b128 v[96:99], v5 offset:13312
s_add_u32 s45, s44, 73728
v_mfma_f32_16x16x32_bf16 v[60:63], v[72:75], a[12:15], v[60:63]
s_waitcnt lgkmcnt(5)
buffer_load_dwordx4 a[72:75], v1, s[8:11], s45 offen offset:0 sc1
v_mfma_f32_16x16x32_bf16 v[44:47], v[76:79], a[8:11], v[44:47]
ds_read_b128 v[72:75], v10 offset:0
buffer_load_dwordx4 a[76:79], v1, s[8:11], s45 offen offset:1024 sc1
v_mfma_f32_16x16x32_bf16 v[64:67], v[76:79], a[12:15], v[64:67]
s_waitcnt lgkmcnt(5)
v_mfma_f32_16x16x32_bf16 v[48:51], v[80:83], a[8:11], v[48:51]
s_barrier
ds_read_b128 v[76:79], v5 offset:28672
s_add_u32 s45, s44, 81920
v_mfma_f32_16x16x32_bf16 v[68:71], v[80:83], a[12:15], v[68:71]
s_waitcnt lgkmcnt(5) vmcnt(14)
buffer_load_dwordx4 a[80:83], v1, s[8:11], s45 offen offset:0 sc1
v_mfma_f32_16x16x32_bf16 v[32:35], v[84:87], a[16:19], v[32:35]
ds_read_b128 v[80:83], v5 offset:29696
buffer_load_dwordx4 a[84:87], v1, s[8:11], s45 offen offset:1024 sc1
v_mfma_f32_16x16x32_bf16 v[52:55], v[84:87], a[20:23], v[52:55]
s_waitcnt lgkmcnt(5)
v_mfma_f32_16x16x32_bf16 v[36:39], v[88:91], a[16:19], v[36:39]
ds_read_b128 v[84:87], v5 offset:30720
v_mfma_f32_16x16x32_bf16 v[56:59], v[88:91], a[20:23], v[56:59]
s_waitcnt lgkmcnt(5)
v_mfma_f32_16x16x32_bf16 v[40:43], v[92:95], a[16:19], v[40:43]
ds_read_b128 v[88:91], v5 offset:31744
s_add_u32 s45, s44, 90112
v_mfma_f32_16x16x32_bf16 v[60:63], v[92:95], a[20:23], v[60:63]
s_waitcnt lgkmcnt(5)
buffer_load_dwordx4 a[88:91], v1, s[8:11], s45 offen offset:0 sc1
v_mfma_f32_16x16x32_bf16 v[44:47], v[96:99], a[16:19], v[44:47]
ds_read_b128 v[92:95], v5 offset:32768
buffer_load_dwordx4 a[92:95], v1, s[8:11], s45 offen offset:1024 sc1
v_mfma_f32_16x16x32_bf16 v[64:67], v[96:99], a[20:23], v[64:67]
s_waitcnt lgkmcnt(5)
v_mfma_f32_16x16x32_bf16 v[48:51], v[72:75], a[16:19], v[48:51]
ds_read_b128 v[96:99], v5 offset:33792
v_mfma_f32_16x16x32_bf16 v[68:71], v[72:75], a[20:23], v[68:71]
s_waitcnt lgkmcnt(5) vmcnt(16)
v_mfma_f32_16x16x32_bf16 v[32:35], v[76:79], a[24:27], v[32:35]
ds_read_b128 v[72:75], v5 offset:34816
s_add_u32 s45, s44, 98304
v_mfma_f32_16x16x32_bf16 v[52:55], v[76:79], a[28:31], v[52:55]
s_waitcnt lgkmcnt(5)
buffer_load_dwordx4 a[96:99], v1, s[8:11], s45 offen offset:0 sc1
v_mfma_f32_16x16x32_bf16 v[36:39], v[80:83], a[24:27], v[36:39]
ds_read_b128 v[76:79], v5 offset:35840
buffer_load_dwordx4 a[100:103], v1, s[8:11], s45 offen offset:1024 sc1
v_mfma_f32_16x16x32_bf16 v[56:59], v[80:83], a[28:31], v[56:59]
s_waitcnt lgkmcnt(5)
v_mfma_f32_16x16x32_bf16 v[40:43], v[84:87], a[24:27], v[40:43]
ds_read_b128 v[80:83], v5 offset:36864
v_mfma_f32_16x16x32_bf16 v[60:63], v[84:87], a[28:31], v[60:63]
s_waitcnt lgkmcnt(5)
v_mfma_f32_16x16x32_bf16 v[44:47], v[88:91], a[24:27], v[44:47]
ds_read_b128 v[84:87], v5 offset:37888
s_add_u32 s45, s44, 106496
v_mfma_f32_16x16x32_bf16 v[64:67], v[88:91], a[28:31], v[64:67]
s_waitcnt lgkmcnt(5)
buffer_load_dwordx4 a[104:107], v1, s[8:11], s45 offen offset:0 sc1
v_mfma_f32_16x16x32_bf16 v[48:51], v[92:95], a[24:27], v[48:51]
ds_read_b128 v[88:91], v5 offset:38912
buffer_load_dwordx4 a[108:111], v1, s[8:11], s45 offen offset:1024 sc1
v_mfma_f32_16x16x32_bf16 v[68:71], v[92:95], a[28:31], v[68:71]
s_waitcnt lgkmcnt(5) vmcnt(18)
v_mfma_f32_16x16x32_bf16 v[32:35], v[96:99], a[32:35], v[32:35]
ds_read_b128 v[92:95], v5 offset:39936
v_mfma_f32_16x16x32_bf16 v[52:55], v[96:99], a[36:39], v[52:55]
s_waitcnt lgkmcnt(5)
v_mfma_f32_16x16x32_bf16 v[36:39], v[72:75], a[32:35], v[36:39]
ds_read_b128 v[96:99], v5 offset:40960
s_add_u32 s45, s44, 114688
v_mfma_f32_16x16x32_bf16 v[56:59], v[72:75], a[36:39], v[56:59]
s_waitcnt lgkmcnt(5)
buffer_load_dwordx4 a[112:115], v1, s[8:11], s45 offen offset:0 sc1
v_mfma_f32_16x16x32_bf16 v[40:43], v[76:79], a[32:35], v[40:43]
ds_read_b128 v[72:75], v5 offset:41984
buffer_load_dwordx4 a[116:119], v1, s[8:11], s45 offen offset:1024 sc1
v_mfma_f32_16x16x32_bf16 v[60:63], v[76:79], a[36:39], v[60:63]
s_waitcnt lgkmcnt(5)
v_mfma_f32_16x16x32_bf16 v[44:47], v[80:83], a[32:35], v[44:47]
ds_read_b128 v[76:79], v10 offset:2048
v_mfma_f32_16x16x32_bf16 v[64:67], v[80:83], a[36:39], v[64:67]
s_waitcnt lgkmcnt(5)
v_mfma_f32_16x16x32_bf16 v[48:51], v[84:87], a[32:35], v[48:51]
s_barrier
ds_read_b128 v[80:83], v6 offset:0
s_add_u32 s45, s44, 122880
v_mfma_f32_16x16x32_bf16 v[68:71], v[84:87], a[36:39], v[68:71]
s_waitcnt lgkmcnt(5) vmcnt(18)
buffer_load_dwordx4 a[120:123], v1, s[8:11], s45 offen offset:0 sc1
v_mfma_f32_16x16x32_bf16 v[32:35], v[88:91], a[40:43], v[32:35]
ds_read_b128 v[84:87], v6 offset:1024
s_add_u32 m0, s30, 0
v_mfma_f32_16x16x32_bf16 v[52:55], v[88:91], a[44:47], v[52:55]
s_waitcnt lgkmcnt(5)
s_add_u32 s42, s60, 153600
v_mfma_f32_16x16x32_bf16 v[36:39], v[92:95], a[40:43], v[36:39]
ds_read_b128 v[88:91], v6 offset:2048
buffer_load_dwordx4 v1, s[8:11], s42 offen offset:0 lds
v_mfma_f32_16x16x32_bf16 v[56:59], v[92:95], a[44:47], v[56:59]
s_waitcnt lgkmcnt(5)
v_mfma_f32_16x16x32_bf16 v[40:43], v[96:99], a[40:43], v[40:43]
ds_read_b128 v[92:95], v6 offset:3072
buffer_load_dwordx4 a[124:127], v1, s[8:11], s45 offen offset:1024 sc1
v_mfma_f32_16x16x32_bf16 v[60:63], v[96:99], a[44:47], v[60:63]
s_waitcnt lgkmcnt(5)
v_mfma_f32_16x16x32_bf16 v[44:47], v[72:75], a[40:43], v[44:47]
ds_read_b128 v[96:99], v6 offset:4096
v_mfma_f32_16x16x32_bf16 v[64:67], v[72:75], a[44:47], v[64:67]
s_waitcnt lgkmcnt(5)
v_mfma_f32_16x16x32_bf16 v[48:51], v[76:79], a[40:43], v[48:51]
ds_read_b128 v[72:75], v6 offset:5120
buffer_load_dwordx4 v1, s[8:11], s42 offen offset:1024 lds
v_mfma_f32_16x16x32_bf16 v[68:71], v[76:79], a[44:47], v[68:71]
s_waitcnt lgkmcnt(5) vmcnt(20)
v_mfma_f32_16x16x32_bf16 v[32:35], v[80:83], a[48:51], v[32:35]
ds_read_b128 v[76:79], v6 offset:6144
v_mfma_f32_16x16x32_bf16 v[52:55], v[80:83], a[52:55], v[52:55]
s_waitcnt lgkmcnt(5)
v_mfma_f32_16x16x32_bf16 v[36:39], v[84:87], a[48:51], v[36:39]
ds_read_b128 v[80:83], v6 offset:7168
s_add_u32 s45, s44, 131072
v_mfma_f32_16x16x32_bf16 v[56:59], v[84:87], a[52:55], v[56:59]
s_waitcnt lgkmcnt(5)
buffer_load_dwordx4 a[128:131], v1, s[8:11], s45 offen offset:0 sc1
v_mfma_f32_16x16x32_bf16 v[40:43], v[88:91], a[48:51], v[40:43]
ds_read_b128 v[84:87], v6 offset:8192
v_mfma_f32_16x16x32_bf16 v[60:63], v[88:91], a[52:55], v[60:63]
s_waitcnt lgkmcnt(5)
v_mfma_f32_16x16x32_bf16 v[44:47], v[92:95], a[48:51], v[44:47]
ds_read_b128 v[88:91], v6 offset:9216
buffer_load_dwordx4 v1, s[8:11], s42 offen offset:2048 lds
v_mfma_f32_16x16x32_bf16 v[64:67], v[92:95], a[52:55], v[64:67]
s_waitcnt lgkmcnt(5)
v_mfma_f32_16x16x32_bf16 v[48:51], v[96:99], a[48:51], v[48:51]
ds_read_b128 v[92:95], v6 offset:10240
v_mfma_f32_16x16x32_bf16 v[68:71], v[96:99], a[52:55], v[68:71]
s_waitcnt lgkmcnt(5) vmcnt(20)
v_mfma_f32_16x16x32_bf16 v[32:35], v[72:75], a[56:59], v[32:35]
ds_read_b128 v[96:99], v6 offset:11264
buffer_load_dwordx4 a[132:135], v1, s[8:11], s45 offen offset:1024 sc1
v_mfma_f32_16x16x32_bf16 v[52:55], v[72:75], a[60:63], v[52:55]
s_waitcnt lgkmcnt(5)
v_mfma_f32_16x16x32_bf16 v[36:39], v[76:79], a[56:59], v[36:39]
ds_read_b128 v[72:75], v6 offset:12288
v_mfma_f32_16x16x32_bf16 v[56:59], v[76:79], a[60:63], v[56:59]
s_waitcnt lgkmcnt(5)
v_mfma_f32_16x16x32_bf16 v[40:43], v[80:83], a[56:59], v[40:43]
ds_read_b128 v[76:79], v6 offset:13312
buffer_load_dwordx4 v1, s[8:11], s42 offen offset:3072 lds
v_mfma_f32_16x16x32_bf16 v[60:63], v[80:83], a[60:63], v[60:63]
s_waitcnt lgkmcnt(5)
v_mfma_f32_16x16x32_bf16 v[44:47], v[84:87], a[56:59], v[44:47]
ds_read_b128 v[80:83], v10 offset:4096
v_mfma_f32_16x16x32_bf16 v[64:67], v[84:87], a[60:63], v[64:67]
s_waitcnt lgkmcnt(5)
v_mfma_f32_16x16x32_bf16 v[48:51], v[88:91], a[56:59], v[48:51]
s_barrier
ds_read_b128 v[84:87], v6 offset:28672
s_add_u32 s45, s44, 139264
v_mfma_f32_16x16x32_bf16 v[68:71], v[88:91], a[60:63], v[68:71]
s_waitcnt lgkmcnt(5) vmcnt(20)
buffer_load_dwordx4 a[136:139], v1, s[8:11], s45 offen offset:0 sc1
v_mfma_f32_16x16x32_bf16 v[32:35], v[92:95], a[64:67], v[32:35]
ds_read_b128 v[88:91], v6 offset:29696
s_add_u32 m0, s30, 4096
v_mfma_f32_16x16x32_bf16 v[52:55], v[92:95], a[68:71], v[52:55]
s_waitcnt lgkmcnt(5)
s_add_u32 s42, s60, 157696
v_mfma_f32_16x16x32_bf16 v[36:39], v[96:99], a[64:67], v[36:39]
ds_read_b128 v[92:95], v6 offset:30720
buffer_load_dwordx4 v1, s[8:11], s42 offen offset:0 lds
v_mfma_f32_16x16x32_bf16 v[56:59], v[96:99], a[68:71], v[56:59]
s_waitcnt lgkmcnt(5)
buffer_load_dwordx4 a[140:143], v1, s[8:11], s45 offen offset:1024 sc1
v_mfma_f32_16x16x32_bf16 v[40:43], v[72:75], a[64:67], v[40:43]
ds_read_b128 v[96:99], v6 offset:31744
buffer_load_dwordx4 v1, s[8:11], s42 offen offset:1024 lds
v_mfma_f32_16x16x32_bf16 v[60:63], v[72:75], a[68:71], v[60:63]
s_waitcnt lgkmcnt(5)
v_mfma_f32_16x16x32_bf16 v[44:47], v[76:79], a[64:67], v[44:47]
ds_read_b128 v[72:75], v6 offset:32768
v_mfma_f32_16x16x32_bf16 v[64:67], v[76:79], a[68:71], v[64:67]
s_waitcnt lgkmcnt(5)
v_mfma_f32_16x16x32_bf16 v[48:51], v[80:83], a[64:67], v[48:51]
ds_read_b128 v[76:79], v6 offset:33792
s_add_u32 s45, s44, 147456
v_mfma_f32_16x16x32_bf16 v[68:71], v[80:83], a[68:71], v[68:71]
s_waitcnt lgkmcnt(5) vmcnt(22)
buffer_load_dwordx4 a[144:147], v1, s[8:11], s45 offen offset:0 sc1
v_mfma_f32_16x16x32_bf16 v[32:35], v[84:87], a[72:75], v[32:35]
ds_read_b128 v[80:83], v6 offset:34816
buffer_load_dwordx4 v1, s[8:11], s42 offen offset:2048 lds
v_mfma_f32_16x16x32_bf16 v[52:55], v[84:87], a[76:79], v[52:55]
s_waitcnt lgkmcnt(5)
v_mfma_f32_16x16x32_bf16 v[36:39], v[88:91], a[72:75], v[36:39]
ds_read_b128 v[84:87], v6 offset:35840
buffer_load_dwordx4 a[148:151], v1, s[8:11], s45 offen offset:1024 sc1
v_mfma_f32_16x16x32_bf16 v[56:59], v[88:91], a[76:79], v[56:59]
s_waitcnt lgkmcnt(5)
v_mfma_f32_16x16x32_bf16 v[40:43], v[92:95], a[72:75], v[40:43]
ds_read_b128 v[88:91], v6 offset:36864
s_add_u32 m0, s61, 143360
v_mfma_f32_16x16x32_bf16 v[60:63], v[92:95], a[76:79], v[60:63]
s_waitcnt lgkmcnt(5)
s_add_u32 s42, s62, 153600
v_mfma_f32_16x16x32_bf16 v[44:47], v[96:99], a[72:75], v[44:47]
ds_read_b128 v[92:95], v6 offset:37888
buffer_load_dwordx4 v1, s[8:11], s42 offen lds
v_mfma_f32_16x16x32_bf16 v[64:67], v[96:99], a[76:79], v[64:67]
s_waitcnt lgkmcnt(5)
v_mfma_f32_16x16x32_bf16 v[48:51], v[72:75], a[72:75], v[48:51]
ds_read_b128 v[96:99], v6 offset:38912
s_add_u32 m0, s30, 28672
v_mfma_f32_16x16x32_bf16 v[68:71], v[72:75], a[76:79], v[68:71]
s_waitcnt lgkmcnt(5) vmcnt(24)
s_add_u32 s42, s60, 184320
v_mfma_f32_16x16x32_bf16 v[32:35], v[76:79], a[80:83], v[32:35]
ds_read_b128 v[72:75], v6 offset:39936
buffer_load_dwordx4 v1, s[8:11], s42 offen offset:0 lds
v_mfma_f32_16x16x32_bf16 v[52:55], v[76:79], a[84:87], v[52:55]
s_waitcnt lgkmcnt(5)
buffer_load_dwordx4 v1, s[8:11], s42 offen offset:1024 lds
v_mfma_f32_16x16x32_bf16 v[36:39], v[80:83], a[80:83], v[36:39]
ds_read_b128 v[76:79], v6 offset:40960
buffer_load_dwordx4 v1, s[8:11], s42 offen offset:2048 lds
v_mfma_f32_16x16x32_bf16 v[56:59], v[80:83], a[84:87], v[56:59]
s_waitcnt lgkmcnt(5)
v_mfma_f32_16x16x32_bf16 v[40:43], v[84:87], a[80:83], v[40:43]
ds_read_b128 v[80:83], v6 offset:41984
buffer_load_dwordx4 v1, s[8:11], s42 offen offset:3072 lds
v_mfma_f32_16x16x32_bf16 v[60:63], v[84:87], a[84:87], v[60:63]
s_waitcnt lgkmcnt(5)
v_mfma_f32_16x16x32_bf16 v[44:47], v[88:91], a[80:83], v[44:47]
ds_read_b128 v[84:87], v10 offset:6144
v_mfma_f32_16x16x32_bf16 v[64:67], v[88:91], a[84:87], v[64:67]
s_waitcnt lgkmcnt(5)
v_mfma_f32_16x16x32_bf16 v[48:51], v[92:95], a[80:83], v[48:51]
s_barrier
ds_read_b128 v[88:91], v7 offset:0
s_add_u32 s45, s44, 155648
v_mfma_f32_16x16x32_bf16 v[68:71], v[92:95], a[84:87], v[68:71]
s_waitcnt lgkmcnt(5) vmcnt(26)
buffer_load_dwordx4 a[152:155], v1, s[8:11], s45 offen offset:0 sc1
v_mfma_f32_16x16x32_bf16 v[32:35], v[96:99], a[88:91], v[32:35]
ds_read_b128 v[92:95], v7 offset:1024
s_add_u32 m0, s30, 32768
v_mfma_f32_16x16x32_bf16 v[52:55], v[96:99], a[92:95], v[52:55]
s_waitcnt lgkmcnt(5)
s_add_u32 s42, s60, 188416
v_mfma_f32_16x16x32_bf16 v[36:39], v[72:75], a[88:91], v[36:39]
ds_read_b128 v[96:99], v7 offset:2048
buffer_load_dwordx4 v1, s[8:11], s42 offen offset:0 lds
v_mfma_f32_16x16x32_bf16 v[56:59], v[72:75], a[92:95], v[56:59]
s_waitcnt lgkmcnt(5)
buffer_load_dwordx4 a[156:159], v1, s[8:11], s45 offen offset:1024 sc1
v_mfma_f32_16x16x32_bf16 v[40:43], v[76:79], a[88:91], v[40:43]
ds_read_b128 v[72:75], v7 offset:3072
buffer_load_dwordx4 v1, s[8:11], s42 offen offset:1024 lds
v_mfma_f32_16x16x32_bf16 v[60:63], v[76:79], a[92:95], v[60:63]
s_waitcnt lgkmcnt(5)
v_mfma_f32_16x16x32_bf16 v[44:47], v[80:83], a[88:91], v[44:47]
ds_read_b128 v[76:79], v7 offset:4096
v_mfma_f32_16x16x32_bf16 v[64:67], v[80:83], a[92:95], v[64:67]
s_waitcnt lgkmcnt(5)
v_mfma_f32_16x16x32_bf16 v[48:51], v[84:87], a[88:91], v[48:51]
ds_read_b128 v[80:83], v7 offset:5120
s_add_u32 s45, s44, 163840
v_mfma_f32_16x16x32_bf16 v[68:71], v[84:87], a[92:95], v[68:71]
s_waitcnt lgkmcnt(5) vmcnt(28)
buffer_load_dwordx4 a[160:163], v1, s[8:11], s45 offen offset:0 sc1
v_mfma_f32_16x16x32_bf16 v[32:35], v[88:91], a[96:99], v[32:35]
ds_read_b128 v[84:87], v7 offset:6144
buffer_load_dwordx4 v1, s[8:11], s42 offen offset:2048 lds
v_mfma_f32_16x16x32_bf16 v[52:55], v[88:91], a[100:103], v[52:55]
s_waitcnt lgkmcnt(5)
v_mfma_f32_16x16x32_bf16 v[36:39], v[92:95], a[96:99], v[36:39]
ds_read_b128 v[88:91], v7 offset:7168
buffer_load_dwordx4 a[164:167], v1, s[8:11], s45 offen offset:1024 sc1
v_mfma_f32_16x16x32_bf16 v[56:59], v[92:95], a[100:103], v[56:59]
s_waitcnt lgkmcnt(5)
v_mfma_f32_16x16x32_bf16 v[40:43], v[96:99], a[96:99], v[40:43]
ds_read_b128 v[92:95], v7 offset:8192
s_add_u32 m0, s61, 145408
v_mfma_f32_16x16x32_bf16 v[60:63], v[96:99], a[100:103], v[60:63]
s_waitcnt lgkmcnt(5)
s_add_u32 s42, s62, 184320
v_mfma_f32_16x16x32_bf16 v[44:47], v[72:75], a[96:99], v[44:47]
ds_read_b128 v[96:99], v7 offset:9216
buffer_load_dwordx4 v1, s[8:11], s42 offen lds
v_mfma_f32_16x16x32_bf16 v[64:67], v[72:75], a[100:103], v[64:67]
s_waitcnt lgkmcnt(5)
v_mfma_f32_16x16x32_bf16 v[48:51], v[76:79], a[96:99], v[48:51]
ds_read_b128 v[72:75], v7 offset:10240
s_add_u32 m0, s30, 57344
v_mfma_f32_16x16x32_bf16 v[68:71], v[76:79], a[100:103], v[68:71]
s_waitcnt lgkmcnt(5) vmcnt(30)
s_add_u32 s42, s60, 215040
v_mfma_f32_16x16x32_bf16 v[32:35], v[80:83], a[104:107], v[32:35]
ds_read_b128 v[76:79], v7 offset:11264
buffer_load_dwordx4 v1, s[8:11], s42 offen offset:0 lds
v_mfma_f32_16x16x32_bf16 v[52:55], v[80:83], a[108:111], v[52:55]
s_waitcnt lgkmcnt(5)
buffer_load_dwordx4 v1, s[8:11], s42 offen offset:1024 lds
v_mfma_f32_16x16x32_bf16 v[36:39], v[84:87], a[104:107], v[36:39]
ds_read_b128 v[80:83], v7 offset:12288
buffer_load_dwordx4 v1, s[8:11], s42 offen offset:2048 lds
v_mfma_f32_16x16x32_bf16 v[56:59], v[84:87], a[108:111], v[56:59]
s_waitcnt lgkmcnt(5)
v_mfma_f32_16x16x32_bf16 v[40:43], v[88:91], a[104:107], v[40:43]
ds_read_b128 v[84:87], v7 offset:13312
buffer_load_dwordx4 v1, s[8:11], s42 offen offset:3072 lds
v_mfma_f32_16x16x32_bf16 v[60:63], v[88:91], a[108:111], v[60:63]
s_waitcnt lgkmcnt(5)
v_mfma_f32_16x16x32_bf16 v[44:47], v[92:95], a[104:107], v[44:47]
ds_read_b128 v[88:91], v10 offset:8192
v_mfma_f32_16x16x32_bf16 v[64:67], v[92:95], a[108:111], v[64:67]
s_waitcnt lgkmcnt(5)
v_mfma_f32_16x16x32_bf16 v[48:51], v[96:99], a[104:107], v[48:51]
s_waitcnt vmcnt(16)
s_barrier
ds_read_b128 v[92:95], v5 offset:0
s_add_u32 s45, s44, 172032
v_mfma_f32_16x16x32_bf16 v[68:71], v[96:99], a[108:111], v[68:71]
s_waitcnt lgkmcnt(5)
buffer_load_dwordx4 a[168:171], v1, s[8:11], s45 offen offset:0 sc1
v_mfma_f32_16x16x32_bf16 v[32:35], v[72:75], a[112:115], v[32:35]
ds_read_b128 v[96:99], v5 offset:1024
s_add_u32 m0, s30, 61440
v_mfma_f32_16x16x32_bf16 v[52:55], v[72:75], a[116:119], v[52:55]
s_waitcnt lgkmcnt(5)
s_add_u32 s42, s60, 219136
v_mfma_f32_16x16x32_bf16 v[36:39], v[76:79], a[112:115], v[36:39]
ds_read_b128 v[72:75], v5 offset:2048
buffer_load_dwordx4 v1, s[8:11], s42 offen offset:0 lds
v_mfma_f32_16x16x32_bf16 v[56:59], v[76:79], a[116:119], v[56:59]
s_waitcnt lgkmcnt(5)
buffer_load_dwordx4 a[172:175], v1, s[8:11], s45 offen offset:1024 sc1
v_mfma_f32_16x16x32_bf16 v[40:43], v[80:83], a[112:115], v[40:43]
ds_read_b128 v[76:79], v5 offset:3072
buffer_load_dwordx4 v1, s[8:11], s42 offen offset:1024 lds
v_mfma_f32_16x16x32_bf16 v[60:63], v[80:83], a[116:119], v[60:63]
s_waitcnt lgkmcnt(5)
v_mfma_f32_16x16x32_bf16 v[44:47], v[84:87], a[112:115], v[44:47]
ds_read_b128 v[80:83], v5 offset:4096
v_mfma_f32_16x16x32_bf16 v[64:67], v[84:87], a[116:119], v[64:67]
s_waitcnt lgkmcnt(5)
v_mfma_f32_16x16x32_bf16 v[48:51], v[88:91], a[112:115], v[48:51]
ds_read_b128 v[84:87], v5 offset:5120
s_add_u32 s45, s44, 180224
v_mfma_f32_16x16x32_bf16 v[68:71], v[88:91], a[116:119], v[68:71]
s_waitcnt lgkmcnt(5)
buffer_load_dwordx4 a[176:179], v1, s[8:11], s45 offen offset:0 sc1
v_mfma_f32_16x16x32_bf16 v[32:35], v[92:95], a[120:123], v[32:35]
ds_read_b128 v[88:91], v5 offset:6144
buffer_load_dwordx4 v1, s[8:11], s42 offen offset:2048 lds
v_mfma_f32_16x16x32_bf16 v[52:55], v[92:95], a[124:127], v[52:55]
s_waitcnt lgkmcnt(5)
v_mfma_f32_16x16x32_bf16 v[36:39], v[96:99], a[120:123], v[36:39]
ds_read_b128 v[92:95], v5 offset:7168
buffer_load_dwordx4 a[180:183], v1, s[8:11], s45 offen offset:1024 sc1
v_mfma_f32_16x16x32_bf16 v[56:59], v[96:99], a[124:127], v[56:59]
s_waitcnt lgkmcnt(5)
v_mfma_f32_16x16x32_bf16 v[40:43], v[72:75], a[120:123], v[40:43]
ds_read_b128 v[96:99], v5 offset:8192
s_add_u32 m0, s61, 147456
v_mfma_f32_16x16x32_bf16 v[60:63], v[72:75], a[124:127], v[60:63]
s_waitcnt lgkmcnt(5)
s_add_u32 s42, s62, 215040
v_mfma_f32_16x16x32_bf16 v[44:47], v[76:79], a[120:123], v[44:47]
ds_read_b128 v[72:75], v5 offset:9216
buffer_load_dwordx4 v1, s[8:11], s42 offen lds
v_mfma_f32_16x16x32_bf16 v[64:67], v[76:79], a[124:127], v[64:67]
s_waitcnt lgkmcnt(5)
v_mfma_f32_16x16x32_bf16 v[48:51], v[80:83], a[120:123], v[48:51]
ds_read_b128 v[76:79], v5 offset:10240
s_add_u32 m0, s30, 86016
v_mfma_f32_16x16x32_bf16 v[68:71], v[80:83], a[124:127], v[68:71]
s_waitcnt lgkmcnt(5)
s_add_u32 s42, s60, 245760
v_mfma_f32_16x16x32_bf16 v[32:35], v[84:87], a[128:131], v[32:35]
ds_read_b128 v[80:83], v5 offset:11264
buffer_load_dwordx4 v1, s[8:11], s42 offen offset:0 lds
v_mfma_f32_16x16x32_bf16 v[52:55], v[84:87], a[132:135], v[52:55]
s_waitcnt lgkmcnt(5)
buffer_load_dwordx4 v1, s[8:11], s42 offen offset:1024 lds
v_mfma_f32_16x16x32_bf16 v[36:39], v[88:91], a[128:131], v[36:39]
ds_read_b128 v[84:87], v5 offset:12288
buffer_load_dwordx4 v1, s[8:11], s42 offen offset:2048 lds
v_mfma_f32_16x16x32_bf16 v[56:59], v[88:91], a[132:135], v[56:59]
s_waitcnt lgkmcnt(5)
v_mfma_f32_16x16x32_bf16 v[40:43], v[92:95], a[128:131], v[40:43]
ds_read_b128 v[88:91], v5 offset:13312
buffer_load_dwordx4 v1, s[8:11], s42 offen offset:3072 lds
v_mfma_f32_16x16x32_bf16 v[60:63], v[92:95], a[132:135], v[60:63]
s_waitcnt lgkmcnt(5)
v_mfma_f32_16x16x32_bf16 v[44:47], v[96:99], a[128:131], v[44:47]
ds_read_b128 v[92:95], v10 offset:0
v_mfma_f32_16x16x32_bf16 v[64:67], v[96:99], a[132:135], v[64:67]
s_waitcnt lgkmcnt(5)
v_mfma_f32_16x16x32_bf16 v[48:51], v[72:75], a[128:131], v[48:51]
s_waitcnt vmcnt(16)
s_barrier
ds_read_b128 v[96:99], v5 offset:28672
s_add_u32 s45, s44, 188416
v_mfma_f32_16x16x32_bf16 v[68:71], v[72:75], a[132:135], v[68:71]
s_waitcnt lgkmcnt(5)
buffer_load_dwordx4 a[184:187], v1, s[8:11], s45 offen offset:0 sc1
v_mfma_f32_16x16x32_bf16 v[32:35], v[76:79], a[136:139], v[32:35]
ds_read_b128 v[72:75], v5 offset:29696
s_add_u32 m0, s30, 90112
v_mfma_f32_16x16x32_bf16 v[52:55], v[76:79], a[140:143], v[52:55]
s_waitcnt lgkmcnt(5)
s_add_u32 s42, s60, 249856
v_mfma_f32_16x16x32_bf16 v[36:39], v[80:83], a[136:139], v[36:39]
ds_read_b128 v[76:79], v5 offset:30720
buffer_load_dwordx4 v1, s[8:11], s42 offen offset:0 lds
v_mfma_f32_16x16x32_bf16 v[56:59], v[80:83], a[140:143], v[56:59]
s_waitcnt lgkmcnt(5)
v_mfma_f32_16x16x32_bf16 v[40:43], v[84:87], a[136:139], v[40:43]
ds_read_b128 v[80:83], v5 offset:31744
buffer_load_dwordx4 a[188:191], v1, s[8:11], s45 offen offset:1024 sc1
v_mfma_f32_16x16x32_bf16 v[60:63], v[84:87], a[140:143], v[60:63]
s_waitcnt lgkmcnt(5)
v_mfma_f32_16x16x32_bf16 v[44:47], v[88:91], a[136:139], v[44:47]
ds_read_b128 v[84:87], v5 offset:32768
v_mfma_f32_16x16x32_bf16 v[64:67], v[88:91], a[140:143], v[64:67]
s_waitcnt lgkmcnt(5)
v_mfma_f32_16x16x32_bf16 v[48:51], v[92:95], a[136:139], v[48:51]
ds_read_b128 v[88:91], v5 offset:33792
buffer_load_dwordx4 v1, s[8:11], s42 offen offset:1024 lds
v_mfma_f32_16x16x32_bf16 v[68:71], v[92:95], a[140:143], v[68:71]
s_waitcnt lgkmcnt(5)
v_mfma_f32_16x16x32_bf16 v[32:35], v[96:99], a[144:147], v[32:35]
ds_read_b128 v[92:95], v5 offset:34816
v_mfma_f32_16x16x32_bf16 v[52:55], v[96:99], a[148:151], v[52:55]
s_waitcnt lgkmcnt(5)
v_mfma_f32_16x16x32_bf16 v[36:39], v[72:75], a[144:147], v[36:39]
ds_read_b128 v[96:99], v5 offset:35840
s_add_u32 s45, s44, 196608
v_mfma_f32_16x16x32_bf16 v[56:59], v[72:75], a[148:151], v[56:59]
s_waitcnt lgkmcnt(5)
buffer_load_dwordx4 a[192:195], v1, s[8:11], s45 offen offset:0 sc1
v_mfma_f32_16x16x32_bf16 v[40:43], v[76:79], a[144:147], v[40:43]
ds_read_b128 v[72:75], v5 offset:36864
v_mfma_f32_16x16x32_bf16 v[60:63], v[76:79], a[148:151], v[60:63]
s_waitcnt lgkmcnt(5)
v_mfma_f32_16x16x32_bf16 v[44:47], v[80:83], a[144:147], v[44:47]
ds_read_b128 v[76:79], v5 offset:37888
buffer_load_dwordx4 v1, s[8:11], s42 offen offset:2048 lds
v_mfma_f32_16x16x32_bf16 v[64:67], v[80:83], a[148:151], v[64:67]
s_waitcnt lgkmcnt(5)
v_mfma_f32_16x16x32_bf16 v[48:51], v[84:87], a[144:147], v[48:51]
ds_read_b128 v[80:83], v5 offset:38912
v_mfma_f32_16x16x32_bf16 v[68:71], v[84:87], a[148:151], v[68:71]
s_waitcnt lgkmcnt(5)
v_mfma_f32_16x16x32_bf16 v[32:35], v[88:91], a[152:155], v[32:35]
ds_read_b128 v[84:87], v5 offset:39936
buffer_load_dwordx4 a[196:199], v1, s[8:11], s45 offen offset:1024 sc1
v_mfma_f32_16x16x32_bf16 v[52:55], v[88:91], a[156:159], v[52:55]
s_waitcnt lgkmcnt(5)
v_mfma_f32_16x16x32_bf16 v[36:39], v[92:95], a[152:155], v[36:39]
ds_read_b128 v[88:91], v5 offset:40960
v_mfma_f32_16x16x32_bf16 v[56:59], v[92:95], a[156:159], v[56:59]
s_waitcnt lgkmcnt(5)
v_mfma_f32_16x16x32_bf16 v[40:43], v[96:99], a[152:155], v[40:43]
ds_read_b128 v[92:95], v5 offset:41984
s_add_u32 m0, s61, 149504
v_mfma_f32_16x16x32_bf16 v[60:63], v[96:99], a[156:159], v[60:63]
s_waitcnt lgkmcnt(5)
s_add_u32 s42, s62, 245760
v_mfma_f32_16x16x32_bf16 v[44:47], v[72:75], a[152:155], v[44:47]
ds_read_b128 v[96:99], v10 offset:2048
buffer_load_dwordx4 v1, s[8:11], s42 offen lds
v_mfma_f32_16x16x32_bf16 v[64:67], v[72:75], a[156:159], v[64:67]
s_waitcnt lgkmcnt(5)
v_mfma_f32_16x16x32_bf16 v[48:51], v[76:79], a[152:155], v[48:51]
s_waitcnt vmcnt(12)
s_barrier
ds_read_b128 v[72:75], v6 offset:0
s_add_u32 s45, s44, 204800
v_mfma_f32_16x16x32_bf16 v[68:71], v[76:79], a[156:159], v[68:71]
s_waitcnt lgkmcnt(5)
buffer_load_dwordx4 a[200:203], v1, s[8:11], s45 offen offset:0 sc1
v_mfma_f32_16x16x32_bf16 v[32:35], v[80:83], a[160:163], v[32:35]
ds_read_b128 v[76:79], v6 offset:1024
v_mfma_f32_16x16x32_bf16 v[52:55], v[80:83], a[164:167], v[52:55]
s_waitcnt lgkmcnt(5)
v_mfma_f32_16x16x32_bf16 v[36:39], v[84:87], a[160:163], v[36:39]
ds_read_b128 v[80:83], v6 offset:2048
v_mfma_f32_16x16x32_bf16 v[56:59], v[84:87], a[164:167], v[56:59]
s_waitcnt lgkmcnt(5)
v_mfma_f32_16x16x32_bf16 v[40:43], v[88:91], a[160:163], v[40:43]
ds_read_b128 v[84:87], v6 offset:3072
buffer_load_dwordx4 a[204:207], v1, s[8:11], s45 offen offset:1024 sc1
v_mfma_f32_16x16x32_bf16 v[60:63], v[88:91], a[164:167], v[60:63]
s_waitcnt lgkmcnt(5)
v_mfma_f32_16x16x32_bf16 v[44:47], v[92:95], a[160:163], v[44:47]
ds_read_b128 v[88:91], v6 offset:4096
v_mfma_f32_16x16x32_bf16 v[64:67], v[92:95], a[164:167], v[64:67]
s_waitcnt lgkmcnt(5)
v_mfma_f32_16x16x32_bf16 v[48:51], v[96:99], a[160:163], v[48:51]
ds_read_b128 v[92:95], v6 offset:5120
v_mfma_f32_16x16x32_bf16 v[68:71], v[96:99], a[164:167], v[68:71]
s_waitcnt lgkmcnt(5)
v_mfma_f32_16x16x32_bf16 v[32:35], v[72:75], a[168:171], v[32:35]
ds_read_b128 v[96:99], v6 offset:6144
v_mfma_f32_16x16x32_bf16 v[52:55], v[72:75], a[172:175], v[52:55]
s_waitcnt lgkmcnt(5)
v_mfma_f32_16x16x32_bf16 v[36:39], v[76:79], a[168:171], v[36:39]
ds_read_b128 v[72:75], v6 offset:7168
s_add_u32 s45, s44, 212992
v_mfma_f32_16x16x32_bf16 v[56:59], v[76:79], a[172:175], v[56:59]
s_waitcnt lgkmcnt(5)
buffer_load_dwordx4 a[208:211], v1, s[8:11], s45 offen offset:0 sc1
v_mfma_f32_16x16x32_bf16 v[40:43], v[80:83], a[168:171], v[40:43]
ds_read_b128 v[76:79], v6 offset:8192
v_mfma_f32_16x16x32_bf16 v[60:63], v[80:83], a[172:175], v[60:63]
s_waitcnt lgkmcnt(5)
v_mfma_f32_16x16x32_bf16 v[44:47], v[84:87], a[168:171], v[44:47]
ds_read_b128 v[80:83], v6 offset:9216
v_mfma_f32_16x16x32_bf16 v[64:67], v[84:87], a[172:175], v[64:67]
s_waitcnt lgkmcnt(5)
v_mfma_f32_16x16x32_bf16 v[48:51], v[88:91], a[168:171], v[48:51]
ds_read_b128 v[84:87], v6 offset:10240
v_mfma_f32_16x16x32_bf16 v[68:71], v[88:91], a[172:175], v[68:71]
s_waitcnt lgkmcnt(5)
v_mfma_f32_16x16x32_bf16 v[32:35], v[92:95], a[176:179], v[32:35]
ds_read_b128 v[88:91], v6 offset:11264
buffer_load_dwordx4 a[212:215], v1, s[8:11], s45 offen offset:1024 sc1
v_mfma_f32_16x16x32_bf16 v[52:55], v[92:95], a[180:183], v[52:55]
s_waitcnt lgkmcnt(5)
v_mfma_f32_16x16x32_bf16 v[36:39], v[96:99], a[176:179], v[36:39]
ds_read_b128 v[92:95], v6 offset:12288
v_mfma_f32_16x16x32_bf16 v[56:59], v[96:99], a[180:183], v[56:59]
s_waitcnt lgkmcnt(5)
v_mfma_f32_16x16x32_bf16 v[40:43], v[72:75], a[176:179], v[40:43]
ds_read_b128 v[96:99], v6 offset:13312
v_mfma_f32_16x16x32_bf16 v[60:63], v[72:75], a[180:183], v[60:63]
s_waitcnt lgkmcnt(5)
v_mfma_f32_16x16x32_bf16 v[44:47], v[76:79], a[176:179], v[44:47]
ds_read_b128 v[72:75], v10 offset:4096
v_mfma_f32_16x16x32_bf16 v[64:67], v[76:79], a[180:183], v[64:67]
s_waitcnt lgkmcnt(5)
v_mfma_f32_16x16x32_bf16 v[48:51], v[80:83], a[176:179], v[48:51]
s_waitcnt vmcnt(4)
s_barrier
ds_read_b128 v[76:79], v6 offset:28672
v_mfma_f32_16x16x32_bf16 v[68:71], v[80:83], a[180:183], v[68:71]
s_waitcnt lgkmcnt(5)
v_mfma_f32_16x16x32_bf16 v[32:35], v[84:87], a[184:187], v[32:35]
ds_read_b128 v[80:83], v6 offset:29696
v_mfma_f32_16x16x32_bf16 v[52:55], v[84:87], a[188:191], v[52:55]
s_waitcnt lgkmcnt(5)
v_mfma_f32_16x16x32_bf16 v[36:39], v[88:91], a[184:187], v[36:39]
ds_read_b128 v[84:87], v6 offset:30720
v_mfma_f32_16x16x32_bf16 v[56:59], v[88:91], a[188:191], v[56:59]
s_waitcnt lgkmcnt(5)
v_mfma_f32_16x16x32_bf16 v[40:43], v[92:95], a[184:187], v[40:43]
ds_read_b128 v[88:91], v6 offset:31744
v_mfma_f32_16x16x32_bf16 v[60:63], v[92:95], a[188:191], v[60:63]
s_waitcnt lgkmcnt(5)
v_mfma_f32_16x16x32_bf16 v[44:47], v[96:99], a[184:187], v[44:47]
ds_read_b128 v[92:95], v6 offset:32768
v_mfma_f32_16x16x32_bf16 v[64:67], v[96:99], a[188:191], v[64:67]
s_waitcnt lgkmcnt(5)
v_mfma_f32_16x16x32_bf16 v[48:51], v[72:75], a[184:187], v[48:51]
ds_read_b128 v[96:99], v6 offset:33792
v_mfma_f32_16x16x32_bf16 v[68:71], v[72:75], a[188:191], v[68:71]
s_waitcnt lgkmcnt(5)
v_mfma_f32_16x16x32_bf16 v[32:35], v[76:79], a[192:195], v[32:35]
ds_read_b128 v[72:75], v6 offset:34816
v_mfma_f32_16x16x32_bf16 v[52:55], v[76:79], a[196:199], v[52:55]
s_waitcnt lgkmcnt(5)
v_mfma_f32_16x16x32_bf16 v[36:39], v[80:83], a[192:195], v[36:39]
ds_read_b128 v[76:79], v6 offset:35840
v_mfma_f32_16x16x32_bf16 v[56:59], v[80:83], a[196:199], v[56:59]
s_waitcnt lgkmcnt(5)
v_mfma_f32_16x16x32_bf16 v[40:43], v[84:87], a[192:195], v[40:43]
ds_read_b128 v[80:83], v6 offset:36864
v_mfma_f32_16x16x32_bf16 v[60:63], v[84:87], a[196:199], v[60:63]
s_waitcnt lgkmcnt(5)
v_mfma_f32_16x16x32_bf16 v[44:47], v[88:91], a[192:195], v[44:47]
ds_read_b128 v[84:87], v6 offset:37888
v_mfma_f32_16x16x32_bf16 v[64:67], v[88:91], a[196:199], v[64:67]
s_waitcnt lgkmcnt(5)
v_mfma_f32_16x16x32_bf16 v[48:51], v[92:95], a[192:195], v[48:51]
ds_read_b128 v[88:91], v6 offset:38912
v_mfma_f32_16x16x32_bf16 v[68:71], v[92:95], a[196:199], v[68:71]
s_waitcnt lgkmcnt(5) vmcnt(2)
v_mfma_f32_16x16x32_bf16 v[32:35], v[96:99], a[200:203], v[32:35]
ds_read_b128 v[92:95], v6 offset:39936
v_mfma_f32_16x16x32_bf16 v[52:55], v[96:99], a[204:207], v[52:55]
s_waitcnt lgkmcnt(5)
v_mfma_f32_16x16x32_bf16 v[36:39], v[72:75], a[200:203], v[36:39]
ds_read_b128 v[96:99], v6 offset:40960
v_mfma_f32_16x16x32_bf16 v[56:59], v[72:75], a[204:207], v[56:59]
s_waitcnt lgkmcnt(5)
v_mfma_f32_16x16x32_bf16 v[40:43], v[76:79], a[200:203], v[40:43]
ds_read_b128 v[72:75], v6 offset:41984
v_mfma_f32_16x16x32_bf16 v[60:63], v[76:79], a[204:207], v[60:63]
s_waitcnt lgkmcnt(5)
v_mfma_f32_16x16x32_bf16 v[44:47], v[80:83], a[200:203], v[44:47]
ds_read_b128 v[76:79], v10 offset:6144
v_mfma_f32_16x16x32_bf16 v[64:67], v[80:83], a[204:207], v[64:67]
s_waitcnt lgkmcnt(5)
v_mfma_f32_16x16x32_bf16 v[48:51], v[84:87], a[200:203], v[48:51]
v_mfma_f32_16x16x32_bf16 v[68:71], v[84:87], a[204:207], v[68:71]
s_waitcnt lgkmcnt(4) vmcnt(0)
v_mfma_f32_16x16x32_bf16 v[32:35], v[88:91], a[208:211], v[32:35]
v_mfma_f32_16x16x32_bf16 v[52:55], v[88:91], a[212:215], v[52:55]
s_waitcnt lgkmcnt(3)
v_mfma_f32_16x16x32_bf16 v[36:39], v[92:95], a[208:211], v[36:39]
v_mfma_f32_16x16x32_bf16 v[56:59], v[92:95], a[212:215], v[56:59]
s_waitcnt lgkmcnt(2)
v_mfma_f32_16x16x32_bf16 v[40:43], v[96:99], a[208:211], v[40:43]
v_mfma_f32_16x16x32_bf16 v[60:63], v[96:99], a[212:215], v[60:63]
s_waitcnt lgkmcnt(1)
v_mfma_f32_16x16x32_bf16 v[44:47], v[72:75], a[208:211], v[44:47]
v_mfma_f32_16x16x32_bf16 v[64:67], v[72:75], a[212:215], v[64:67]
s_waitcnt lgkmcnt(0)
v_mfma_f32_16x16x32_bf16 v[48:51], v[76:79], a[208:211], v[48:51]
v_mfma_f32_16x16x32_bf16 v[68:71], v[76:79], a[212:215], v[68:71]
s_mul_i32 s48, s16, 5120
s_add_u32 s48, s48, 0
v_add_u32 v5, s48, v1
s_xor_b32 s49, s16, 2
s_mul_i32 s49, s49, 5120
s_add_u32 s49, s49, 0
v_add_u32_e64 v6, s49, v1
v_accvgpr_read_b32 v100, a246
v_accvgpr_read_b32 v101, a247
v_accvgpr_read_b32 v102, a248
v_accvgpr_read_b32 v103, a249
v_accvgpr_read_b32 v104, a250
v_accvgpr_read_b32 v105, a251
v_accvgpr_read_b32 v106, a252
v_accvgpr_read_b32 v107, a253
v_accvgpr_read_b32 v108, a254
v_accvgpr_read_b32 v109, a255
s_barrier
s_cmp_lg_u32 s96, 0
s_cbranch_scc1 L_kh1_81
ds_write_b128 v5, v[52:55] offset:0
ds_write_b128 v5, v[56:59] offset:1024
ds_write_b128 v5, v[60:63] offset:2048
ds_write_b128 v5, v[64:67] offset:3072
ds_write_b128 v5, v[68:71] offset:4096
s_waitcnt lgkmcnt(0)
s_barrier
ds_read_b128 v[112:115], v6 offset:0
ds_read_b128 v[116:119], v6 offset:1024
ds_read_b128 v[120:123], v6 offset:2048
ds_read_b128 v[124:127], v6 offset:3072
ds_read_b128 v[128:131], v6 offset:4096
s_waitcnt lgkmcnt(0)
v_pk_add_f32 v[72:73], v[32:33], v[112:113]
v_pk_add_f32 v[74:75], v[34:35], v[114:115]
v_pk_add_f32 v[76:77], v[36:37], v[116:117]
v_pk_add_f32 v[78:79], v[38:39], v[118:119]
v_pk_add_f32 v[80:81], v[40:41], v[120:121]
v_pk_add_f32 v[82:83], v[42:43], v[122:123]
v_pk_add_f32 v[84:85], v[44:45], v[124:125]
v_pk_add_f32 v[86:87], v[46:47], v[126:127]
v_pk_add_f32 v[88:89], v[48:49], v[128:129]
v_pk_add_f32 v[90:91], v[50:51], v[130:131]
s_branch L_khd_82
L_kh1_81:
ds_write_b128 v5, v[32:35] offset:0
ds_write_b128 v5, v[36:39] offset:1024
ds_write_b128 v5, v[40:43] offset:2048
ds_write_b128 v5, v[44:47] offset:3072
ds_write_b128 v5, v[48:51] offset:4096
s_waitcnt lgkmcnt(0)
s_barrier
ds_read_b128 v[112:115], v6 offset:0
ds_read_b128 v[116:119], v6 offset:1024
ds_read_b128 v[120:123], v6 offset:2048
ds_read_b128 v[124:127], v6 offset:3072
ds_read_b128 v[128:131], v6 offset:4096
s_waitcnt lgkmcnt(0)
v_pk_add_f32 v[72:73], v[52:53], v[112:113]
v_pk_add_f32 v[74:75], v[54:55], v[114:115]
v_pk_add_f32 v[76:77], v[56:57], v[116:117]
v_pk_add_f32 v[78:79], v[58:59], v[118:119]
v_pk_add_f32 v[80:81], v[60:61], v[120:121]
v_pk_add_f32 v[82:83], v[62:63], v[122:123]
v_pk_add_f32 v[84:85], v[64:65], v[124:125]
v_pk_add_f32 v[86:87], v[66:67], v[126:127]
v_pk_add_f32 v[88:89], v[68:69], v[128:129]
v_pk_add_f32 v[90:91], v[70:71], v[130:131]
L_khd_82:
s_mov_b32 s53, 0x00003f80
s_mov_b32 s54, 0x3f800000
s_nop 0
v_dot2_f32_bf16 v72, v100, s53, v72
v_dot2_f32_bf16 v73, v100, s54, v73
v_dot2_f32_bf16 v74, v101, s53, v74
v_dot2_f32_bf16 v75, v101, s54, v75
v_dot2_f32_bf16 v76, v102, s53, v76
v_dot2_f32_bf16 v77, v102, s54, v77
v_dot2_f32_bf16 v78, v103, s53, v78
v_dot2_f32_bf16 v79, v103, s54, v79
v_dot2_f32_bf16 v80, v104, s53, v80
v_dot2_f32_bf16 v81, v104, s54, v81
v_dot2_f32_bf16 v82, v105, s53, v82
v_dot2_f32_bf16 v83, v105, s54, v83
v_dot2_f32_bf16 v84, v106, s53, v84
v_dot2_f32_bf16 v85, v106, s54, v85
v_dot2_f32_bf16 v86, v107, s53, v86
v_dot2_f32_bf16 v87, v107, s54, v87
v_dot2_f32_bf16 v88, v108, s53, v88
v_dot2_f32_bf16 v89, v108, s54, v89
v_dot2_f32_bf16 v90, v109, s53, v90
v_dot2_f32_bf16 v91, v109, s54, v91
s_nop 2
s_nop 0
v_cvt_pk_bf16_f32 v132, v72, v73
v_cvt_pk_bf16_f32 v133, v74, v75
v_cvt_pk_bf16_f32 v134, v76, v77
v_cvt_pk_bf16_f32 v135, v78, v79
v_cvt_pk_bf16_f32 v136, v80, v81
v_cvt_pk_bf16_f32 v137, v82, v83
v_cvt_pk_bf16_f32 v138, v84, v85
v_cvt_pk_bf16_f32 v139, v86, v87
v_cvt_pk_bf16_f32 v140, v88, v89
v_cvt_pk_bf16_f32 v141, v90, v91
buffer_store_dwordx2 v[132:133], v8, s[12:15], s63 offen offset:0 nt
buffer_store_dwordx2 v[134:135], v8, s[12:15], s63 offen offset:32 nt
buffer_store_dwordx2 v[136:137], v8, s[12:15], s63 offen offset:64 nt
buffer_store_dwordx2 v[138:139], v8, s[12:15], s63 offen offset:96 nt
buffer_store_dwordx2 v[140:141], v8, s[12:15], s63 offen offset:128 nt
s_endpgm
L_end_interleave_layers__sliding_local_dilated__glu_gated_geglu__prompt_kernel:
s_endpgm
.section .rodata,"a"
.p2align 6
.amdhsa_kernel interleave_layers__sliding_local_dilated__glu_gated_geglu__prompt_kernel
  .amdhsa_next_free_vgpr 512
  .amdhsa_next_free_sgpr 102
  .amdhsa_accum_offset 256
  .amdhsa_group_segment_fixed_size 0
  .amdhsa_kernarg_size 80
  .amdhsa_user_sgpr_count 2
  .amdhsa_user_sgpr_kernarg_segment_ptr 1
  .amdhsa_system_sgpr_workgroup_id_x 1
.end_amdhsa_kernel
.text
```
